```python
import torch

def _softmax(x, axis=-1):
    return torch.softmax(x, dim=axis)
def _gelu(x):
    return torch.nn.functional.gelu(x, approximate="tanh")
def _silu(x):
    return torch.nn.functional.silu(x)
def _sigmoid(x):
    return torch.sigmoid(x)
def _layernorm(x, axis=-1, eps=1e-5):
    m = x.mean(dim=axis, keepdim=True)
    v = x.var(dim=axis, keepdim=True, unbiased=False)
    return (x - m) / torch.sqrt(v + eps)
def _scatter_add(tgt, idx, src, axis=0):
    return tgt.clone().index_add_(axis, idx, src)
def _segment_sum(src, seg, n):
    out = torch.zeros((n,) + src.shape[1:], dtype=src.dtype)
    return out.index_add_(0, seg, src)
def _pad(x, pw):
    flat = tuple(v for pair in reversed(pw) for v in pair)
    return torch.nn.functional.pad(x, flat)

kernel_name = 'interleave_layers__spectral_fnet__dense_activation_relu__prompt'

def setup_inputs():

    _w = (lambda a: (lambda t: t.to(torch.bfloat16) if t.is_floating_point() else t)(torch.as_tensor(a)))
    def _A_setup():
        B, S, D = 1, 2048, 512
        ns = torch.arange(S)[:, None] * torch.arange(S)[None, :]
        nd = torch.arange(D)[:, None] * torch.arange(D)[None, :]
        Ws_re = torch.cos(-2.0 * torch.pi * ns / S).to(float)
        Ws_im = torch.sin(-2.0 * torch.pi * ns / S).to(float)
        Wd_re = torch.cos(-2.0 * torch.pi * nd / D).to(float)
        Wd_im = torch.sin(-2.0 * torch.pi * nd / D).to(float)
        return {
            "x": _w((lambda *s: torch.randn(*s, dtype=torch.bfloat16) * 0.05)(B, S, D)),
            "dft_seq_re": _w(Ws_re),
            "dft_seq_im": _w(Ws_im),
            "dft_hid_re": _w(Wd_re),
            "dft_hid_im": _w(Wd_im),
        }
    _A_in = _A_setup()

    def _B_setup():
        B, S, D, Dff = 1, 2048, 512, 1792
        return {
            "x": _w((lambda *s: torch.randn(*s, dtype=torch.bfloat16) * 0.05)(B, S, D)),
            "w1": _w((lambda *s: torch.randn(*s, dtype=torch.bfloat16) * 1.6)(D, Dff)),
            "w2": _w((lambda *s: torch.randn(*s, dtype=torch.bfloat16) * 1.6)(Dff, D)),
        }
    _B_in = _B_setup()

    return {
        "A_x": _A_in["x"],
        "A_dft_seq_re": _A_in["dft_seq_re"],
        "A_dft_seq_im": _A_in["dft_seq_im"],
        "A_dft_hid_re": _A_in["dft_hid_re"],
        "A_dft_hid_im": _A_in["dft_hid_im"],
        "B_x": _B_in["x"],
        "B_w1": _B_in["w1"],
        "B_w2": _B_in["w2"],
    }

def reference(A_x, A_dft_seq_re, A_dft_seq_im, A_dft_hid_re, A_dft_hid_im, B_x, B_w1, B_w2):
    def _A_ref(x, dft_seq_re, dft_seq_im, dft_hid_re, dft_hid_im):
        a = torch.einsum("bsd,ed->bse", x, dft_hid_re)
        b = torch.einsum("bsd,ed->bse", x, dft_hid_im)
        y = torch.einsum("ts,bse->bte", dft_seq_re, a) - torch.einsum("ts,bse->bte", dft_seq_im, b)
        return y

    def _B_ref(x, w1, w2):
        h = torch.einsum("bsd,df->bsf", x, w1)
        zero = torch.zeros_like(h)
        h = torch.maximum(h, zero)
        return torch.einsum("bsf,fd->bsd", h, w2)

    x = A_x
    x = x + _A_ref(_layernorm(x, axis=-1), A_dft_seq_re, A_dft_seq_im, A_dft_hid_re, A_dft_hid_im)
    x = x + _B_ref(_layernorm(x, axis=-1), B_w1, B_w2)
    x = x + _A_ref(_layernorm(x, axis=-1), A_dft_seq_re, A_dft_seq_im, A_dft_hid_re, A_dft_hid_im)
    x = x + _B_ref(_layernorm(x, axis=-1), B_w1, B_w2)
    return x
```

```asm
; @launch grid=(256,1,1) block=(256,1,1) lds=163840
.amdgcn_target "amdgcn-amd-amdhsa--gfx950"
.text
.globl interleave_layers__spectral_fnet__dense_activation_relu__prompt_kernel
.p2align 8
.type interleave_layers__spectral_fnet__dense_activation_relu__prompt_kernel,@function
interleave_layers__spectral_fnet__dense_activation_relu__prompt_kernel:
  s_cmp_ge_u32 s2, 256
  s_cbranch_scc1 END
  s_load_dwordx4 s[4:7], s[0:1], 0
  s_load_dwordx2 s[12:13], s[0:1], 16
  s_load_dwordx4 s[16:19], s[0:1], 48
  s_load_dwordx4 s[24:27], s[0:1], 64
  s_load_dwordx2 s[28:29], s[0:1], 80
  s_getreg_b32 s59, hwreg(HW_REG_XCC_ID, 0, 4)
  s_getpc_b64 s[44:45]
PCL:
  s_add_u32 s44, s44, TABLE-PCL
  s_addc_u32 s45, s45, 0
  v_lshrrev_b32 v5, 6, v0
  v_and_b32 v0, 63, v0
  s_and_b32 s36, s2, 7
  s_lshr_b32 s37, s2, 3
  v_readfirstlane_b32 s41, v5
  s_lshr_b32 s47, s37, 4
  s_lshl_b32 s46, s36, 1
  s_add_u32 s46, s46, s47
  s_sub_u32 s48, 32, s46
  s_cmp_eq_u32 s46, 0
  s_cselect_b32 s48, 16, s48
  s_bitcmp1_b32 s37, 3
  s_cselect_b32 s38, s48, s46
  s_and_b32 s39, s37, 7
  s_and_b32 s40, s37, 15
  s_bitcmp1_b32 s41, 1
  s_cselect_b32 s46, s48, s46
  v_and_b32 v1, 15, v0
  v_lshrrev_b32 v2, 4, v0
  v_bfe_u32 v3, v0, 2, 2
  v_and_b32 v4, 3, v0
  s_waitcnt lgkmcnt(0)
  s_mov_b32 s8, s6
  s_mov_b32 s9, s7
  s_mov_b32 s32, s26
  s_mov_b32 s33, s27
  s_mov_b32 s20, s18
  s_mov_b32 s21, s19
  s_mov_b32 s6, 0x200000
  s_mov_b32 s7, 0x20000
  s_mov_b32 s10, 0x800000
  s_mov_b32 s11, 0x20000
  s_mov_b32 s14, 0x800000
  s_mov_b32 s15, 0x20000
  s_mov_b32 s18, 1835008
  s_mov_b32 s19, 0x20000
  s_mov_b32 s22, 1835008
  s_mov_b32 s23, 0x20000
  s_mov_b32 s26, 0x200000
  s_mov_b32 s27, 0x20000
  s_mov_b32 s30, 20971520
  s_mov_b32 s31, 0x20000
  s_mov_b32 s34, 256
  s_mov_b32 s35, 0x20000
  s_mov_b32 s43, 0
  s_add_u32 s28, s28, 0
  s_addc_u32 s29, s29, 0
  s_cmp_lg_u32 s2, 0
  s_cbranch_scc1 NON_1
  s_cmp_lg_u32 s41, 0
  s_cbranch_scc1 NON_1
  s_memrealtime s[56:57]
  s_waitcnt lgkmcnt(0)
  s_lshl_b32 s56, s56, 8
  s_or_b32 s56, s56, 0x80000000
  v_mov_b32 v5, s56
  v_mov_b32 v6, 0
  s_mov_b64 exec, 1
  buffer_store_dword v5, v6, s[32:35], 0 offen sc1
  s_mov_b64 exec, -1
NON_1:
  v_lshrrev_b32 v6, 2, v0
  v_bfe_u32 v7, v6, 3, 1
  s_lshl_b32 s47, s41, 1
  v_add_u32 v7, s47, v7
  v_lshrrev_b32 v8, 2, v7
  v_and_b32 v7, 3, v7
  v_lshl_add_u32 v8, v7, 4, v8
  v_and_b32 v7, 7, v6
  v_lshl_add_u32 v8, v7, 1, v8
  v_lshlrev_b32 v8, 5, v8
  v_add_u32 v8, s38, v8
  v_lshlrev_b32 v8, 10, v8
  v_lshl_add_u32 v8, v4, 4, v8
  s_lshl_b32 s47, s39, 7
  buffer_load_dwordx4 v[16:19], v8, s[4:7], s47 offen
  s_add_u32 s47, s47, 64
  s_and_b32 s47, s47, 1023
  buffer_load_dwordx4 v[20:23], v8, s[4:7], s47 offen
  s_add_u32 s47, s47, 64
  s_and_b32 s47, s47, 1023
  buffer_load_dwordx4 v[24:27], v8, s[4:7], s47 offen
  s_add_u32 s47, s47, 64
  s_and_b32 s47, s47, 1023
  buffer_load_dwordx4 v[28:31], v8, s[4:7], s47 offen
  s_add_u32 s47, s47, 64
  s_and_b32 s47, s47, 1023
  buffer_load_dwordx4 v[32:35], v8, s[4:7], s47 offen
  s_add_u32 s47, s47, 64
  s_and_b32 s47, s47, 1023
  buffer_load_dwordx4 v[36:39], v8, s[4:7], s47 offen
  s_add_u32 s47, s47, 64
  s_and_b32 s47, s47, 1023
  buffer_load_dwordx4 v[40:43], v8, s[4:7], s47 offen
  s_add_u32 s47, s47, 64
  s_and_b32 s47, s47, 1023
  buffer_load_dwordx4 v[44:47], v8, s[4:7], s47 offen
  s_add_u32 s47, s47, 64
  s_and_b32 s47, s47, 1023
  buffer_load_dwordx4 v[48:51], v8, s[4:7], s47 offen
  s_add_u32 s47, s47, 64
  s_and_b32 s47, s47, 1023
  buffer_load_dwordx4 v[52:55], v8, s[4:7], s47 offen
  s_add_u32 s47, s47, 64
  s_and_b32 s47, s47, 1023
  buffer_load_dwordx4 v[56:59], v8, s[4:7], s47 offen
  s_add_u32 s47, s47, 64
  s_and_b32 s47, s47, 1023
  buffer_load_dwordx4 v[60:63], v8, s[4:7], s47 offen
  s_add_u32 s47, s47, 64
  s_and_b32 s47, s47, 1023
  buffer_load_dwordx4 v[64:67], v8, s[4:7], s47 offen
  s_add_u32 s47, s47, 64
  s_and_b32 s47, s47, 1023
  buffer_load_dwordx4 v[68:71], v8, s[4:7], s47 offen
  s_add_u32 s47, s47, 64
  s_and_b32 s47, s47, 1023
  buffer_load_dwordx4 v[72:75], v8, s[4:7], s47 offen
  s_add_u32 s47, s47, 64
  s_and_b32 s47, s47, 1023
  buffer_load_dwordx4 v[76:79], v8, s[4:7], s47 offen
  s_lshr_b32 s47, s41, 1
  s_lshl_b32 s47, s47, 12
  v_lshlrev_b32 v5, 4, v0
  v_add_u32 v5, s47, v5
  global_load_dwordx4 v[128:131], v5, s[44:45] offset:0
  global_load_dwordx4 v[132:135], v5, s[44:45] offset:1024
  global_load_dwordx4 v[136:139], v5, s[44:45] offset:2048
  global_load_dwordx4 v[140:143], v5, s[44:45] offset:3072
  s_lshr_b32 s47, s39, 2
  s_and_b32 s48, s39, 3
  s_lshl_b32 s48, s48, 4
  s_add_u32 s47, s47, s48
  s_lshl_b32 s47, s47, 5
  s_add_u32 s47, s47, s38
  s_lshl_b32 s47, s47, 12
  v_lshrrev_b32 v5, 1, v1
  v_lshlrev_b32 v5, 18, v5
  v_lshl_add_u32 v5, v2, 4, v5
  buffer_load_dwordx4 v[80:83], v5, s[8:11], s47 offen
  buffer_load_dwordx4 v[84:87], v5, s[12:15], s47 offen
  s_lshl_b32 s47, s37, 12
  s_lshl_b32 s48, s41, 10
  s_add_u32 s47, s47, s48
  v_lshlrev_b32 v95, 4, v0
  v_add_u32 v95, s47, v95
  v_min_u32 v95, TABLE-interleave_layers__spectral_fnet__dense_activation_relu__prompt_kernel+18416, v95
  s_sub_u32 s48, s44, TABLE-interleave_layers__spectral_fnet__dense_activation_relu__prompt_kernel
  s_subb_u32 s49, s45, 0
  global_load_dwordx4 v[248:251], v95, s[48:49]
  s_lshl_b32 s47, s2, 2
  s_add_u32 s47, s47, s41
  s_mul_i32 s47, s47, 1792
  v_min_u32 v246, 13, v0
  v_lshlrev_b32 v246, 7, v246
  buffer_load_dword v247, v246, s[16:19], s47 offen
  v_lshlrev_b32 v5, 4, v0
  v_add_u32 v5, 0, v5
  v_mul_u32_u24 v6, 0x4925, v5
  v_lshrrev_b32 v6, 22, v6
  v_mul_u32_u24 v7, 224, v6
  v_sub_u32 v5, v5, v7
  v_mul_u32_u24 v6, 3584, v6
  v_add_u32 v88, v5, v6
  v_lshlrev_b32 v5, 4, v0
  v_add_u32 v5, 1024, v5
  v_mul_u32_u24 v6, 0x4925, v5
  v_lshrrev_b32 v6, 22, v6
  v_mul_u32_u24 v7, 224, v6
  v_sub_u32 v5, v5, v7
  v_mul_u32_u24 v6, 3584, v6
  v_add_u32 v89, v5, v6
  v_lshlrev_b32 v5, 4, v0
  v_add_u32 v5, 2048, v5
  v_mul_u32_u24 v6, 0x4925, v5
  v_lshrrev_b32 v6, 22, v6
  v_mul_u32_u24 v7, 224, v6
  v_sub_u32 v5, v5, v7
  v_mul_u32_u24 v6, 3584, v6
  v_add_u32 v90, v5, v6
  v_lshlrev_b32 v5, 4, v0
  v_add_u32 v5, 3072, v5
  v_mul_u32_u24 v6, 0x4925, v5
  v_lshrrev_b32 v6, 22, v6
  v_mul_u32_u24 v7, 224, v6
  v_sub_u32 v5, v5, v7
  v_mul_u32_u24 v6, 3584, v6
  v_add_u32 v91, v5, v6
  v_lshlrev_b32 v5, 4, v0
  v_add_u32 v5, 4096, v5
  v_mul_u32_u24 v6, 0x4925, v5
  v_lshrrev_b32 v6, 22, v6
  v_mul_u32_u24 v7, 224, v6
  v_sub_u32 v5, v5, v7
  v_mul_u32_u24 v6, 3584, v6
  v_add_u32 v92, v5, v6
  v_lshlrev_b32 v5, 4, v0
  v_add_u32 v5, 5120, v5
  v_mul_u32_u24 v6, 0x4925, v5
  v_lshrrev_b32 v6, 22, v6
  v_mul_u32_u24 v7, 224, v6
  v_sub_u32 v5, v5, v7
  v_mul_u32_u24 v6, 3584, v6
  v_add_u32 v93, v5, v6
  v_lshlrev_b32 v5, 4, v0
  v_add_u32 v5, 6144, v5
  v_mul_u32_u24 v6, 0x4925, v5
  v_lshrrev_b32 v6, 22, v6
  v_mul_u32_u24 v7, 224, v6
  v_sub_u32 v5, v5, v7
  v_mul_u32_u24 v6, 3584, v6
  v_add_u32 v94, v5, v6
  s_mul_i32 s50, s40, 224
  s_mul_i32 s51, s41, 458752
  s_add_u32 s50, s50, s51
  s_mul_i32 s51, s41, 28672
  s_add_u32 s51, s51, 0
  s_lshr_b32 s52, s37, 4
  s_lshl_b32 s52, s52, 1
  s_add_u32 s52, s52, s36
  s_add_u32 s52, s52, 0
  s_and_b32 s52, s52, 3
  s_mul_i32 s53, s52, 114688
  s_add_u32 s53, s53, s50
  s_mul_i32 s52, s52, 7168
  s_add_u32 s52, s52, s51
  s_add_u32 m0, s52, 0
  s_nop 0
  buffer_load_dwordx4 v88, s[16:19], s53 offen lds
  s_add_u32 m0, s52, 1024
  s_nop 0
  buffer_load_dwordx4 v89, s[16:19], s53 offen lds
  s_add_u32 m0, s52, 2048
  s_nop 0
  buffer_load_dwordx4 v90, s[16:19], s53 offen lds
  s_add_u32 m0, s52, 3072
  s_nop 0
  buffer_load_dwordx4 v91, s[16:19], s53 offen lds
  s_add_u32 m0, s52, 4096
  s_nop 0
  buffer_load_dwordx4 v92, s[16:19], s53 offen lds
  s_add_u32 m0, s52, 5120
  s_nop 0
  buffer_load_dwordx4 v93, s[16:19], s53 offen lds
  s_add_u32 m0, s52, 6144
  s_nop 0
  buffer_load_dwordx4 v94, s[16:19], s53 offen lds
  s_lshr_b32 s52, s37, 4
  s_lshl_b32 s52, s52, 1
  s_add_u32 s52, s52, s36
  s_add_u32 s52, s52, 1
  s_and_b32 s52, s52, 3
  s_mul_i32 s53, s52, 114688
  s_add_u32 s53, s53, s50
  s_mul_i32 s52, s52, 7168
  s_add_u32 s52, s52, s51
  s_add_u32 m0, s52, 0
  s_nop 0
  buffer_load_dwordx4 v88, s[16:19], s53 offen lds
  s_waitcnt vmcnt(16)
  v_mov_b32 v95, 0
  buffer_load_dword v95, v95, s[32:35], 0 offen sc1
  s_mov_b32 s47, 0x3f803f80
  v_mov_b32 v9, 0
  v_mov_b32 v10, 0
  v_mov_b32 v11, 0
  v_mov_b32 v12, 0
  v_dot2_f32_bf16 v9, v16, s47, v9
  v_dot2_f32_bf16 v10, v16, v16, v10
  v_dot2_f32_bf16 v11, v17, s47, v11
  v_dot2_f32_bf16 v12, v17, v17, v12
  v_dot2_f32_bf16 v9, v18, s47, v9
  v_dot2_f32_bf16 v10, v18, v18, v10
  v_dot2_f32_bf16 v11, v19, s47, v11
  v_dot2_f32_bf16 v12, v19, v19, v12
  v_dot2_f32_bf16 v9, v20, s47, v9
  v_dot2_f32_bf16 v10, v20, v20, v10
  v_dot2_f32_bf16 v11, v21, s47, v11
  v_dot2_f32_bf16 v12, v21, v21, v12
  v_dot2_f32_bf16 v9, v22, s47, v9
  v_dot2_f32_bf16 v10, v22, v22, v10
  v_dot2_f32_bf16 v11, v23, s47, v11
  v_dot2_f32_bf16 v12, v23, v23, v12
  v_dot2_f32_bf16 v9, v24, s47, v9
  v_dot2_f32_bf16 v10, v24, v24, v10
  v_dot2_f32_bf16 v11, v25, s47, v11
  v_dot2_f32_bf16 v12, v25, v25, v12
  v_dot2_f32_bf16 v9, v26, s47, v9
  v_dot2_f32_bf16 v10, v26, v26, v10
  v_dot2_f32_bf16 v11, v27, s47, v11
  v_dot2_f32_bf16 v12, v27, v27, v12
  v_dot2_f32_bf16 v9, v28, s47, v9
  v_dot2_f32_bf16 v10, v28, v28, v10
  v_dot2_f32_bf16 v11, v29, s47, v11
  v_dot2_f32_bf16 v12, v29, v29, v12
  v_dot2_f32_bf16 v9, v30, s47, v9
  v_dot2_f32_bf16 v10, v30, v30, v10
  v_dot2_f32_bf16 v11, v31, s47, v11
  v_dot2_f32_bf16 v12, v31, v31, v12
  v_dot2_f32_bf16 v9, v32, s47, v9
  v_dot2_f32_bf16 v10, v32, v32, v10
  v_dot2_f32_bf16 v11, v33, s47, v11
  v_dot2_f32_bf16 v12, v33, v33, v12
  v_dot2_f32_bf16 v9, v34, s47, v9
  v_dot2_f32_bf16 v10, v34, v34, v10
  v_dot2_f32_bf16 v11, v35, s47, v11
  v_dot2_f32_bf16 v12, v35, v35, v12
  v_dot2_f32_bf16 v9, v36, s47, v9
  v_dot2_f32_bf16 v10, v36, v36, v10
  v_dot2_f32_bf16 v11, v37, s47, v11
  v_dot2_f32_bf16 v12, v37, v37, v12
  v_dot2_f32_bf16 v9, v38, s47, v9
  v_dot2_f32_bf16 v10, v38, v38, v10
  v_dot2_f32_bf16 v11, v39, s47, v11
  v_dot2_f32_bf16 v12, v39, v39, v12
  v_dot2_f32_bf16 v9, v40, s47, v9
  v_dot2_f32_bf16 v10, v40, v40, v10
  v_dot2_f32_bf16 v11, v41, s47, v11
  v_dot2_f32_bf16 v12, v41, v41, v12
  v_dot2_f32_bf16 v9, v42, s47, v9
  v_dot2_f32_bf16 v10, v42, v42, v10
  v_dot2_f32_bf16 v11, v43, s47, v11
  v_dot2_f32_bf16 v12, v43, v43, v12
  v_dot2_f32_bf16 v9, v44, s47, v9
  v_dot2_f32_bf16 v10, v44, v44, v10
  v_dot2_f32_bf16 v11, v45, s47, v11
  v_dot2_f32_bf16 v12, v45, v45, v12
  v_dot2_f32_bf16 v9, v46, s47, v9
  v_dot2_f32_bf16 v10, v46, v46, v10
  v_dot2_f32_bf16 v11, v47, s47, v11
  v_dot2_f32_bf16 v12, v47, v47, v12
  v_dot2_f32_bf16 v9, v48, s47, v9
  v_dot2_f32_bf16 v10, v48, v48, v10
  v_dot2_f32_bf16 v11, v49, s47, v11
  v_dot2_f32_bf16 v12, v49, v49, v12
  v_dot2_f32_bf16 v9, v50, s47, v9
  v_dot2_f32_bf16 v10, v50, v50, v10
  v_dot2_f32_bf16 v11, v51, s47, v11
  v_dot2_f32_bf16 v12, v51, v51, v12
  v_dot2_f32_bf16 v9, v52, s47, v9
  v_dot2_f32_bf16 v10, v52, v52, v10
  v_dot2_f32_bf16 v11, v53, s47, v11
  v_dot2_f32_bf16 v12, v53, v53, v12
  v_dot2_f32_bf16 v9, v54, s47, v9
  v_dot2_f32_bf16 v10, v54, v54, v10
  v_dot2_f32_bf16 v11, v55, s47, v11
  v_dot2_f32_bf16 v12, v55, v55, v12
  v_dot2_f32_bf16 v9, v56, s47, v9
  v_dot2_f32_bf16 v10, v56, v56, v10
  v_dot2_f32_bf16 v11, v57, s47, v11
  v_dot2_f32_bf16 v12, v57, v57, v12
  v_dot2_f32_bf16 v9, v58, s47, v9
  v_dot2_f32_bf16 v10, v58, v58, v10
  v_dot2_f32_bf16 v11, v59, s47, v11
  v_dot2_f32_bf16 v12, v59, v59, v12
  v_dot2_f32_bf16 v9, v60, s47, v9
  v_dot2_f32_bf16 v10, v60, v60, v10
  v_dot2_f32_bf16 v11, v61, s47, v11
  v_dot2_f32_bf16 v12, v61, v61, v12
  v_dot2_f32_bf16 v9, v62, s47, v9
  v_dot2_f32_bf16 v10, v62, v62, v10
  v_dot2_f32_bf16 v11, v63, s47, v11
  v_dot2_f32_bf16 v12, v63, v63, v12
  v_dot2_f32_bf16 v9, v64, s47, v9
  v_dot2_f32_bf16 v10, v64, v64, v10
  v_dot2_f32_bf16 v11, v65, s47, v11
  v_dot2_f32_bf16 v12, v65, v65, v12
  v_dot2_f32_bf16 v9, v66, s47, v9
  v_dot2_f32_bf16 v10, v66, v66, v10
  v_dot2_f32_bf16 v11, v67, s47, v11
  v_dot2_f32_bf16 v12, v67, v67, v12
  v_dot2_f32_bf16 v9, v68, s47, v9
  v_dot2_f32_bf16 v10, v68, v68, v10
  v_dot2_f32_bf16 v11, v69, s47, v11
  v_dot2_f32_bf16 v12, v69, v69, v12
  v_dot2_f32_bf16 v9, v70, s47, v9
  v_dot2_f32_bf16 v10, v70, v70, v10
  v_dot2_f32_bf16 v11, v71, s47, v11
  v_dot2_f32_bf16 v12, v71, v71, v12
  v_dot2_f32_bf16 v9, v72, s47, v9
  v_dot2_f32_bf16 v10, v72, v72, v10
  v_dot2_f32_bf16 v11, v73, s47, v11
  v_dot2_f32_bf16 v12, v73, v73, v12
  v_dot2_f32_bf16 v9, v74, s47, v9
  v_dot2_f32_bf16 v10, v74, v74, v10
  v_dot2_f32_bf16 v11, v75, s47, v11
  v_dot2_f32_bf16 v12, v75, v75, v12
  v_dot2_f32_bf16 v9, v76, s47, v9
  v_dot2_f32_bf16 v10, v76, v76, v10
  v_dot2_f32_bf16 v11, v77, s47, v11
  v_dot2_f32_bf16 v12, v77, v77, v12
  v_dot2_f32_bf16 v9, v78, s47, v9
  v_dot2_f32_bf16 v10, v78, v78, v10
  v_dot2_f32_bf16 v11, v79, s47, v11
  v_dot2_f32_bf16 v12, v79, v79, v12
  s_nop 1
  v_add_f32 v9, v9, v11
  v_add_f32 v10, v10, v12
  s_nop 0
  v_add_f32_dpp v9, v9, v9 quad_perm:[1,0,3,2] row_mask:0xf bank_mask:0xf
  v_add_f32_dpp v10, v10, v10 quad_perm:[1,0,3,2] row_mask:0xf bank_mask:0xf
  s_nop 0
  v_add_f32_dpp v9, v9, v9 quad_perm:[2,3,0,1] row_mask:0xf bank_mask:0xf
  v_add_f32_dpp v10, v10, v10 quad_perm:[2,3,0,1] row_mask:0xf bank_mask:0xf
  v_mul_f32 v9, 0x3b000000, v9
  v_mul_f32 v10, 0x3b000000, v10
  v_fma_f32 v10, -v9, v9, v10
  v_max_f32 v10, 0, v10
  v_add_f32 v10, 0x3727c5ac, v10
  v_rsq_f32 v10, v10
  s_nop 0
  v_mul_f32 v9, v9, v10
  v_sub_f32 v9, 0, v9
  v_swap_b32 v9, v10
  v_lshlrev_b32 v11, 16, v16
  v_and_b32 v12, 0xffff0000, v16
  v_fma_f32 v11, v11, v9, v10
  v_fma_f32 v12, v12, v9, v10
  v_cvt_pk_bf16_f32 v16, v11, v12
  v_lshlrev_b32 v11, 16, v17
  v_and_b32 v12, 0xffff0000, v17
  v_fma_f32 v11, v11, v9, v10
  v_fma_f32 v12, v12, v9, v10
  v_cvt_pk_bf16_f32 v17, v11, v12
  v_lshlrev_b32 v11, 16, v18
  v_and_b32 v12, 0xffff0000, v18
  v_fma_f32 v11, v11, v9, v10
  v_fma_f32 v12, v12, v9, v10
  v_cvt_pk_bf16_f32 v18, v11, v12
  v_lshlrev_b32 v11, 16, v19
  v_and_b32 v12, 0xffff0000, v19
  v_fma_f32 v11, v11, v9, v10
  v_fma_f32 v12, v12, v9, v10
  v_cvt_pk_bf16_f32 v19, v11, v12
  v_lshlrev_b32 v11, 16, v20
  v_and_b32 v12, 0xffff0000, v20
  v_fma_f32 v11, v11, v9, v10
  v_fma_f32 v12, v12, v9, v10
  v_cvt_pk_bf16_f32 v20, v11, v12
  v_lshlrev_b32 v11, 16, v21
  v_and_b32 v12, 0xffff0000, v21
  v_fma_f32 v11, v11, v9, v10
  v_fma_f32 v12, v12, v9, v10
  v_cvt_pk_bf16_f32 v21, v11, v12
  v_lshlrev_b32 v11, 16, v22
  v_and_b32 v12, 0xffff0000, v22
  v_fma_f32 v11, v11, v9, v10
  v_fma_f32 v12, v12, v9, v10
  v_cvt_pk_bf16_f32 v22, v11, v12
  v_lshlrev_b32 v11, 16, v23
  v_and_b32 v12, 0xffff0000, v23
  v_fma_f32 v11, v11, v9, v10
  v_fma_f32 v12, v12, v9, v10
  v_cvt_pk_bf16_f32 v23, v11, v12
  v_lshrrev_b32 v6, 2, v0
  s_mul_i32 s47, s41, 12288
  s_add_u32 s47, s47, 114688
  v_bfe_u32 v11, v6, 1, 1
  v_bfe_u32 v12, v6, 3, 1
  v_lshl_or_b32 v11, v12, 1, v11
  v_lshlrev_b32 v11, 5, v11
  v_lshl_add_u32 v11, v4, 3, v11
  v_lshl_add_u32 v11, v6, 7, v11
  v_add_u32 v11, s47, v11
  v_xor_b32 v12, 32, v11
  v_xor_b32 v13, 64, v11
  v_xor_b32 v14, 96, v11
  ds_write_b64 v11, v[16:17]
  ds_write_b64 v12, v[18:19]
  ds_write_b64 v13, v[20:21]
  ds_write_b64 v14, v[22:23]
  s_waitcnt vmcnt(13) lgkmcnt(0)
  s_barrier
  s_and_b32 s47, s41, 1
  s_lshl_b32 s47, s47, 1
  v_lshrrev_b32 v6, 1, v3
  v_and_b32 v7, 1, v2
  v_lshl_or_b32 v6, v7, 1, v6
  v_xor_b32 v6, s47, v6
  v_lshlrev_b32 v6, 5, v6
  v_lshl_add_u32 v6, v4, 3, v6
  v_and_b32 v7, 1, v2
  v_lshl_add_u32 v7, v7, 3, v3
  v_lshl_add_u32 v6, v7, 7, v6
  v_lshrrev_b32 v7, 1, v2
  v_mul_u32_u24 v7, 12288, v7
  v_add_u32 v6, v7, v6
  v_add_u32 v6, 114688, v6
  v_xor_b32 v7, 32, v6
  ds_read_b64_tr_b16 v[96:97], v6 offset:0
  ds_read_b64_tr_b16 v[98:99], v6 offset:512
  ds_read_b64_tr_b16 v[100:101], v6 offset:24576
  ds_read_b64_tr_b16 v[102:103], v6 offset:25088
  ds_read_b64_tr_b16 v[104:105], v7 offset:0
  ds_read_b64_tr_b16 v[106:107], v7 offset:512
  ds_read_b64_tr_b16 v[108:109], v7 offset:24576
  ds_read_b64_tr_b16 v[110:111], v7 offset:25088
  s_lshr_b32 s47, s41, 1
  s_lshl_b32 s47, s47, 20
  s_lshl_b32 s48, s38, 10
  s_add_u32 s47, s47, s48
  s_lshl_b32 s48, s39, 7
  s_add_u32 s47, s47, s48
  s_and_b32 s48, s41, 1
  s_lshl_b32 s48, s48, 6
  s_add_u32 s47, s47, s48
  s_add_u32 s47, s47, 0
  v_lshlrev_b32 v8, 15, v1
  v_lshl_add_u32 v8, v2, 4, v8
  s_add_u32 s48, s47, 0x80000
  s_waitcnt lgkmcnt(0)
  v_mfma_f32_16x16x32_bf16 v[112:115], v[96:99], v[128:131], 0
  v_mfma_f32_16x16x32_bf16 v[112:115], v[100:103], v[132:135], v[112:115]
  v_mfma_f32_16x16x32_bf16 v[116:119], v[104:107], v[128:131], 0
  v_mfma_f32_16x16x32_bf16 v[116:119], v[108:111], v[132:135], v[116:119]
  v_mfma_f32_16x16x32_bf16 v[120:123], v[96:99], v[136:139], 0
  v_mfma_f32_16x16x32_bf16 v[120:123], v[100:103], v[140:143], v[120:123]
  v_mfma_f32_16x16x32_bf16 v[124:127], v[104:107], v[136:139], 0
  v_mfma_f32_16x16x32_bf16 v[124:127], v[108:111], v[140:143], v[124:127]
  s_nop 1
  v_cvt_pk_bf16_f32 v112, v112, v113
  v_cvt_pk_bf16_f32 v113, v114, v115
  v_cvt_pk_bf16_f32 v114, v116, v117
  v_cvt_pk_bf16_f32 v115, v118, v119
  buffer_store_dwordx4 v[112:115], v8, s[28:31], s47 offen sc1
  v_cvt_pk_bf16_f32 v120, v120, v121
  v_cvt_pk_bf16_f32 v121, v122, v123
  v_cvt_pk_bf16_f32 v122, v124, v125
  v_cvt_pk_bf16_f32 v123, v126, v127
  buffer_store_dwordx4 v[120:123], v8, s[28:31], s48 offen sc1
  s_mul_i32 s50, s40, 224
  s_mul_i32 s51, s41, 458752
  s_add_u32 s50, s50, s51
  s_mul_i32 s51, s41, 28672
  s_add_u32 s51, s51, 0
  s_lshr_b32 s52, s37, 4
  s_lshl_b32 s52, s52, 1
  s_add_u32 s52, s52, s36
  s_add_u32 s52, s52, 1
  s_and_b32 s52, s52, 3
  s_mul_i32 s53, s52, 114688
  s_add_u32 s53, s53, s50
  s_mul_i32 s52, s52, 7168
  s_add_u32 s52, s52, s51
  s_add_u32 m0, s52, 1024
  s_nop 0
  buffer_load_dwordx4 v89, s[16:19], s53 offen lds
  s_add_u32 m0, s52, 2048
  s_nop 0
  buffer_load_dwordx4 v90, s[16:19], s53 offen lds
  s_add_u32 m0, s52, 3072
  s_nop 0
  buffer_load_dwordx4 v91, s[16:19], s53 offen lds
  s_add_u32 m0, s52, 4096
  s_nop 0
  buffer_load_dwordx4 v92, s[16:19], s53 offen lds
  s_waitcnt vmcnt(4)
  v_readfirstlane_b32 s42, v95
  s_cmp_lg_u32 s42, 0
  s_cbranch_scc1 ND_2
  s_mov_b32 s58, 0x40000
  v_mov_b32 v5, 0
NP_3:
  buffer_load_dword v6, v5, s[32:35], 0 offen sc1
  s_waitcnt vmcnt(0)
  v_readfirstlane_b32 s42, v6
  s_cmp_lg_u32 s42, 0
  s_cbranch_scc1 ND_4
  s_sub_u32 s58, s58, 1
  s_cmp_lg_u32 s58, 0
  s_cbranch_scc1 NP_3
ND_4:
ND_2:
  s_lshl_b32 s54, s2, 6
  s_waitcnt vmcnt(4)
  s_barrier
  s_cmp_lg_u32 s41, 0
  s_cbranch_scc1 SIG_5
  s_add_u32 s57, s42, 0
  s_add_u32 s57, s57, s59
  v_mov_b32 v5, s57
  v_mov_b32 v6, 19922944
  v_add_u32 v6, s54, v6
  s_mov_b64 exec, 1
  buffer_store_dword v5, v6, s[28:31], 0 offen sc1
  s_mov_b64 exec, -1
SIG_5:
  s_lshl_b32 s47, s2, 2
  s_add_u32 s47, s47, s41
  s_mul_i32 s47, s47, 1792
  v_min_u32 v246, 13, v0
  v_lshlrev_b32 v246, 7, v246
  buffer_load_dword v248, v246, s[20:23], s47 offen
  s_mul_i32 s50, s40, 224
  s_mul_i32 s51, s41, 458752
  s_add_u32 s50, s50, s51
  s_mul_i32 s51, s41, 28672
  s_add_u32 s51, s51, 0
  s_lshr_b32 s52, s37, 4
  s_lshl_b32 s52, s52, 1
  s_add_u32 s52, s52, s36
  s_add_u32 s52, s52, 1
  s_and_b32 s52, s52, 3
  s_mul_i32 s53, s52, 114688
  s_add_u32 s53, s53, s50
  s_mul_i32 s52, s52, 7168
  s_add_u32 s52, s52, s51
  s_add_u32 m0, s52, 5120
  s_nop 0
  buffer_load_dwordx4 v93, s[16:19], s53 offen lds
  s_add_u32 m0, s52, 6144
  s_nop 0
  buffer_load_dwordx4 v94, s[16:19], s53 offen lds
  s_lshr_b32 s52, s37, 4
  s_lshl_b32 s52, s52, 1
  s_add_u32 s52, s52, s36
  s_add_u32 s52, s52, 2
  s_and_b32 s52, s52, 3
  s_mul_i32 s53, s52, 114688
  s_add_u32 s53, s53, s50
  s_mul_i32 s52, s52, 7168
  s_add_u32 s52, s52, s51
  s_add_u32 m0, s52, 0
  s_nop 0
  buffer_load_dwordx4 v88, s[16:19], s53 offen lds
  s_add_u32 m0, s52, 1024
  s_nop 0
  buffer_load_dwordx4 v89, s[16:19], s53 offen lds
  s_add_u32 m0, s52, 2048
  s_nop 0
  buffer_load_dwordx4 v90, s[16:19], s53 offen lds
  s_add_u32 m0, s52, 3072
  s_nop 0
  buffer_load_dwordx4 v91, s[16:19], s53 offen lds
  s_add_u32 m0, s52, 4096
  s_nop 0
  buffer_load_dwordx4 v92, s[16:19], s53 offen lds
  s_add_u32 m0, s52, 5120
  s_nop 0
  buffer_load_dwordx4 v93, s[16:19], s53 offen lds
  s_add_u32 m0, s52, 6144
  s_nop 0
  buffer_load_dwordx4 v94, s[16:19], s53 offen lds
  s_lshr_b32 s52, s37, 4
  s_lshl_b32 s52, s52, 1
  s_add_u32 s52, s52, s36
  s_add_u32 s52, s52, 3
  s_and_b32 s52, s52, 3
  s_mul_i32 s53, s52, 114688
  s_add_u32 s53, s53, s50
  s_mul_i32 s52, s52, 7168
  s_add_u32 s52, s52, s51
  s_add_u32 m0, s52, 0
  s_nop 0
  buffer_load_dwordx4 v88, s[16:19], s53 offen lds
  s_add_u32 m0, s52, 1024
  s_nop 0
  buffer_load_dwordx4 v89, s[16:19], s53 offen lds
  s_add_u32 m0, s52, 2048
  s_nop 0
  buffer_load_dwordx4 v90, s[16:19], s53 offen lds
  s_add_u32 m0, s52, 3072
  s_nop 0
  buffer_load_dwordx4 v91, s[16:19], s53 offen lds
  s_add_u32 m0, s52, 4096
  s_nop 0
  buffer_load_dwordx4 v92, s[16:19], s53 offen lds
  s_add_u32 m0, s52, 5120
  s_nop 0
  buffer_load_dwordx4 v93, s[16:19], s53 offen lds
  s_add_u32 m0, s52, 6144
  s_nop 0
  buffer_load_dwordx4 v94, s[16:19], s53 offen lds
  s_cmp_eq_u32 s38, 0
  s_cselect_b32 s50, 0, -1
  s_cmp_ge_u32 s39, 4
  s_cselect_b32 s51, 0x80008000, 0
  s_xor_b32 s52, s51, 0x80008000
  v_and_b32 v5, 1, v1
  v_cmp_eq_u32 vcc, 1, v5
  s_nop 1
  v_cndmask_b32 v6, v80, v84, vcc
  v_xor_b32 v7, s52, v84
  v_xor_b32 v8, s51, v80
  v_cndmask_b32 v7, v7, v8, vcc
  v_and_b32 v7, s50, v7
  v_accvgpr_write_b32 a224, v6
  v_accvgpr_write_b32 a228, v7
  v_cndmask_b32 v6, v81, v85, vcc
  v_xor_b32 v7, s52, v85
  v_xor_b32 v8, s51, v81
  v_cndmask_b32 v7, v7, v8, vcc
  v_and_b32 v7, s50, v7
  v_accvgpr_write_b32 a225, v6
  v_accvgpr_write_b32 a229, v7
  v_cndmask_b32 v6, v82, v86, vcc
  v_xor_b32 v7, s52, v86
  v_xor_b32 v8, s51, v82
  v_cndmask_b32 v7, v7, v8, vcc
  v_and_b32 v7, s50, v7
  v_accvgpr_write_b32 a226, v6
  v_accvgpr_write_b32 a230, v7
  v_cndmask_b32 v6, v83, v87, vcc
  v_xor_b32 v7, s52, v87
  v_xor_b32 v8, s51, v83
  v_cndmask_b32 v7, v7, v8, vcc
  v_and_b32 v7, s50, v7
  v_accvgpr_write_b32 a227, v6
  v_accvgpr_write_b32 a231, v7
  v_lshlrev_b32 v5, 4, v0
  v_add_u32 v5, 8192, v5
  v_add_u32 v6, 4096, v5
  global_load_dwordx4 v[8:11], v5, s[44:45] offset:0
  global_load_dwordx4 v[12:15], v5, s[44:45] offset:1024
  global_load_dwordx4 v[16:19], v5, s[44:45] offset:2048
  global_load_dwordx4 v[20:23], v5, s[44:45] offset:3072
  global_load_dwordx4 v[24:27], v6, s[44:45] offset:0
  global_load_dwordx4 v[28:31], v6, s[44:45] offset:1024
  global_load_dwordx4 v[32:35], v6, s[44:45] offset:2048
  global_load_dwordx4 v[36:39], v6, s[44:45] offset:3072
  v_add_u32 v6, 4096, v6
  global_load_dwordx4 v[40:43], v6, s[44:45] offset:0
  global_load_dwordx4 v[44:47], v6, s[44:45] offset:1024
  s_lshl_b32 s47, s41, 8
  v_lshlrev_b32 v48, 10, v2
  v_lshl_add_u32 v48, v1, 4, v48
  v_add_u32 v48, s47, v48
  s_lshl_b32 s47, s41, 13
  s_add_u32 s47, s47, 114688
  v_lshrrev_b32 v49, 1, v1
  v_xor_b32 v49, v49, v2
  v_lshlrev_b32 v49, 5, v49
  v_and_b32 v50, 1, v1
  v_lshl_add_u32 v49, v50, 4, v49
  v_lshl_add_u32 v49, v2, 8, v49
  v_add_u32 v49, s47, v49
  v_xor_b32 v50, 128, v49
  v_lshrrev_b32 v96, 1, v1
  v_xor_b32 v96, v96, v2
  v_lshlrev_b32 v96, 5, v96
  v_and_b32 v97, 1, v1
  v_lshl_add_u32 v96, v97, 4, v96
  v_lshl_add_u32 v96, v2, 10, v96
  s_lshl_b32 s48, s41, 8
  v_add_u32 v96, s48, v96
  v_xor_b32 v97, 128, v96
  s_lshl_b32 s48, s41, 12
  s_sub_u32 s48, 32768, s48
  v_mov_b32 v98, s48
  v_cmp_gt_u32 vcc, 2, v2
  s_nop 1
  v_cndmask_b32 v98, 0, v98, vcc
  v_and_b32 v51, 1, v2
  v_lshl_or_b32 v51, v51, 2, v3
  v_lshlrev_b32 v51, 5, v51
  v_lshl_add_u32 v51, v4, 3, v51
  v_lshl_add_u32 v52, v2, 3, v3
  v_lshl_add_u32 v51, v52, 8, v51
  v_add_u32 v51, s47, v51
  v_xor_b32 v52, 32, v51
  v_xor_b32 v53, 64, v51
  v_xor_b32 v54, 96, v51
  v_xor_b32 v55, 128, v51
  v_xor_b32 v56, 160, v51
  v_xor_b32 v57, 192, v51
  v_xor_b32 v58, 224, v51
  s_lshl_b32 s47, s41, 12
  s_lshr_b32 s48, s41, 1
  s_lshl_b32 s48, s48, 5
  s_add_u32 s47, s47, s48
  v_lshlrev_b32 v59, 3, v2
  v_add_u32 v59, s47, v59
  v_lshlrev_b32 v60, 3, v1
  v_xor_b32 v59, v59, v60
  v_lshl_add_u32 v59, v1, 8, v59
  v_add_u32 v59, 147456, v59
  v_xor_b32 v60, 32, v59
  v_xor_b32 v61, 64, v59
  v_xor_b32 v62, 96, v59
  s_lshl_b32 s47, s41, 2
  v_lshrrev_b32 v63, 1, v2
  v_add_u32 v63, s47, v63
  v_and_b32 v64, 1, v2
  v_mul_u32_u24 v64, 8224, v64
  v_lshl_add_u32 v64, v3, 6, v64
  v_lshl_add_u32 v64, v4, 3, v64
  v_lshlrev_b32 v65, 3, v63
  v_xor_b32 v64, v64, v65
  v_lshl_add_u32 v63, v63, 8, v64
  v_add_u32 v63, 147456, v63
  v_xor_b32 v64, 32, v63
  v_xor_b32 v65, 16, v63
  v_add_u32 v65, 512, v65
  v_xor_b32 v66, 32, v65
  v_lshlrev_b32 v67, 5, v1
  v_lshl_add_u32 v67, v2, 3, v67
  s_lshl_b32 s47, s38, 16
  s_lshl_b32 s48, s39, 13
  s_add_u32 s47, s47, s48
  s_lshl_b32 s48, s41, 11
  s_add_u32 s47, s47, s48
  v_add_u32 v68, s47, v67
  s_lshr_b32 s47, s39, 2
  s_and_b32 s48, s39, 3
  s_lshl_b32 s48, s48, 4
  s_add_u32 s47, s47, s48
  s_lshl_b32 s48, s41, 2
  s_add_u32 s47, s47, s48
  s_lshl_b32 s47, s47, 5
  s_add_u32 s47, s47, s38
  s_lshl_b32 s47, s47, 10
  v_add_u32 v69, s47, v67
  v_add_u32 v70, 0x10000, v69
  s_lshl_b32 s47, s41, 1
  v_lshrrev_b32 v71, 1, v1
  v_xor_b32 v72, s47, v71
  v_lshlrev_b32 v72, 4, v72
  v_lshl_add_u32 v72, v71, 9, v72
  v_lshl_add_u32 v72, v2, 7, v72
  v_and_b32 v71, 1, v1
  v_lshl_add_u32 v71, v71, 3, v72
  v_add_u32 v71, 123136, v71
  v_xor_b32 v72, 16, v71
  s_lshl_b32 s47, s41, 2
  v_lshrrev_b32 v73, 5, v0
  v_add_u32 v73, s47, v73
  v_and_b32 v74, 7, v0
  v_xor_b32 v75, v74, v73
  v_and_b32 v75, 7, v75
  v_lshlrev_b32 v75, 4, v75
  v_lshl_add_u32 v75, v73, 9, v75
  v_bfe_u32 v84, v0, 3, 2
  v_lshl_add_u32 v75, v84, 7, v75
  v_lshlrev_b32 v73, 10, v73
  v_lshl_add_u32 v73, v84, 8, v73
  v_lshl_add_u32 v73, v74, 4, v73
  s_lshl_b32 s47, s38, 16
  s_lshr_b32 s48, s39, 1
  s_lshl_b32 s48, s48, 14
  s_add_u32 s47, s47, s48
  s_and_b32 s48, s39, 1
  s_lshl_b32 s48, s48, 7
  s_add_u32 s47, s47, s48
  v_add_u32 v74, s47, v73
  v_add_u32 v73, 123136, v75
  v_xor_b32 v85, 32, v73
  v_lshrrev_b32 v222, 1, v0
  v_and_b32 v223, 3, v222
  v_lshrrev_b32 v222, 2, v222
  v_lshl_add_u32 v222, v223, 6, v222
  v_and_b32 v223, 1, v0
  v_lshl_add_u32 v222, v223, 3, v222
  s_lshl_b32 s47, s41, 4
  v_add_u32 v222, s47, v222
  v_lshlrev_b32 v222, 6, v222
  v_add_u32 v222, 19922944, v222
  s_mov_b32 s56, s42
  s_mov_b32 s58, 0x40000
POLL_10:
  buffer_load_dword v223, v222, s[28:31], 0 offen sc1
  s_waitcnt vmcnt(0)
  v_and_b32 v224, 0xfffffff0, v223
  v_cmp_ne_u32 vcc, s56, v224
  s_nop 4
  s_cbranch_vccz PD_11
  s_sub_u32 s58, s58, 1
  s_cmp_lg_u32 s58, 0
  s_cbranch_scc1 POLL_10
PD_11:
  v_and_b32 v223, 15, v223
  v_cmp_ne_u32 vcc, s59, v223
  s_lshl_b32 s47, s36, 3
  s_lshl_b64 s[48:49], 0xff, s47
  s_and_b64 s[48:49], s[48:49], vcc
  s_cmp_lg_u64 s[48:49], 0
  s_cselect_b32 s53, 1, 0
  s_sub_u32 s47, 32, s38
  s_cmp_lt_u32 s39, 4
  s_cselect_b32 s47, s38, s47
  s_add_u32 s48, s47, 32
  s_cmp_eq_u32 s38, 0
  s_cselect_b32 s48, 0, s48
  s_lshl_b32 s47, s47, 15
  s_lshl_b32 s48, s48, 15
  s_add_u32 s47, s47, 0
  s_add_u32 s48, s48, 0
  s_mov_b32 s49, 4194304
  s_lshl_b32 s50, s41, 13
  s_add_u32 s50, s50, 114688
  s_lshl_b32 s51, s41, 12
  s_add_u32 s51, s51, 147456
  s_add_u32 m0, s50, 0
  s_nop 0
  buffer_load_dwordx4 v96, s[28:31], s47 offen sc1 lds
  s_add_u32 m0, s50, 1024
  s_add_u32 s47, s47, 4096
  buffer_load_dwordx4 v96, s[28:31], s47 offen sc1 lds
  s_add_u32 m0, s50, 2048
  s_add_u32 s47, s47, 4096
  buffer_load_dwordx4 v97, s[28:31], s47 offen sc1 lds
  s_add_u32 m0, s50, 3072
  s_add_u32 s47, s47, 4096
  buffer_load_dwordx4 v97, s[28:31], s47 offen sc1 lds
  s_add_u32 m0, s50, 4096
  s_add_u32 s47, s47, 4096
  buffer_load_dwordx4 v96, s[28:31], s47 offen sc1 lds
  s_add_u32 m0, s50, 5120
  s_add_u32 s47, s47, 4096
  buffer_load_dwordx4 v96, s[28:31], s47 offen sc1 lds
  s_add_u32 m0, s50, 6144
  s_add_u32 s47, s47, 4096
  buffer_load_dwordx4 v97, s[28:31], s47 offen sc1 lds
  s_add_u32 m0, s50, 7168
  s_add_u32 s47, s47, 4096
  buffer_load_dwordx4 v97, s[28:31], s47 offen sc1 lds
  s_add_u32 s48, s48, 16384
  buffer_load_dwordx4 v[144:147], v48, s[28:31], s48 offen sc1
  s_add_u32 s48, s48, 4096
  buffer_load_dwordx4 v[148:151], v48, s[28:31], s48 offen sc1
  s_add_u32 s48, s48, 4096
  buffer_load_dwordx4 v[152:155], v48, s[28:31], s48 offen sc1
  s_add_u32 s48, s48, 4096
  buffer_load_dwordx4 v[156:159], v48, s[28:31], s48 offen sc1
  s_add_u32 m0, s51, 0
  s_sub_u32 s48, s48, 28672
  buffer_load_dwordx4 v96, s[28:31], s48 offen sc1 lds
  s_add_u32 m0, s51, 1024
  s_add_u32 s48, s48, 4096
  buffer_load_dwordx4 v96, s[28:31], s48 offen sc1 lds
  s_add_u32 m0, s51, 2048
  s_add_u32 s48, s48, 4096
  buffer_load_dwordx4 v97, s[28:31], s48 offen sc1 lds
  s_add_u32 m0, s51, 3072
  s_add_u32 s48, s48, 4096
  buffer_load_dwordx4 v97, s[28:31], s48 offen sc1 lds
  buffer_load_dwordx2 v[76:77], v69, s[4:7], 0 offen offset:0
  buffer_load_dwordx2 v[78:79], v69, s[4:7], 0 offen offset:512
  buffer_load_dwordx2 v[80:81], v70, s[4:7], 0 offen offset:0
  buffer_load_dwordx2 v[82:83], v70, s[4:7], 0 offen offset:512
  s_mul_i32 s54, s40, 224
  s_mul_i32 s55, s41, 458752
  s_add_u32 s54, s54, s55
  v_lshrrev_b32 v86, 3, v0
  v_lshlrev_b32 v86, 10, v86
  v_and_b32 v87, 7, v0
  v_lshl_add_u32 v86, v87, 4, v86
  s_mul_i32 s55, s41, 458752
  s_lshl_b32 s49, s39, 7
  s_add_u32 s55, s55, s49
  s_add_u32 s55, s55, 0
  s_waitcnt vmcnt(12)
  ds_read_b64_tr_b16 v[160:161], v51 offset:0
  ds_read_b64_tr_b16 v[162:163], v51 offset:1024
  ds_read_b64_tr_b16 v[164:165], v52 offset:0
  ds_read_b64_tr_b16 v[166:167], v52 offset:1024
  ds_read_b64_tr_b16 v[168:169], v53 offset:0
  ds_read_b64_tr_b16 v[170:171], v53 offset:1024
  ds_read_b64_tr_b16 v[172:173], v54 offset:0
  ds_read_b64_tr_b16 v[174:175], v54 offset:1024
  ds_read_b64_tr_b16 v[176:177], v55 offset:0
  ds_read_b64_tr_b16 v[178:179], v55 offset:1024
  ds_read_b64_tr_b16 v[180:181], v56 offset:0
  ds_read_b64_tr_b16 v[182:183], v56 offset:1024
  buffer_load_dwordx4 a[0:3], v86, s[20:23], s55 offen
  v_add_u32 v86, 8192, v86
  ds_read_b64_tr_b16 v[184:185], v57 offset:0
  ds_read_b64_tr_b16 v[186:187], v57 offset:1024
  ds_read_b64_tr_b16 v[188:189], v58 offset:0
  ds_read_b64_tr_b16 v[190:191], v58 offset:1024
  s_waitcnt lgkmcnt(14)
  v_mfma_f32_16x16x32_bf16 v[192:195], v[160:163], a[224:227], 0
  s_waitcnt lgkmcnt(12)
  v_mfma_f32_16x16x32_bf16 v[196:199], v[164:167], a[224:227], 0
  s_waitcnt lgkmcnt(10)
  v_mfma_f32_16x16x32_bf16 v[200:203], v[168:171], a[224:227], 0
  s_waitcnt lgkmcnt(8)
  v_mfma_f32_16x16x32_bf16 v[204:207], v[172:175], a[224:227], 0
  buffer_load_dwordx4 a[4:7], v86, s[20:23], s55 offen
  v_add_u32 v86, 8192, v86
  s_waitcnt lgkmcnt(6)
  v_mfma_f32_16x16x32_bf16 v[208:211], v[176:179], a[224:227], 0
  s_waitcnt lgkmcnt(4)
  v_mfma_f32_16x16x32_bf16 v[212:215], v[180:183], a[224:227], 0
  s_waitcnt lgkmcnt(2)
  v_mfma_f32_16x16x32_bf16 v[216:219], v[184:187], a[224:227], 0
  s_waitcnt lgkmcnt(0)
  v_mfma_f32_16x16x32_bf16 v[220:223], v[188:191], a[224:227], 0
  s_waitcnt vmcnt(10)
  ds_write_b128 v49, v[144:147] offset:4096
  ds_write_b128 v49, v[148:151] offset:5120
  ds_write_b128 v50, v[152:155] offset:6144
  buffer_load_dwordx4 a[8:11], v86, s[20:23], s55 offen
  v_add_u32 v86, 8192, v86
  ds_write_b128 v50, v[156:159] offset:7168
  v_add_u32 v51, v98, v51
  v_add_u32 v52, v98, v52
  v_add_u32 v53, v98, v53
  v_add_u32 v54, v98, v54
  v_add_u32 v55, v98, v55
  v_add_u32 v56, v98, v56
  v_add_u32 v57, v98, v57
  v_add_u32 v58, v98, v58
  s_waitcnt vmcnt(7)
  ds_read_b64_tr_b16 v[160:161], v51 offset:0
  ds_read_b64_tr_b16 v[162:163], v51 offset:1024
  buffer_load_dwordx4 a[12:15], v86, s[20:23], s55 offen
  v_add_u32 v86, 8192, v86
  ds_read_b64_tr_b16 v[164:165], v52 offset:0
  ds_read_b64_tr_b16 v[166:167], v52 offset:1024
  ds_read_b64_tr_b16 v[168:169], v53 offset:0
  ds_read_b64_tr_b16 v[170:171], v53 offset:1024
  ds_read_b64_tr_b16 v[172:173], v54 offset:0
  ds_read_b64_tr_b16 v[174:175], v54 offset:1024
  ds_read_b64_tr_b16 v[176:177], v55 offset:0
  ds_read_b64_tr_b16 v[178:179], v55 offset:1024
  ds_read_b64_tr_b16 v[180:181], v56 offset:0
  ds_read_b64_tr_b16 v[182:183], v56 offset:1024
  ds_read_b64_tr_b16 v[184:185], v57 offset:0
  ds_read_b64_tr_b16 v[186:187], v57 offset:1024
  buffer_load_dwordx4 a[16:19], v86, s[20:23], s55 offen
  v_add_u32 v86, 8192, v86
  ds_read_b64_tr_b16 v[188:189], v58 offset:0
  ds_read_b64_tr_b16 v[190:191], v58 offset:1024
  s_waitcnt lgkmcnt(14)
  v_mfma_f32_16x16x32_bf16 v[192:195], v[160:163], a[228:231], v[192:195]
  s_waitcnt lgkmcnt(12)
  v_mfma_f32_16x16x32_bf16 v[196:199], v[164:167], a[228:231], v[196:199]
  s_waitcnt lgkmcnt(10)
  v_mfma_f32_16x16x32_bf16 v[200:203], v[168:171], a[228:231], v[200:203]
  s_waitcnt lgkmcnt(8)
  v_mfma_f32_16x16x32_bf16 v[204:207], v[172:175], a[228:231], v[204:207]
  s_waitcnt lgkmcnt(6)
  v_mfma_f32_16x16x32_bf16 v[208:211], v[176:179], a[228:231], v[208:211]
  buffer_load_dwordx4 a[20:23], v86, s[20:23], s55 offen
  v_add_u32 v86, 8192, v86
  s_waitcnt lgkmcnt(4)
  v_mfma_f32_16x16x32_bf16 v[212:215], v[180:183], a[228:231], v[212:215]
  s_waitcnt lgkmcnt(2)
  v_mfma_f32_16x16x32_bf16 v[216:219], v[184:187], a[228:231], v[216:219]
  s_waitcnt lgkmcnt(0)
  v_mfma_f32_16x16x32_bf16 v[220:223], v[188:191], a[228:231], v[220:223]
  v_cvt_pk_bf16_f32 v192, v192, v193
  v_cvt_pk_bf16_f32 v193, v194, v195
  ds_write_b64 v59, v[192:193] offset:0
  v_cvt_pk_bf16_f32 v196, v196, v197
  v_cvt_pk_bf16_f32 v197, v198, v199
  ds_write_b64 v60, v[196:197] offset:0
  buffer_load_dwordx4 a[24:27], v86, s[20:23], s55 offen
  v_add_u32 v86, 8192, v86
  v_cvt_pk_bf16_f32 v200, v200, v201
  v_cvt_pk_bf16_f32 v201, v202, v203
  ds_write_b64 v61, v[200:201] offset:0
  v_cvt_pk_bf16_f32 v204, v204, v205
  v_cvt_pk_bf16_f32 v205, v206, v207
  ds_write_b64 v62, v[204:205] offset:0
  v_cvt_pk_bf16_f32 v208, v208, v209
  v_cvt_pk_bf16_f32 v209, v210, v211
  ds_write_b64 v59, v[208:209] offset:128
  v_cvt_pk_bf16_f32 v212, v212, v213
  v_cvt_pk_bf16_f32 v213, v214, v215
  ds_write_b64 v60, v[212:213] offset:128
  buffer_load_dwordx4 a[28:31], v86, s[20:23], s55 offen
  v_add_u32 v86, 8192, v86
  v_cvt_pk_bf16_f32 v216, v216, v217
  v_cvt_pk_bf16_f32 v217, v218, v219
  ds_write_b64 v61, v[216:217] offset:128
  v_cvt_pk_bf16_f32 v220, v220, v221
  v_cvt_pk_bf16_f32 v221, v222, v223
  ds_write_b64 v62, v[220:221] offset:128
  s_lshl_b32 s47, s41, 13
  s_add_u32 s47, s47, 114688
  s_lshr_b32 s48, s41, 1
  s_mul_i32 s48, s48, 8188
  s_add_u32 s47, s47, s48
  v_mov_b32 v96, s47
  buffer_load_dwordx4 a[32:35], v86, s[20:23], s55 offen
  v_add_u32 v86, 8192, v86
  v_mov_b32 v97, s53
  ds_write_b32 v96, v97
  s_waitcnt lgkmcnt(0)
  s_barrier
  v_lshlrev_b32 v96, 13, v4
  v_lshrrev_b32 v97, 1, v4
  v_mul_u32_u24 v97, 8188, v97
  v_add_u32 v96, v96, v97
  v_add_u32 v96, 114688, v96
  ds_read_b32 v97, v96
  s_waitcnt lgkmcnt(0)
  v_cmp_ne_u32 vcc, 0, v97
  buffer_load_dwordx4 a[36:39], v86, s[20:23], s55 offen
  v_add_u32 v86, 8192, v86
  s_nop 4
  s_cmp_eq_u64 vcc, 0
  s_cselect_b32 s43, 1, 0
  ds_read_b64_tr_b16 v[96:97], v63 offset:0
  ds_read_b64_tr_b16 v[98:99], v63 offset:4096
  ds_read_b64_tr_b16 v[100:101], v64 offset:0
  ds_read_b64_tr_b16 v[102:103], v64 offset:4096
  ds_read_b64_tr_b16 v[104:105], v65 offset:0
  ds_read_b64_tr_b16 v[106:107], v65 offset:4096
  ds_read_b64_tr_b16 v[108:109], v66 offset:0
  ds_read_b64_tr_b16 v[110:111], v66 offset:4096
  s_waitcnt lgkmcnt(4)
  buffer_load_dwordx4 a[40:43], v86, s[20:23], s55 offen
  v_add_u32 v86, 8192, v86
  v_mfma_f32_16x16x32_bf16 v[112:115], v[96:99], v[8:11], 0
  v_mfma_f32_16x16x32_bf16 v[116:119], v[96:99], v[12:15], 0
  v_mfma_f32_16x16x32_bf16 v[120:123], v[100:103], v[8:11], 0
  v_mfma_f32_16x16x32_bf16 v[124:127], v[100:103], v[12:15], 0
  s_waitcnt lgkmcnt(0)
  v_mfma_f32_16x16x32_bf16 v[128:131], v[104:107], v[8:11], 0
  v_mfma_f32_16x16x32_bf16 v[132:135], v[104:107], v[12:15], 0
  v_mfma_f32_16x16x32_bf16 v[136:139], v[108:111], v[8:11], 0
  v_mfma_f32_16x16x32_bf16 v[140:143], v[108:111], v[12:15], 0
  v_pk_mul_f32 v[160:161], v[112:113], v[32:33]
  v_pk_mul_f32 v[164:165], v[116:117], v[32:33]
  v_pk_fma_f32 v[160:161], v[116:117], v[40:41], v[160:161]
  buffer_load_dwordx4 a[44:47], v86, s[20:23], s55 offen
  v_add_u32 v86, 8192, v86
  v_pk_fma_f32 v[164:165], v[112:113], v[40:41], v[164:165] neg_lo:[1,0,0] neg_hi:[1,0,0]
  v_pk_mul_f32 v[162:163], v[114:115], v[34:35]
  v_pk_mul_f32 v[166:167], v[118:119], v[34:35]
  v_pk_fma_f32 v[162:163], v[118:119], v[42:43], v[162:163]
  v_pk_fma_f32 v[166:167], v[114:115], v[42:43], v[166:167] neg_lo:[1,0,0] neg_hi:[1,0,0]
  v_cvt_pk_bf16_f32 v144, v160, v161
  v_cvt_pk_bf16_f32 v145, v162, v163
  v_cvt_pk_bf16_f32 v148, v164, v165
  v_cvt_pk_bf16_f32 v149, v166, v167
  v_pk_mul_f32 v[168:169], v[120:121], v[36:37]
  v_pk_mul_f32 v[172:173], v[124:125], v[36:37]
  v_pk_fma_f32 v[168:169], v[124:125], v[44:45], v[168:169]
  buffer_load_dwordx4 a[48:51], v86, s[20:23], s55 offen
  v_add_u32 v86, 8192, v86
  v_pk_fma_f32 v[172:173], v[120:121], v[44:45], v[172:173] neg_lo:[1,0,0] neg_hi:[1,0,0]
  v_pk_mul_f32 v[170:171], v[122:123], v[38:39]
  v_pk_mul_f32 v[174:175], v[126:127], v[38:39]
  v_pk_fma_f32 v[170:171], v[126:127], v[46:47], v[170:171]
  v_pk_fma_f32 v[174:175], v[122:123], v[46:47], v[174:175] neg_lo:[1,0,0] neg_hi:[1,0,0]
  v_cvt_pk_bf16_f32 v146, v168, v169
  v_cvt_pk_bf16_f32 v147, v170, v171
  v_cvt_pk_bf16_f32 v150, v172, v173
  v_cvt_pk_bf16_f32 v151, v174, v175
  v_pk_mul_f32 v[160:161], v[128:129], v[32:33]
  v_pk_mul_f32 v[164:165], v[132:133], v[32:33]
  v_pk_fma_f32 v[160:161], v[132:133], v[40:41], v[160:161]
  buffer_load_dwordx4 a[52:55], v86, s[20:23], s55 offen
  v_add_u32 v86, 8192, v86
  v_pk_fma_f32 v[164:165], v[128:129], v[40:41], v[164:165] neg_lo:[1,0,0] neg_hi:[1,0,0]
  v_pk_mul_f32 v[162:163], v[130:131], v[34:35]
  v_pk_mul_f32 v[166:167], v[134:135], v[34:35]
  v_pk_fma_f32 v[162:163], v[134:135], v[42:43], v[162:163]
  v_pk_fma_f32 v[166:167], v[130:131], v[42:43], v[166:167] neg_lo:[1,0,0] neg_hi:[1,0,0]
  v_cvt_pk_bf16_f32 v152, v160, v161
  v_cvt_pk_bf16_f32 v153, v162, v163
  v_cvt_pk_bf16_f32 v156, v164, v165
  v_cvt_pk_bf16_f32 v157, v166, v167
  v_pk_mul_f32 v[168:169], v[136:137], v[36:37]
  v_pk_mul_f32 v[172:173], v[140:141], v[36:37]
  v_pk_fma_f32 v[168:169], v[140:141], v[44:45], v[168:169]
  buffer_load_dwordx4 a[56:59], v86, s[20:23], s55 offen
  v_add_u32 v86, 8192, v86
  v_pk_fma_f32 v[172:173], v[136:137], v[44:45], v[172:173] neg_lo:[1,0,0] neg_hi:[1,0,0]
  v_pk_mul_f32 v[170:171], v[138:139], v[38:39]
  v_pk_mul_f32 v[174:175], v[142:143], v[38:39]
  v_pk_fma_f32 v[170:171], v[142:143], v[46:47], v[170:171]
  v_pk_fma_f32 v[174:175], v[138:139], v[46:47], v[174:175] neg_lo:[1,0,0] neg_hi:[1,0,0]
  v_cvt_pk_bf16_f32 v154, v168, v169
  v_cvt_pk_bf16_f32 v155, v170, v171
  v_cvt_pk_bf16_f32 v158, v172, v173
  v_cvt_pk_bf16_f32 v159, v174, v175
  v_mfma_f32_16x16x32_bf16 v[176:179], v[144:147], v[16:19], 0
  v_mfma_f32_16x16x32_bf16 v[180:183], v[144:147], v[24:27], 0
  v_mfma_f32_16x16x32_bf16 v[176:179], v[148:151], v[20:23], v[176:179]
  buffer_load_dwordx4 a[60:63], v86, s[20:23], s55 offen
  v_add_u32 v86, 8192, v86
  v_mfma_f32_16x16x32_bf16 v[180:183], v[148:151], v[28:31], v[180:183]
  v_mfma_f32_16x16x32_bf16 v[184:187], v[152:155], v[16:19], 0
  v_mfma_f32_16x16x32_bf16 v[188:191], v[152:155], v[24:27], 0
  v_mfma_f32_16x16x32_bf16 v[184:187], v[156:159], v[20:23], v[184:187]
  v_mfma_f32_16x16x32_bf16 v[188:191], v[156:159], v[28:31], v[188:191]
  s_waitcnt vmcnt(16)
  v_lshlrev_b32 v112, 16, v76
  v_and_b32 v113, 0xffff0000, v76
  v_lshlrev_b32 v114, 16, v77
  v_and_b32 v115, 0xffff0000, v77
  v_lshlrev_b32 v116, 16, v78
  v_and_b32 v117, 0xffff0000, v78
  buffer_load_dwordx4 a[64:67], v86, s[20:23], s55 offen
  v_add_u32 v86, 8192, v86
  v_lshlrev_b32 v118, 16, v79
  v_and_b32 v119, 0xffff0000, v79
  v_lshlrev_b32 v120, 16, v80
  v_and_b32 v121, 0xffff0000, v80
  v_lshlrev_b32 v122, 16, v81
  v_and_b32 v123, 0xffff0000, v81
  v_lshlrev_b32 v124, 16, v82
  v_and_b32 v125, 0xffff0000, v82
  v_lshlrev_b32 v126, 16, v83
  v_and_b32 v127, 0xffff0000, v83
  v_pk_add_f32 v[176:177], v[176:177], v[112:113]
  v_pk_add_f32 v[178:179], v[178:179], v[114:115]
  buffer_load_dwordx4 a[68:71], v86, s[20:23], s55 offen
  v_add_u32 v86, 8192, v86
  v_pk_add_f32 v[180:181], v[180:181], v[116:117]
  v_pk_add_f32 v[182:183], v[182:183], v[118:119]
  v_pk_add_f32 v[184:185], v[184:185], v[120:121]
  v_pk_add_f32 v[186:187], v[186:187], v[122:123]
  v_pk_add_f32 v[188:189], v[188:189], v[124:125]
  v_pk_add_f32 v[190:191], v[190:191], v[126:127]
  v_pk_add_f32 v[104:105], v[176:177], v[178:179]
  v_pk_mul_f32 v[106:107], v[176:177], v[176:177]
  v_pk_fma_f32 v[106:107], v[178:179], v[178:179], v[106:107]
  v_pk_add_f32 v[104:105], v[104:105], v[180:181]
  v_pk_fma_f32 v[106:107], v[180:181], v[180:181], v[106:107]
  v_pk_add_f32 v[104:105], v[104:105], v[182:183]
  buffer_load_dwordx4 a[72:75], v86, s[20:23], s55 offen
  v_add_u32 v86, 8192, v86
  v_pk_fma_f32 v[106:107], v[182:183], v[182:183], v[106:107]
  v_pk_add_f32 v[108:109], v[184:185], v[186:187]
  v_pk_mul_f32 v[110:111], v[184:185], v[184:185]
  v_pk_fma_f32 v[110:111], v[186:187], v[186:187], v[110:111]
  v_pk_add_f32 v[108:109], v[108:109], v[188:189]
  v_pk_fma_f32 v[110:111], v[188:189], v[188:189], v[110:111]
  v_pk_add_f32 v[108:109], v[108:109], v[190:191]
  v_pk_fma_f32 v[110:111], v[190:191], v[190:191], v[110:111]
  v_add_f32 v100, v104, v105
  v_add_f32 v101, v106, v107
  v_add_f32 v102, v108, v109
  v_add_f32 v103, v110, v111
  buffer_load_dwordx4 a[76:79], v86, s[20:23], s55 offen
  v_add_u32 v86, 8192, v86
  v_add_f32_dpp v100, v100, v100 quad_perm:[1,0,3,2] row_mask:0xf bank_mask:0xf
  v_add_f32_dpp v101, v101, v101 quad_perm:[1,0,3,2] row_mask:0xf bank_mask:0xf
  v_add_f32_dpp v102, v102, v102 quad_perm:[1,0,3,2] row_mask:0xf bank_mask:0xf
  v_add_f32_dpp v103, v103, v103 quad_perm:[1,0,3,2] row_mask:0xf bank_mask:0xf
  v_add_f32_dpp v100, v100, v100 quad_perm:[2,3,0,1] row_mask:0xf bank_mask:0xf
  v_add_f32_dpp v101, v101, v101 quad_perm:[2,3,0,1] row_mask:0xf bank_mask:0xf
  v_add_f32_dpp v102, v102, v102 quad_perm:[2,3,0,1] row_mask:0xf bank_mask:0xf
  v_add_f32_dpp v103, v103, v103 quad_perm:[2,3,0,1] row_mask:0xf bank_mask:0xf
  v_add_f32_dpp v100, v100, v100 row_half_mirror row_mask:0xf bank_mask:0xf
  v_add_f32_dpp v101, v101, v101 row_half_mirror row_mask:0xf bank_mask:0xf
  v_add_f32_dpp v102, v102, v102 row_half_mirror row_mask:0xf bank_mask:0xf
  v_add_f32_dpp v103, v103, v103 row_half_mirror row_mask:0xf bank_mask:0xf
  buffer_load_dwordx4 a[80:83], v86, s[20:23], s55 offen
  v_add_u32 v86, 8192, v86
  v_add_f32_dpp v100, v100, v100 row_mirror row_mask:0xf bank_mask:0xf
  v_add_f32_dpp v101, v101, v101 row_mirror row_mask:0xf bank_mask:0xf
  v_add_f32_dpp v102, v102, v102 row_mirror row_mask:0xf bank_mask:0xf
  v_add_f32_dpp v103, v103, v103 row_mirror row_mask:0xf bank_mask:0xf
  v_mov_b32 v104, v100
  v_mov_b32 v105, v101
  v_mov_b32 v106, v102
  v_mov_b32 v107, v103
  v_permlane16_swap_b32 v100, v104
  v_permlane16_swap_b32 v101, v105
  v_permlane16_swap_b32 v102, v106
  v_permlane16_swap_b32 v103, v107
  buffer_load_dwordx4 a[84:87], v86, s[20:23], s55 offen
  v_add_u32 v86, 8192, v86
  v_add_f32 v100, v100, v104
  v_add_f32 v101, v101, v105
  v_add_f32 v102, v102, v106
  v_add_f32 v103, v103, v107
  v_mov_b32 v104, v100
  v_mov_b32 v105, v101
  v_mov_b32 v106, v102
  v_mov_b32 v107, v103
  v_permlane32_swap_b32 v100, v104
  v_permlane32_swap_b32 v101, v105
  v_permlane32_swap_b32 v102, v106
  v_permlane32_swap_b32 v103, v107
  buffer_load_dwordx4 a[88:91], v86, s[20:23], s55 offen
  v_add_u32 v86, 8192, v86
  v_add_f32 v100, v100, v104
  v_add_f32 v101, v101, v105
  v_add_f32 v102, v102, v106
  v_add_f32 v103, v103, v107
  v_mul_f32 v100, 0x3b000000, v100
  v_mul_f32 v101, 0x3b000000, v101
  v_fma_f32 v101, -v100, v100, v101
  v_max_f32 v101, 0, v101
  v_add_f32 v101, 0x3727c5ac, v101
  v_rsq_f32 v101, v101
  s_nop 0
  v_mul_f32 v100, v100, v101
  buffer_load_dwordx4 a[92:95], v86, s[20:23], s55 offen
  v_add_u32 v86, 8192, v86
  v_sub_f32 v100, 0, v100
  v_swap_b32 v100, v101
  v_mul_f32 v102, 0x3b000000, v102
  v_mul_f32 v103, 0x3b000000, v103
  v_fma_f32 v103, -v102, v102, v103
  v_max_f32 v103, 0, v103
  v_add_f32 v103, 0x3727c5ac, v103
  v_rsq_f32 v103, v103
  s_nop 0
  v_mul_f32 v102, v102, v103
  v_sub_f32 v102, 0, v102
  v_swap_b32 v102, v103
  buffer_load_dwordx4 a[96:99], v86, s[20:23], s55 offen
  v_add_u32 v86, 8192, v86
  v_cvt_pk_bf16_f32 v208, v176, v177
  v_cvt_pk_bf16_f32 v209, v178, v179
  v_cvt_pk_bf16_f32 v210, v180, v181
  v_cvt_pk_bf16_f32 v211, v182, v183
  v_pk_fma_f32 v[176:177], v[176:177], v[100:101], v[100:101] op_sel:[0,0,1] op_sel_hi:[1,0,1]
  v_pk_fma_f32 v[178:179], v[178:179], v[100:101], v[100:101] op_sel:[0,0,1] op_sel_hi:[1,0,1]
  v_pk_fma_f32 v[180:181], v[180:181], v[100:101], v[100:101] op_sel:[0,0,1] op_sel_hi:[1,0,1]
  v_pk_fma_f32 v[182:183], v[182:183], v[100:101], v[100:101] op_sel:[0,0,1] op_sel_hi:[1,0,1]
  v_cvt_pk_bf16_f32 v216, v176, v177
  v_cvt_pk_bf16_f32 v217, v178, v179
  v_cvt_pk_bf16_f32 v218, v180, v181
  v_cvt_pk_bf16_f32 v219, v182, v183
  buffer_load_dwordx4 a[100:103], v86, s[20:23], s55 offen
  v_add_u32 v86, 8192, v86
  v_cvt_pk_bf16_f32 v212, v184, v185
  v_cvt_pk_bf16_f32 v213, v186, v187
  v_cvt_pk_bf16_f32 v214, v188, v189
  v_cvt_pk_bf16_f32 v215, v190, v191
  v_pk_fma_f32 v[184:185], v[184:185], v[102:103], v[102:103] op_sel:[0,0,1] op_sel_hi:[1,0,1]
  v_pk_fma_f32 v[186:187], v[186:187], v[102:103], v[102:103] op_sel:[0,0,1] op_sel_hi:[1,0,1]
  v_pk_fma_f32 v[188:189], v[188:189], v[102:103], v[102:103] op_sel:[0,0,1] op_sel_hi:[1,0,1]
  v_pk_fma_f32 v[190:191], v[190:191], v[102:103], v[102:103] op_sel:[0,0,1] op_sel_hi:[1,0,1]
  v_cvt_pk_bf16_f32 v220, v184, v185
  v_cvt_pk_bf16_f32 v221, v186, v187
  v_cvt_pk_bf16_f32 v222, v188, v189
  v_cvt_pk_bf16_f32 v223, v190, v191
  buffer_load_dwordx4 a[104:107], v86, s[20:23], s55 offen
  v_add_u32 v86, 8192, v86
  buffer_load_dwordx4 a[108:111], v86, s[20:23], s55 offen
  v_add_u32 v86, 8192, v86
  s_mov_b32 s47, 4194304
  s_mov_b32 s48, 8388608
  ds_write_b64 v71, v[216:217] offset:0
  ds_write_b64 v71, v[218:219] offset:4096
  ds_write_b64 v72, v[220:221] offset:0
  ds_write_b64 v72, v[222:223] offset:4096
  s_cmp_eq_u32 s43, 0
  s_cbranch_scc1 SLOW_12
  buffer_store_dwordx2 v[208:209], v68, s[28:31], s47 offen offset:0
  buffer_store_dwordx2 v[210:211], v68, s[28:31], s47 offen offset:512
  buffer_store_dwordx2 v[212:213], v68, s[28:31], s47 offen offset:1024
  buffer_store_dwordx2 v[214:215], v68, s[28:31], s47 offen offset:1536
  s_branch JOIN_13
SLOW_12:
  buffer_store_dwordx2 v[208:209], v68, s[28:31], s47 offen offset:0 sc1
  buffer_store_dwordx2 v[210:211], v68, s[28:31], s47 offen offset:512 sc1
  buffer_store_dwordx2 v[212:213], v68, s[28:31], s47 offen offset:1024 sc1
  buffer_store_dwordx2 v[214:215], v68, s[28:31], s47 offen offset:1536 sc1
JOIN_13:
  s_waitcnt lgkmcnt(0)
  s_barrier
  ds_read_b128 v[216:219], v73
  ds_read_b128 v[220:223], v85 offset:1024
  s_cmp_eq_u32 s43, 0
  s_cbranch_scc1 SLOW_14
  s_waitcnt lgkmcnt(1)
  buffer_store_dwordx4 v[216:219], v74, s[28:31], s48 offen
  s_waitcnt lgkmcnt(0)
  buffer_store_dwordx4 v[220:223], v74, s[28:31], s48 offen offset:2048
  s_branch JOIN_15
SLOW_14:
  s_waitcnt lgkmcnt(1)
  buffer_store_dwordx4 v[216:219], v74, s[28:31], s48 offen sc1
  s_waitcnt lgkmcnt(0)
  buffer_store_dwordx4 v[220:223], v74, s[28:31], s48 offen offset:2048 sc1
JOIN_15:
  s_lshr_b32 s54, s37, 4
  s_lshl_b32 s48, s36, 1
  s_add_u32 s54, s54, s48
  s_lshl_b32 s54, s54, 8
  s_add_u32 s54, s54, 19955712
  s_lshl_b32 s48, s40, 4
  s_add_u32 s54, s54, s48
  s_lshl_b32 s48, s41, 2
  s_add_u32 s54, s54, s48
  s_add_u32 s57, s42, 16
  v_mov_b32 v222, s57
  v_mov_b32 v223, s54
  s_waitcnt vmcnt(0)
  s_mov_b64 exec, 1
  s_cmp_eq_u32 s43, 0
  s_cbranch_scc1 SLOW_16
  buffer_store_dword v222, v223, s[28:31], 0 offen
  s_branch JOIN_17
SLOW_16:
  buffer_store_dword v222, v223, s[28:31], 0 offen sc1
JOIN_17:
  s_mov_b64 exec, -1
  s_lshr_b32 s47, s37, 4
  s_lshl_b32 s48, s36, 1
  s_add_u32 s47, s47, s48
  s_lshl_b32 s47, s47, 8
  s_add_u32 s47, s47, 19955712
  s_lshl_b32 s48, s41, 6
  s_add_u32 s47, s47, s48
  v_lshlrev_b32 v222, 2, v1
  v_add_u32 v222, s47, v222
  s_add_u32 s56, s42, 16
  s_mov_b32 s58, 0x40000
POLL_18:
  buffer_load_dword v223, v222, s[28:31], 0 offen sc1
  s_waitcnt vmcnt(0)
  v_cmp_ne_u32 vcc, s56, v223
  s_nop 4
  s_cbranch_vccz PD_19
  s_sub_u32 s58, s58, 1
  s_cmp_lg_u32 s58, 0
  s_cbranch_scc1 POLL_18
PD_19:
  v_lshlrev_b32 v5, 4, v0
  s_lshl_b32 s47, s46, 16
  s_and_b32 s48, s41, 1
  s_lshl_b32 s48, s48, 15
  s_add_u32 s47, s47, s48
  s_add_u32 s47, s47, 8388608
  s_add_u32 s48, s47, 16384
  buffer_load_dwordx4 v[8:11], v5, s[28:31], s47 offen offset:0 sc1
  buffer_load_dwordx4 v[12:15], v5, s[28:31], s48 offen offset:0 sc1
  buffer_load_dwordx4 v[16:19], v5, s[28:31], s47 offen offset:1024 sc1
  buffer_load_dwordx4 v[20:23], v5, s[28:31], s48 offen offset:1024 sc1
  buffer_load_dwordx4 v[24:27], v5, s[28:31], s47 offen offset:2048 sc1
  buffer_load_dwordx4 v[28:31], v5, s[28:31], s48 offen offset:2048 sc1
  buffer_load_dwordx4 v[32:35], v5, s[28:31], s47 offen offset:3072 sc1
  buffer_load_dwordx4 v[36:39], v5, s[28:31], s48 offen offset:3072 sc1
  s_add_u32 s47, s47, 4096
  s_add_u32 s48, s48, 4096
  v_lshrrev_b32 v250, 3, v0
  v_lshlrev_b32 v250, 10, v250
  v_and_b32 v251, 7, v0
  v_lshl_add_u32 v250, v251, 4, v250
  s_mul_i32 s55, s41, 458752
  s_lshl_b32 s49, s39, 7
  s_add_u32 s55, s55, s49
  s_add_u32 s55, s55, 229376
  v_lshl_add_u32 v252, v2, 2, v3
  v_mul_u32_u24 v252, 224, v252
  v_lshl_add_u32 v252, v4, 3, v252
  v_add_u32 v252, 0, v252
  v_add_u32 v253, 57344, v252
  ds_read_b64_tr_b16 v[136:137], v252 offset:0
  ds_read_b64_tr_b16 v[138:139], v252 offset:3584
  ds_read_b64_tr_b16 v[140:141], v252 offset:32
  ds_read_b64_tr_b16 v[142:143], v252 offset:3616
  ds_read_b64_tr_b16 v[144:145], v252 offset:64
  ds_read_b64_tr_b16 v[146:147], v252 offset:3648
  ds_read_b64_tr_b16 v[148:149], v252 offset:96
  ds_read_b64_tr_b16 v[150:151], v252 offset:3680
  ds_read_b64_tr_b16 v[152:153], v252 offset:128
  ds_read_b64_tr_b16 v[154:155], v252 offset:3712
  ds_read_b64_tr_b16 v[156:157], v252 offset:160
  ds_read_b64_tr_b16 v[158:159], v252 offset:3744
  ds_read_b64_tr_b16 v[160:161], v252 offset:192
  ds_read_b64_tr_b16 v[162:163], v252 offset:3776
  s_waitcnt vmcnt(6)
  s_waitcnt lgkmcnt(12)
  v_mfma_f32_16x16x32_bf16 v[192:195], v[136:139], v[8:11], 0
  ds_read_b64_tr_b16 v[164:165], v252 offset:7168
  v_mfma_f32_16x16x32_bf16 v[196:199], v[136:139], v[12:15], 0
  ds_read_b64_tr_b16 v[166:167], v252 offset:10752
  s_waitcnt lgkmcnt(12)
  v_mfma_f32_16x16x32_bf16 v[200:203], v[140:143], v[8:11], 0
  ds_read_b64_tr_b16 v[136:137], v252 offset:7200
  v_mfma_f32_16x16x32_bf16 v[204:207], v[140:143], v[12:15], 0
  ds_read_b64_tr_b16 v[138:139], v252 offset:10784
  buffer_load_dwordx4 v[40:43], v5, s[28:31], s47 offen offset:0 sc1
  buffer_load_dwordx4 v[44:47], v5, s[28:31], s48 offen offset:0 sc1
  s_waitcnt lgkmcnt(12)
  v_mfma_f32_16x16x32_bf16 v[208:211], v[144:147], v[8:11], 0
  ds_read_b64_tr_b16 v[140:141], v252 offset:7232
  v_mfma_f32_16x16x32_bf16 v[212:215], v[144:147], v[12:15], 0
  ds_read_b64_tr_b16 v[142:143], v252 offset:10816
  s_waitcnt lgkmcnt(12)
  v_mfma_f32_16x16x32_bf16 v[216:219], v[148:151], v[8:11], 0
  ds_read_b64_tr_b16 v[144:145], v252 offset:7264
  v_mfma_f32_16x16x32_bf16 v[220:223], v[148:151], v[12:15], 0
  ds_read_b64_tr_b16 v[146:147], v252 offset:10848
  s_waitcnt lgkmcnt(12)
  v_mfma_f32_16x16x32_bf16 v[224:227], v[152:155], v[8:11], 0
  ds_read_b64_tr_b16 v[148:149], v252 offset:7296
  v_mfma_f32_16x16x32_bf16 v[228:231], v[152:155], v[12:15], 0
  ds_read_b64_tr_b16 v[150:151], v252 offset:10880
  buffer_load_dwordx4 v[48:51], v5, s[28:31], s47 offen offset:1024 sc1
  buffer_load_dwordx4 v[52:55], v5, s[28:31], s48 offen offset:1024 sc1
  s_waitcnt lgkmcnt(12)
  v_mfma_f32_16x16x32_bf16 v[232:235], v[156:159], v[8:11], 0
  ds_read_b64_tr_b16 v[152:153], v252 offset:7328
  v_mfma_f32_16x16x32_bf16 v[236:239], v[156:159], v[12:15], 0
  ds_read_b64_tr_b16 v[154:155], v252 offset:10912
  s_waitcnt lgkmcnt(12)
  v_mfma_f32_16x16x32_bf16 v[240:243], v[160:163], v[8:11], 0
  ds_read_b64_tr_b16 v[156:157], v252 offset:7360
  v_mfma_f32_16x16x32_bf16 v[244:247], v[160:163], v[12:15], 0
  ds_read_b64_tr_b16 v[158:159], v252 offset:10944
  s_waitcnt vmcnt(8)
  s_waitcnt lgkmcnt(12)
  v_mfma_f32_16x16x32_bf16 v[192:195], v[164:167], v[16:19], v[192:195]
  ds_read_b64_tr_b16 v[160:161], v252 offset:14336
  v_mfma_f32_16x16x32_bf16 v[196:199], v[164:167], v[20:23], v[196:199]
  ds_read_b64_tr_b16 v[162:163], v252 offset:17920
  s_waitcnt lgkmcnt(12)
  v_mfma_f32_16x16x32_bf16 v[200:203], v[136:139], v[16:19], v[200:203]
  ds_read_b64_tr_b16 v[164:165], v252 offset:14368
  v_mfma_f32_16x16x32_bf16 v[204:207], v[136:139], v[20:23], v[204:207]
  ds_read_b64_tr_b16 v[166:167], v252 offset:17952
  buffer_load_dwordx4 v[56:59], v5, s[28:31], s47 offen offset:2048 sc1
  buffer_load_dwordx4 v[60:63], v5, s[28:31], s48 offen offset:2048 sc1
  s_waitcnt lgkmcnt(12)
  v_mfma_f32_16x16x32_bf16 v[208:211], v[140:143], v[16:19], v[208:211]
  ds_read_b64_tr_b16 v[136:137], v252 offset:14400
  v_mfma_f32_16x16x32_bf16 v[212:215], v[140:143], v[20:23], v[212:215]
  ds_read_b64_tr_b16 v[138:139], v252 offset:17984
  s_waitcnt lgkmcnt(12)
  v_mfma_f32_16x16x32_bf16 v[216:219], v[144:147], v[16:19], v[216:219]
  ds_read_b64_tr_b16 v[140:141], v252 offset:14432
  v_mfma_f32_16x16x32_bf16 v[220:223], v[144:147], v[20:23], v[220:223]
  ds_read_b64_tr_b16 v[142:143], v252 offset:18016
  s_waitcnt lgkmcnt(12)
  v_mfma_f32_16x16x32_bf16 v[224:227], v[148:151], v[16:19], v[224:227]
  ds_read_b64_tr_b16 v[144:145], v252 offset:14464
  v_mfma_f32_16x16x32_bf16 v[228:231], v[148:151], v[20:23], v[228:231]
  ds_read_b64_tr_b16 v[146:147], v252 offset:18048
  buffer_load_dwordx4 v[64:67], v5, s[28:31], s47 offen offset:3072 sc1
  buffer_load_dwordx4 v[68:71], v5, s[28:31], s48 offen offset:3072 sc1
  s_add_u32 s47, s47, 4096
  s_add_u32 s48, s48, 4096
  s_waitcnt lgkmcnt(12)
  v_mfma_f32_16x16x32_bf16 v[232:235], v[152:155], v[16:19], v[232:235]
  ds_read_b64_tr_b16 v[148:149], v252 offset:14496
  v_mfma_f32_16x16x32_bf16 v[236:239], v[152:155], v[20:23], v[236:239]
  ds_read_b64_tr_b16 v[150:151], v252 offset:18080
  s_waitcnt lgkmcnt(12)
  v_mfma_f32_16x16x32_bf16 v[240:243], v[156:159], v[16:19], v[240:243]
  ds_read_b64_tr_b16 v[152:153], v252 offset:14528
  v_mfma_f32_16x16x32_bf16 v[244:247], v[156:159], v[20:23], v[244:247]
  ds_read_b64_tr_b16 v[154:155], v252 offset:18112
  s_waitcnt vmcnt(10)
  s_waitcnt lgkmcnt(12)
  v_mfma_f32_16x16x32_bf16 v[192:195], v[160:163], v[24:27], v[192:195]
  ds_read_b64_tr_b16 v[156:157], v252 offset:21504
  v_mfma_f32_16x16x32_bf16 v[196:199], v[160:163], v[28:31], v[196:199]
  ds_read_b64_tr_b16 v[158:159], v252 offset:25088
  s_waitcnt lgkmcnt(12)
  v_mfma_f32_16x16x32_bf16 v[200:203], v[164:167], v[24:27], v[200:203]
  ds_read_b64_tr_b16 v[160:161], v252 offset:21536
  v_mfma_f32_16x16x32_bf16 v[204:207], v[164:167], v[28:31], v[204:207]
  ds_read_b64_tr_b16 v[162:163], v252 offset:25120
  buffer_load_dwordx4 v[72:75], v5, s[28:31], s47 offen offset:0 sc1
  buffer_load_dwordx4 v[76:79], v5, s[28:31], s48 offen offset:0 sc1
  s_waitcnt lgkmcnt(12)
  v_mfma_f32_16x16x32_bf16 v[208:211], v[136:139], v[24:27], v[208:211]
  ds_read_b64_tr_b16 v[164:165], v252 offset:21568
  v_mfma_f32_16x16x32_bf16 v[212:215], v[136:139], v[28:31], v[212:215]
  ds_read_b64_tr_b16 v[166:167], v252 offset:25152
  s_waitcnt lgkmcnt(12)
  v_mfma_f32_16x16x32_bf16 v[216:219], v[140:143], v[24:27], v[216:219]
  ds_read_b64_tr_b16 v[136:137], v252 offset:21600
  v_mfma_f32_16x16x32_bf16 v[220:223], v[140:143], v[28:31], v[220:223]
  ds_read_b64_tr_b16 v[138:139], v252 offset:25184
  s_waitcnt lgkmcnt(12)
  v_mfma_f32_16x16x32_bf16 v[224:227], v[144:147], v[24:27], v[224:227]
  ds_read_b64_tr_b16 v[140:141], v252 offset:21632
  v_mfma_f32_16x16x32_bf16 v[228:231], v[144:147], v[28:31], v[228:231]
  ds_read_b64_tr_b16 v[142:143], v252 offset:25216
  buffer_load_dwordx4 v[80:83], v5, s[28:31], s47 offen offset:1024 sc1
  buffer_load_dwordx4 v[84:87], v5, s[28:31], s48 offen offset:1024 sc1
  s_waitcnt lgkmcnt(12)
  v_mfma_f32_16x16x32_bf16 v[232:235], v[148:151], v[24:27], v[232:235]
  ds_read_b64_tr_b16 v[144:145], v252 offset:21664
  v_mfma_f32_16x16x32_bf16 v[236:239], v[148:151], v[28:31], v[236:239]
  ds_read_b64_tr_b16 v[146:147], v252 offset:25248
  s_waitcnt lgkmcnt(12)
  v_mfma_f32_16x16x32_bf16 v[240:243], v[152:155], v[24:27], v[240:243]
  ds_read_b64_tr_b16 v[148:149], v252 offset:21696
  v_mfma_f32_16x16x32_bf16 v[244:247], v[152:155], v[28:31], v[244:247]
  ds_read_b64_tr_b16 v[150:151], v252 offset:25280
  s_waitcnt vmcnt(12)
  s_waitcnt lgkmcnt(12)
  v_mfma_f32_16x16x32_bf16 v[192:195], v[156:159], v[32:35], v[192:195]
  ds_read_b64_tr_b16 v[152:153], v252 offset:28672
  v_mfma_f32_16x16x32_bf16 v[196:199], v[156:159], v[36:39], v[196:199]
  ds_read_b64_tr_b16 v[154:155], v252 offset:32256
  s_waitcnt lgkmcnt(12)
  v_mfma_f32_16x16x32_bf16 v[200:203], v[160:163], v[32:35], v[200:203]
  ds_read_b64_tr_b16 v[156:157], v252 offset:28704
  v_mfma_f32_16x16x32_bf16 v[204:207], v[160:163], v[36:39], v[204:207]
  ds_read_b64_tr_b16 v[158:159], v252 offset:32288
  buffer_load_dwordx4 v[88:91], v5, s[28:31], s47 offen offset:2048 sc1
  buffer_load_dwordx4 v[92:95], v5, s[28:31], s48 offen offset:2048 sc1
  s_waitcnt lgkmcnt(12)
  v_mfma_f32_16x16x32_bf16 v[208:211], v[164:167], v[32:35], v[208:211]
  ds_read_b64_tr_b16 v[160:161], v252 offset:28736
  v_mfma_f32_16x16x32_bf16 v[212:215], v[164:167], v[36:39], v[212:215]
  ds_read_b64_tr_b16 v[162:163], v252 offset:32320
  s_waitcnt lgkmcnt(12)
  v_mfma_f32_16x16x32_bf16 v[216:219], v[136:139], v[32:35], v[216:219]
  ds_read_b64_tr_b16 v[164:165], v252 offset:28768
  v_mfma_f32_16x16x32_bf16 v[220:223], v[136:139], v[36:39], v[220:223]
  ds_read_b64_tr_b16 v[166:167], v252 offset:32352
  s_waitcnt lgkmcnt(12)
  v_mfma_f32_16x16x32_bf16 v[224:227], v[140:143], v[32:35], v[224:227]
  ds_read_b64_tr_b16 v[136:137], v252 offset:28800
  v_mfma_f32_16x16x32_bf16 v[228:231], v[140:143], v[36:39], v[228:231]
  ds_read_b64_tr_b16 v[138:139], v252 offset:32384
  buffer_load_dwordx4 v[96:99], v5, s[28:31], s47 offen offset:3072 sc1
  buffer_load_dwordx4 v[100:103], v5, s[28:31], s48 offen offset:3072 sc1
  s_add_u32 s47, s47, 4096
  s_add_u32 s48, s48, 4096
  s_waitcnt lgkmcnt(12)
  v_mfma_f32_16x16x32_bf16 v[232:235], v[144:147], v[32:35], v[232:235]
  ds_read_b64_tr_b16 v[140:141], v252 offset:28832
  v_mfma_f32_16x16x32_bf16 v[236:239], v[144:147], v[36:39], v[236:239]
  ds_read_b64_tr_b16 v[142:143], v252 offset:32416
  s_waitcnt lgkmcnt(12)
  v_mfma_f32_16x16x32_bf16 v[240:243], v[148:151], v[32:35], v[240:243]
  ds_read_b64_tr_b16 v[144:145], v252 offset:28864
  v_mfma_f32_16x16x32_bf16 v[244:247], v[148:151], v[36:39], v[244:247]
  ds_read_b64_tr_b16 v[146:147], v252 offset:32448
  s_waitcnt vmcnt(14)
  s_waitcnt lgkmcnt(12)
  v_mfma_f32_16x16x32_bf16 v[192:195], v[152:155], v[40:43], v[192:195]
  ds_read_b64_tr_b16 v[148:149], v252 offset:35840
  v_mfma_f32_16x16x32_bf16 v[196:199], v[152:155], v[44:47], v[196:199]
  ds_read_b64_tr_b16 v[150:151], v252 offset:39424
  s_waitcnt lgkmcnt(12)
  v_mfma_f32_16x16x32_bf16 v[200:203], v[156:159], v[40:43], v[200:203]
  ds_read_b64_tr_b16 v[152:153], v252 offset:35872
  v_mfma_f32_16x16x32_bf16 v[204:207], v[156:159], v[44:47], v[204:207]
  ds_read_b64_tr_b16 v[154:155], v252 offset:39456
  buffer_load_dwordx4 v[104:107], v5, s[28:31], s47 offen offset:0 sc1
  buffer_load_dwordx4 v[108:111], v5, s[28:31], s48 offen offset:0 sc1
  s_waitcnt lgkmcnt(12)
  v_mfma_f32_16x16x32_bf16 v[208:211], v[160:163], v[40:43], v[208:211]
  ds_read_b64_tr_b16 v[156:157], v252 offset:35904
  v_mfma_f32_16x16x32_bf16 v[212:215], v[160:163], v[44:47], v[212:215]
  ds_read_b64_tr_b16 v[158:159], v252 offset:39488
  s_waitcnt lgkmcnt(12)
  v_mfma_f32_16x16x32_bf16 v[216:219], v[164:167], v[40:43], v[216:219]
  ds_read_b64_tr_b16 v[160:161], v252 offset:35936
  v_mfma_f32_16x16x32_bf16 v[220:223], v[164:167], v[44:47], v[220:223]
  ds_read_b64_tr_b16 v[162:163], v252 offset:39520
  s_waitcnt lgkmcnt(12)
  v_mfma_f32_16x16x32_bf16 v[224:227], v[136:139], v[40:43], v[224:227]
  ds_read_b64_tr_b16 v[164:165], v252 offset:35968
  v_mfma_f32_16x16x32_bf16 v[228:231], v[136:139], v[44:47], v[228:231]
  ds_read_b64_tr_b16 v[166:167], v252 offset:39552
  buffer_load_dwordx4 v[112:115], v5, s[28:31], s47 offen offset:1024 sc1
  buffer_load_dwordx4 v[116:119], v5, s[28:31], s48 offen offset:1024 sc1
  s_waitcnt lgkmcnt(12)
  v_mfma_f32_16x16x32_bf16 v[232:235], v[140:143], v[40:43], v[232:235]
  ds_read_b64_tr_b16 v[136:137], v252 offset:36000
  v_mfma_f32_16x16x32_bf16 v[236:239], v[140:143], v[44:47], v[236:239]
  ds_read_b64_tr_b16 v[138:139], v252 offset:39584
  s_waitcnt lgkmcnt(12)
  v_mfma_f32_16x16x32_bf16 v[240:243], v[144:147], v[40:43], v[240:243]
  ds_read_b64_tr_b16 v[140:141], v252 offset:36032
  v_mfma_f32_16x16x32_bf16 v[244:247], v[144:147], v[44:47], v[244:247]
  ds_read_b64_tr_b16 v[142:143], v252 offset:39616
  s_waitcnt vmcnt(16)
  s_waitcnt lgkmcnt(12)
  v_mfma_f32_16x16x32_bf16 v[192:195], v[148:151], v[48:51], v[192:195]
  ds_read_b64_tr_b16 v[144:145], v252 offset:43008
  v_mfma_f32_16x16x32_bf16 v[196:199], v[148:151], v[52:55], v[196:199]
  ds_read_b64_tr_b16 v[146:147], v252 offset:46592
  s_waitcnt lgkmcnt(12)
  v_mfma_f32_16x16x32_bf16 v[200:203], v[152:155], v[48:51], v[200:203]
  ds_read_b64_tr_b16 v[148:149], v252 offset:43040
  v_mfma_f32_16x16x32_bf16 v[204:207], v[152:155], v[52:55], v[204:207]
  ds_read_b64_tr_b16 v[150:151], v252 offset:46624
  buffer_load_dwordx4 v[120:123], v5, s[28:31], s47 offen offset:2048 sc1
  buffer_load_dwordx4 v[124:127], v5, s[28:31], s48 offen offset:2048 sc1
  s_waitcnt lgkmcnt(12)
  v_mfma_f32_16x16x32_bf16 v[208:211], v[156:159], v[48:51], v[208:211]
  ds_read_b64_tr_b16 v[152:153], v252 offset:43072
  v_mfma_f32_16x16x32_bf16 v[212:215], v[156:159], v[52:55], v[212:215]
  ds_read_b64_tr_b16 v[154:155], v252 offset:46656
  s_waitcnt lgkmcnt(12)
  v_mfma_f32_16x16x32_bf16 v[216:219], v[160:163], v[48:51], v[216:219]
  ds_read_b64_tr_b16 v[156:157], v252 offset:43104
  v_mfma_f32_16x16x32_bf16 v[220:223], v[160:163], v[52:55], v[220:223]
  ds_read_b64_tr_b16 v[158:159], v252 offset:46688
  s_waitcnt lgkmcnt(12)
  v_mfma_f32_16x16x32_bf16 v[224:227], v[164:167], v[48:51], v[224:227]
  ds_read_b64_tr_b16 v[160:161], v252 offset:43136
  v_mfma_f32_16x16x32_bf16 v[228:231], v[164:167], v[52:55], v[228:231]
  ds_read_b64_tr_b16 v[162:163], v252 offset:46720
  buffer_load_dwordx4 v[128:131], v5, s[28:31], s47 offen offset:3072 sc1
  buffer_load_dwordx4 v[132:135], v5, s[28:31], s48 offen offset:3072 sc1
  s_waitcnt lgkmcnt(12)
  v_mfma_f32_16x16x32_bf16 v[232:235], v[136:139], v[48:51], v[232:235]
  ds_read_b64_tr_b16 v[164:165], v252 offset:43168
  v_mfma_f32_16x16x32_bf16 v[236:239], v[136:139], v[52:55], v[236:239]
  ds_read_b64_tr_b16 v[166:167], v252 offset:46752
  s_waitcnt lgkmcnt(12)
  v_mfma_f32_16x16x32_bf16 v[240:243], v[140:143], v[48:51], v[240:243]
  ds_read_b64_tr_b16 v[136:137], v252 offset:43200
  v_mfma_f32_16x16x32_bf16 v[244:247], v[140:143], v[52:55], v[244:247]
  ds_read_b64_tr_b16 v[138:139], v252 offset:46784
  s_waitcnt vmcnt(18)
  s_waitcnt lgkmcnt(12)
  v_mfma_f32_16x16x32_bf16 v[192:195], v[144:147], v[56:59], v[192:195]
  ds_read_b64_tr_b16 v[140:141], v252 offset:50176
  v_mfma_f32_16x16x32_bf16 v[196:199], v[144:147], v[60:63], v[196:199]
  ds_read_b64_tr_b16 v[142:143], v252 offset:53760
  s_waitcnt lgkmcnt(12)
  v_mfma_f32_16x16x32_bf16 v[200:203], v[148:151], v[56:59], v[200:203]
  ds_read_b64_tr_b16 v[144:145], v252 offset:50208
  v_mfma_f32_16x16x32_bf16 v[204:207], v[148:151], v[60:63], v[204:207]
  ds_read_b64_tr_b16 v[146:147], v252 offset:53792
  v_min_u32 v254, 55, v0
  v_lshlrev_b32 v254, 7, v254
  s_mul_i32 s52, s38, 229376
  s_mul_i32 s53, s41, 7168
  s_add_u32 s52, s52, s53
  s_mul_i32 s53, s39, 28672
  s_add_u32 s52, s52, s53
  s_add_u32 s52, s52, 10485760
  buffer_load_dword v255, v254, s[28:31], s52 offen sc1
  s_waitcnt lgkmcnt(12)
  v_mfma_f32_16x16x32_bf16 v[208:211], v[152:155], v[56:59], v[208:211]
  ds_read_b64_tr_b16 v[148:149], v252 offset:50240
  v_mfma_f32_16x16x32_bf16 v[212:215], v[152:155], v[60:63], v[212:215]
  ds_read_b64_tr_b16 v[150:151], v252 offset:53824
  s_waitcnt lgkmcnt(12)
  v_mfma_f32_16x16x32_bf16 v[216:219], v[156:159], v[56:59], v[216:219]
  ds_read_b64_tr_b16 v[152:153], v252 offset:50272
  v_mfma_f32_16x16x32_bf16 v[220:223], v[156:159], v[60:63], v[220:223]
  ds_read_b64_tr_b16 v[154:155], v252 offset:53856
  s_waitcnt lgkmcnt(12)
  v_mfma_f32_16x16x32_bf16 v[224:227], v[160:163], v[56:59], v[224:227]
  ds_read_b64_tr_b16 v[156:157], v252 offset:50304
  v_mfma_f32_16x16x32_bf16 v[228:231], v[160:163], v[60:63], v[228:231]
  ds_read_b64_tr_b16 v[158:159], v252 offset:53888
  buffer_load_dwordx4 a[112:115], v250, s[20:23], s55 offen
  s_add_u32 s55, s55, 8192
  buffer_load_dwordx4 a[116:119], v250, s[20:23], s55 offen
  s_add_u32 s55, s55, 8192
  s_waitcnt lgkmcnt(12)
  v_mfma_f32_16x16x32_bf16 v[232:235], v[164:167], v[56:59], v[232:235]
  ds_read_b64_tr_b16 v[160:161], v252 offset:50336
  v_mfma_f32_16x16x32_bf16 v[236:239], v[164:167], v[60:63], v[236:239]
  ds_read_b64_tr_b16 v[162:163], v252 offset:53920
  s_waitcnt lgkmcnt(12)
  v_mfma_f32_16x16x32_bf16 v[240:243], v[136:139], v[56:59], v[240:243]
  ds_read_b64_tr_b16 v[164:165], v252 offset:50368
  v_mfma_f32_16x16x32_bf16 v[244:247], v[136:139], v[60:63], v[244:247]
  ds_read_b64_tr_b16 v[166:167], v252 offset:53952
  s_waitcnt vmcnt(19)
  s_waitcnt lgkmcnt(12)
  v_mfma_f32_16x16x32_bf16 v[192:195], v[140:143], v[64:67], v[192:195]
  ds_read_b64_tr_b16 v[136:137], v253 offset:0
  v_mfma_f32_16x16x32_bf16 v[196:199], v[140:143], v[68:71], v[196:199]
  ds_read_b64_tr_b16 v[138:139], v253 offset:3584
  s_waitcnt lgkmcnt(12)
  v_mfma_f32_16x16x32_bf16 v[200:203], v[144:147], v[64:67], v[200:203]
  ds_read_b64_tr_b16 v[140:141], v253 offset:32
  v_mfma_f32_16x16x32_bf16 v[204:207], v[144:147], v[68:71], v[204:207]
  ds_read_b64_tr_b16 v[142:143], v253 offset:3616
  buffer_load_dwordx4 a[120:123], v250, s[20:23], s55 offen
  s_add_u32 s55, s55, 8192
  buffer_load_dwordx4 a[124:127], v250, s[20:23], s55 offen
  s_add_u32 s55, s55, 8192
  s_waitcnt lgkmcnt(12)
  v_mfma_f32_16x16x32_bf16 v[208:211], v[148:151], v[64:67], v[208:211]
  ds_read_b64_tr_b16 v[144:145], v253 offset:64
  v_mfma_f32_16x16x32_bf16 v[212:215], v[148:151], v[68:71], v[212:215]
  ds_read_b64_tr_b16 v[146:147], v253 offset:3648
  s_waitcnt lgkmcnt(12)
  v_mfma_f32_16x16x32_bf16 v[216:219], v[152:155], v[64:67], v[216:219]
  ds_read_b64_tr_b16 v[148:149], v253 offset:96
  v_mfma_f32_16x16x32_bf16 v[220:223], v[152:155], v[68:71], v[220:223]
  ds_read_b64_tr_b16 v[150:151], v253 offset:3680
  s_waitcnt lgkmcnt(12)
  v_mfma_f32_16x16x32_bf16 v[224:227], v[156:159], v[64:67], v[224:227]
  ds_read_b64_tr_b16 v[152:153], v253 offset:128
  v_mfma_f32_16x16x32_bf16 v[228:231], v[156:159], v[68:71], v[228:231]
  ds_read_b64_tr_b16 v[154:155], v253 offset:3712
  buffer_load_dwordx4 a[128:131], v250, s[20:23], s55 offen
  s_add_u32 s55, s55, 8192
  buffer_load_dwordx4 a[132:135], v250, s[20:23], s55 offen
  s_add_u32 s55, s55, 8192
  s_waitcnt lgkmcnt(12)
  v_mfma_f32_16x16x32_bf16 v[232:235], v[160:163], v[64:67], v[232:235]
  ds_read_b64_tr_b16 v[156:157], v253 offset:160
  v_mfma_f32_16x16x32_bf16 v[236:239], v[160:163], v[68:71], v[236:239]
  ds_read_b64_tr_b16 v[158:159], v253 offset:3744
  s_waitcnt lgkmcnt(12)
  v_mfma_f32_16x16x32_bf16 v[240:243], v[164:167], v[64:67], v[240:243]
  ds_read_b64_tr_b16 v[160:161], v253 offset:192
  v_mfma_f32_16x16x32_bf16 v[244:247], v[164:167], v[68:71], v[244:247]
  ds_read_b64_tr_b16 v[162:163], v253 offset:3776
  s_waitcnt vmcnt(21)
  s_waitcnt lgkmcnt(12)
  v_mfma_f32_16x16x32_bf16 v[192:195], v[136:139], v[72:75], v[192:195]
  ds_read_b64_tr_b16 v[164:165], v253 offset:7168
  v_mfma_f32_16x16x32_bf16 v[196:199], v[136:139], v[76:79], v[196:199]
  ds_read_b64_tr_b16 v[166:167], v253 offset:10752
  s_waitcnt lgkmcnt(12)
  v_mfma_f32_16x16x32_bf16 v[200:203], v[140:143], v[72:75], v[200:203]
  ds_read_b64_tr_b16 v[136:137], v253 offset:7200
  v_mfma_f32_16x16x32_bf16 v[204:207], v[140:143], v[76:79], v[204:207]
  ds_read_b64_tr_b16 v[138:139], v253 offset:10784
  buffer_load_dwordx4 a[136:139], v250, s[20:23], s55 offen
  s_add_u32 s55, s55, 8192
  buffer_load_dwordx4 a[140:143], v250, s[20:23], s55 offen
  s_add_u32 s55, s55, 8192
  s_waitcnt lgkmcnt(12)
  v_mfma_f32_16x16x32_bf16 v[208:211], v[144:147], v[72:75], v[208:211]
  ds_read_b64_tr_b16 v[140:141], v253 offset:7232
  v_mfma_f32_16x16x32_bf16 v[212:215], v[144:147], v[76:79], v[212:215]
  ds_read_b64_tr_b16 v[142:143], v253 offset:10816
  s_waitcnt lgkmcnt(12)
  v_mfma_f32_16x16x32_bf16 v[216:219], v[148:151], v[72:75], v[216:219]
  ds_read_b64_tr_b16 v[144:145], v253 offset:7264
  v_mfma_f32_16x16x32_bf16 v[220:223], v[148:151], v[76:79], v[220:223]
  ds_read_b64_tr_b16 v[146:147], v253 offset:10848
  s_waitcnt lgkmcnt(12)
  v_mfma_f32_16x16x32_bf16 v[224:227], v[152:155], v[72:75], v[224:227]
  ds_read_b64_tr_b16 v[148:149], v253 offset:7296
  v_mfma_f32_16x16x32_bf16 v[228:231], v[152:155], v[76:79], v[228:231]
  ds_read_b64_tr_b16 v[150:151], v253 offset:10880
  buffer_load_dwordx4 a[144:147], v250, s[20:23], s55 offen
  s_add_u32 s55, s55, 8192
  buffer_load_dwordx4 a[148:151], v250, s[20:23], s55 offen
  s_add_u32 s55, s55, 8192
  s_waitcnt lgkmcnt(12)
  v_mfma_f32_16x16x32_bf16 v[232:235], v[156:159], v[72:75], v[232:235]
  ds_read_b64_tr_b16 v[152:153], v253 offset:7328
  v_mfma_f32_16x16x32_bf16 v[236:239], v[156:159], v[76:79], v[236:239]
  ds_read_b64_tr_b16 v[154:155], v253 offset:10912
  s_waitcnt lgkmcnt(12)
  v_mfma_f32_16x16x32_bf16 v[240:243], v[160:163], v[72:75], v[240:243]
  ds_read_b64_tr_b16 v[156:157], v253 offset:7360
  v_mfma_f32_16x16x32_bf16 v[244:247], v[160:163], v[76:79], v[244:247]
  ds_read_b64_tr_b16 v[158:159], v253 offset:10944
  s_waitcnt vmcnt(23)
  s_waitcnt lgkmcnt(12)
  v_mfma_f32_16x16x32_bf16 v[192:195], v[164:167], v[80:83], v[192:195]
  ds_read_b64_tr_b16 v[160:161], v253 offset:14336
  v_mfma_f32_16x16x32_bf16 v[196:199], v[164:167], v[84:87], v[196:199]
  ds_read_b64_tr_b16 v[162:163], v253 offset:17920
  s_waitcnt lgkmcnt(12)
  v_mfma_f32_16x16x32_bf16 v[200:203], v[136:139], v[80:83], v[200:203]
  ds_read_b64_tr_b16 v[164:165], v253 offset:14368
  v_mfma_f32_16x16x32_bf16 v[204:207], v[136:139], v[84:87], v[204:207]
  ds_read_b64_tr_b16 v[166:167], v253 offset:17952
  buffer_load_dwordx4 a[152:155], v250, s[20:23], s55 offen
  s_add_u32 s55, s55, 8192
  buffer_load_dwordx4 a[156:159], v250, s[20:23], s55 offen
  s_add_u32 s55, s55, 8192
  s_waitcnt lgkmcnt(12)
  v_mfma_f32_16x16x32_bf16 v[208:211], v[140:143], v[80:83], v[208:211]
  ds_read_b64_tr_b16 v[136:137], v253 offset:14400
  v_mfma_f32_16x16x32_bf16 v[212:215], v[140:143], v[84:87], v[212:215]
  ds_read_b64_tr_b16 v[138:139], v253 offset:17984
  s_waitcnt lgkmcnt(12)
  v_mfma_f32_16x16x32_bf16 v[216:219], v[144:147], v[80:83], v[216:219]
  ds_read_b64_tr_b16 v[140:141], v253 offset:14432
  v_mfma_f32_16x16x32_bf16 v[220:223], v[144:147], v[84:87], v[220:223]
  ds_read_b64_tr_b16 v[142:143], v253 offset:18016
  s_waitcnt lgkmcnt(12)
  v_mfma_f32_16x16x32_bf16 v[224:227], v[148:151], v[80:83], v[224:227]
  ds_read_b64_tr_b16 v[144:145], v253 offset:14464
  v_mfma_f32_16x16x32_bf16 v[228:231], v[148:151], v[84:87], v[228:231]
  ds_read_b64_tr_b16 v[146:147], v253 offset:18048
  buffer_load_dwordx4 a[160:163], v250, s[20:23], s55 offen
  s_add_u32 s55, s55, 8192
  buffer_load_dwordx4 a[164:167], v250, s[20:23], s55 offen
  s_add_u32 s55, s55, 8192
  s_waitcnt lgkmcnt(12)
  v_mfma_f32_16x16x32_bf16 v[232:235], v[152:155], v[80:83], v[232:235]
  ds_read_b64_tr_b16 v[148:149], v253 offset:14496
  v_mfma_f32_16x16x32_bf16 v[236:239], v[152:155], v[84:87], v[236:239]
  ds_read_b64_tr_b16 v[150:151], v253 offset:18080
  s_waitcnt lgkmcnt(12)
  v_mfma_f32_16x16x32_bf16 v[240:243], v[156:159], v[80:83], v[240:243]
  ds_read_b64_tr_b16 v[152:153], v253 offset:14528
  v_mfma_f32_16x16x32_bf16 v[244:247], v[156:159], v[84:87], v[244:247]
  ds_read_b64_tr_b16 v[154:155], v253 offset:18112
  s_waitcnt vmcnt(25)
  s_waitcnt lgkmcnt(12)
  v_mfma_f32_16x16x32_bf16 v[192:195], v[160:163], v[88:91], v[192:195]
  ds_read_b64_tr_b16 v[156:157], v253 offset:21504
  v_mfma_f32_16x16x32_bf16 v[196:199], v[160:163], v[92:95], v[196:199]
  ds_read_b64_tr_b16 v[158:159], v253 offset:25088
  s_waitcnt lgkmcnt(12)
  v_mfma_f32_16x16x32_bf16 v[200:203], v[164:167], v[88:91], v[200:203]
  ds_read_b64_tr_b16 v[160:161], v253 offset:21536
  v_mfma_f32_16x16x32_bf16 v[204:207], v[164:167], v[92:95], v[204:207]
  ds_read_b64_tr_b16 v[162:163], v253 offset:25120
  buffer_load_dwordx4 a[168:171], v250, s[20:23], s55 offen
  s_add_u32 s55, s55, 8192
  buffer_load_dwordx4 a[172:175], v250, s[20:23], s55 offen
  s_add_u32 s55, s55, 8192
  s_waitcnt lgkmcnt(12)
  v_mfma_f32_16x16x32_bf16 v[208:211], v[136:139], v[88:91], v[208:211]
  ds_read_b64_tr_b16 v[164:165], v253 offset:21568
  v_mfma_f32_16x16x32_bf16 v[212:215], v[136:139], v[92:95], v[212:215]
  ds_read_b64_tr_b16 v[166:167], v253 offset:25152
  s_waitcnt lgkmcnt(12)
  v_mfma_f32_16x16x32_bf16 v[216:219], v[140:143], v[88:91], v[216:219]
  ds_read_b64_tr_b16 v[136:137], v253 offset:21600
  v_mfma_f32_16x16x32_bf16 v[220:223], v[140:143], v[92:95], v[220:223]
  ds_read_b64_tr_b16 v[138:139], v253 offset:25184
  s_waitcnt lgkmcnt(12)
  v_mfma_f32_16x16x32_bf16 v[224:227], v[144:147], v[88:91], v[224:227]
  ds_read_b64_tr_b16 v[140:141], v253 offset:21632
  v_mfma_f32_16x16x32_bf16 v[228:231], v[144:147], v[92:95], v[228:231]
  ds_read_b64_tr_b16 v[142:143], v253 offset:25216
  buffer_load_dwordx4 a[176:179], v250, s[20:23], s55 offen
  s_add_u32 s55, s55, 8192
  buffer_load_dwordx4 a[180:183], v250, s[20:23], s55 offen
  s_add_u32 s55, s55, 8192
  s_waitcnt lgkmcnt(12)
  v_mfma_f32_16x16x32_bf16 v[232:235], v[148:151], v[88:91], v[232:235]
  ds_read_b64_tr_b16 v[144:145], v253 offset:21664
  v_mfma_f32_16x16x32_bf16 v[236:239], v[148:151], v[92:95], v[236:239]
  ds_read_b64_tr_b16 v[146:147], v253 offset:25248
  s_waitcnt lgkmcnt(12)
  v_mfma_f32_16x16x32_bf16 v[240:243], v[152:155], v[88:91], v[240:243]
  ds_read_b64_tr_b16 v[148:149], v253 offset:21696
  v_mfma_f32_16x16x32_bf16 v[244:247], v[152:155], v[92:95], v[244:247]
  ds_read_b64_tr_b16 v[150:151], v253 offset:25280
  s_waitcnt vmcnt(27)
  s_waitcnt lgkmcnt(12)
  v_mfma_f32_16x16x32_bf16 v[192:195], v[156:159], v[96:99], v[192:195]
  ds_read_b64_tr_b16 v[152:153], v253 offset:28672
  v_mfma_f32_16x16x32_bf16 v[196:199], v[156:159], v[100:103], v[196:199]
  ds_read_b64_tr_b16 v[154:155], v253 offset:32256
  s_waitcnt lgkmcnt(12)
  v_mfma_f32_16x16x32_bf16 v[200:203], v[160:163], v[96:99], v[200:203]
  ds_read_b64_tr_b16 v[156:157], v253 offset:28704
  v_mfma_f32_16x16x32_bf16 v[204:207], v[160:163], v[100:103], v[204:207]
  ds_read_b64_tr_b16 v[158:159], v253 offset:32288
  buffer_load_dwordx4 a[184:187], v250, s[20:23], s55 offen
  s_add_u32 s55, s55, 8192
  buffer_load_dwordx4 a[188:191], v250, s[20:23], s55 offen
  s_add_u32 s55, s55, 8192
  s_waitcnt lgkmcnt(12)
  v_mfma_f32_16x16x32_bf16 v[208:211], v[164:167], v[96:99], v[208:211]
  ds_read_b64_tr_b16 v[160:161], v253 offset:28736
  v_mfma_f32_16x16x32_bf16 v[212:215], v[164:167], v[100:103], v[212:215]
  ds_read_b64_tr_b16 v[162:163], v253 offset:32320
  s_waitcnt lgkmcnt(12)
  v_mfma_f32_16x16x32_bf16 v[216:219], v[136:139], v[96:99], v[216:219]
  ds_read_b64_tr_b16 v[164:165], v253 offset:28768
  v_mfma_f32_16x16x32_bf16 v[220:223], v[136:139], v[100:103], v[220:223]
  ds_read_b64_tr_b16 v[166:167], v253 offset:32352
  s_waitcnt lgkmcnt(12)
  v_mfma_f32_16x16x32_bf16 v[224:227], v[140:143], v[96:99], v[224:227]
  ds_read_b64_tr_b16 v[136:137], v253 offset:28800
  v_mfma_f32_16x16x32_bf16 v[228:231], v[140:143], v[100:103], v[228:231]
  ds_read_b64_tr_b16 v[138:139], v253 offset:32384
  buffer_load_dwordx4 a[192:195], v250, s[20:23], s55 offen
  s_add_u32 s55, s55, 8192
  buffer_load_dwordx4 a[196:199], v250, s[20:23], s55 offen
  s_add_u32 s55, s55, 8192
  s_waitcnt lgkmcnt(12)
  v_mfma_f32_16x16x32_bf16 v[232:235], v[144:147], v[96:99], v[232:235]
  ds_read_b64_tr_b16 v[140:141], v253 offset:28832
  v_mfma_f32_16x16x32_bf16 v[236:239], v[144:147], v[100:103], v[236:239]
  ds_read_b64_tr_b16 v[142:143], v253 offset:32416
  s_waitcnt lgkmcnt(12)
  v_mfma_f32_16x16x32_bf16 v[240:243], v[148:151], v[96:99], v[240:243]
  ds_read_b64_tr_b16 v[144:145], v253 offset:28864
  v_mfma_f32_16x16x32_bf16 v[244:247], v[148:151], v[100:103], v[244:247]
  ds_read_b64_tr_b16 v[146:147], v253 offset:32448
  s_waitcnt vmcnt(29)
  s_mul_i32 s47, s46, 229376
  s_and_b32 s48, s41, 1
  s_mul_i32 s48, s48, 114688
  s_add_u32 s47, s47, s48
  s_mul_i32 s48, s40, 7
  s_lshr_b32 s48, s48, 1
  s_lshl_b32 s48, s48, 10
  s_add_u32 s47, s47, s48
  s_add_u32 s47, s47, 10485760
  s_add_u32 s48, s47, 57344
  v_lshlrev_b32 v249, 3, v0
  s_waitcnt lgkmcnt(12)
  v_mfma_f32_16x16x32_bf16 v[192:195], v[152:155], v[104:107], v[192:195]
  ds_read_b64_tr_b16 v[148:149], v253 offset:35840
  v_mfma_f32_16x16x32_bf16 v[196:199], v[152:155], v[108:111], v[196:199]
  ds_read_b64_tr_b16 v[150:151], v253 offset:39424
  s_waitcnt lgkmcnt(12)
  v_mfma_f32_16x16x32_bf16 v[200:203], v[156:159], v[104:107], v[200:203]
  ds_read_b64_tr_b16 v[152:153], v253 offset:35872
  v_mfma_f32_16x16x32_bf16 v[204:207], v[156:159], v[108:111], v[204:207]
  ds_read_b64_tr_b16 v[154:155], v253 offset:39456
  buffer_load_dwordx4 a[200:203], v250, s[20:23], s55 offen
  s_add_u32 s55, s55, 8192
  buffer_load_dwordx4 a[204:207], v250, s[20:23], s55 offen
  s_add_u32 s55, s55, 8192
  s_waitcnt lgkmcnt(12)
  v_mfma_f32_16x16x32_bf16 v[208:211], v[160:163], v[104:107], v[208:211]
  ds_read_b64_tr_b16 v[156:157], v253 offset:35904
  v_mfma_f32_16x16x32_bf16 v[212:215], v[160:163], v[108:111], v[212:215]
  ds_read_b64_tr_b16 v[158:159], v253 offset:39488
  s_waitcnt lgkmcnt(12)
  v_mfma_f32_16x16x32_bf16 v[216:219], v[164:167], v[104:107], v[216:219]
  ds_read_b64_tr_b16 v[160:161], v253 offset:35936
  v_mfma_f32_16x16x32_bf16 v[220:223], v[164:167], v[108:111], v[220:223]
  ds_read_b64_tr_b16 v[162:163], v253 offset:39520
  s_waitcnt lgkmcnt(12)
  v_mfma_f32_16x16x32_bf16 v[224:227], v[136:139], v[104:107], v[224:227]
  ds_read_b64_tr_b16 v[164:165], v253 offset:35968
  v_mfma_f32_16x16x32_bf16 v[228:231], v[136:139], v[108:111], v[228:231]
  ds_read_b64_tr_b16 v[166:167], v253 offset:39552
  buffer_load_dwordx4 a[208:211], v250, s[20:23], s55 offen
  s_add_u32 s55, s55, 8192
  buffer_load_dwordx4 a[212:215], v250, s[20:23], s55 offen
  s_add_u32 s55, s55, 8192
  s_waitcnt lgkmcnt(12)
  v_mfma_f32_16x16x32_bf16 v[232:235], v[140:143], v[104:107], v[232:235]
  ds_read_b64_tr_b16 v[136:137], v253 offset:36000
  v_mfma_f32_16x16x32_bf16 v[236:239], v[140:143], v[108:111], v[236:239]
  ds_read_b64_tr_b16 v[138:139], v253 offset:39584
  s_waitcnt lgkmcnt(12)
  v_mfma_f32_16x16x32_bf16 v[240:243], v[144:147], v[104:107], v[240:243]
  ds_read_b64_tr_b16 v[140:141], v253 offset:36032
  v_mfma_f32_16x16x32_bf16 v[244:247], v[144:147], v[108:111], v[244:247]
  ds_read_b64_tr_b16 v[142:143], v253 offset:39616
  s_waitcnt vmcnt(31)
  s_waitcnt lgkmcnt(12)
  v_mfma_f32_16x16x32_bf16 v[192:195], v[148:151], v[112:115], v[192:195]
  ds_read_b64_tr_b16 v[144:145], v253 offset:43008
  v_mfma_f32_16x16x32_bf16 v[196:199], v[148:151], v[116:119], v[196:199]
  ds_read_b64_tr_b16 v[146:147], v253 offset:46592
  s_waitcnt lgkmcnt(12)
  v_mfma_f32_16x16x32_bf16 v[200:203], v[152:155], v[112:115], v[200:203]
  ds_read_b64_tr_b16 v[148:149], v253 offset:43040
  v_mfma_f32_16x16x32_bf16 v[204:207], v[152:155], v[116:119], v[204:207]
  ds_read_b64_tr_b16 v[150:151], v253 offset:46624
  buffer_load_dwordx4 a[216:219], v250, s[20:23], s55 offen
  s_add_u32 s55, s55, 8192
  buffer_load_dwordx4 a[220:223], v250, s[20:23], s55 offen
  s_add_u32 s55, s55, 8192
  s_waitcnt lgkmcnt(12)
  v_mfma_f32_16x16x32_bf16 v[208:211], v[156:159], v[112:115], v[208:211]
  ds_read_b64_tr_b16 v[152:153], v253 offset:43072
  v_mfma_f32_16x16x32_bf16 v[212:215], v[156:159], v[116:119], v[212:215]
  ds_read_b64_tr_b16 v[154:155], v253 offset:46656
  s_waitcnt lgkmcnt(12)
  v_mfma_f32_16x16x32_bf16 v[216:219], v[160:163], v[112:115], v[216:219]
  ds_read_b64_tr_b16 v[156:157], v253 offset:43104
  v_mfma_f32_16x16x32_bf16 v[220:223], v[160:163], v[116:119], v[220:223]
  ds_read_b64_tr_b16 v[158:159], v253 offset:46688
  s_waitcnt lgkmcnt(12)
  v_mfma_f32_16x16x32_bf16 v[224:227], v[164:167], v[112:115], v[224:227]
  ds_read_b64_tr_b16 v[160:161], v253 offset:43136
  v_mfma_f32_16x16x32_bf16 v[228:231], v[164:167], v[116:119], v[228:231]
  ds_read_b64_tr_b16 v[162:163], v253 offset:46720
  s_waitcnt lgkmcnt(12)
  v_mfma_f32_16x16x32_bf16 v[232:235], v[136:139], v[112:115], v[232:235]
  ds_read_b64_tr_b16 v[164:165], v253 offset:43168
  v_mfma_f32_16x16x32_bf16 v[236:239], v[136:139], v[116:119], v[236:239]
  ds_read_b64_tr_b16 v[166:167], v253 offset:46752
  s_waitcnt lgkmcnt(12)
  v_mfma_f32_16x16x32_bf16 v[240:243], v[140:143], v[112:115], v[240:243]
  ds_read_b64_tr_b16 v[136:137], v253 offset:43200
  v_mfma_f32_16x16x32_bf16 v[244:247], v[140:143], v[116:119], v[244:247]
  ds_read_b64_tr_b16 v[138:139], v253 offset:46784
  s_waitcnt vmcnt(31)
  s_waitcnt lgkmcnt(12)
  v_mfma_f32_16x16x32_bf16 v[192:195], v[144:147], v[120:123], v[192:195]
  ds_read_b64_tr_b16 v[140:141], v253 offset:50176
  v_mfma_f32_16x16x32_bf16 v[196:199], v[144:147], v[124:127], v[196:199]
  ds_read_b64_tr_b16 v[142:143], v253 offset:53760
  s_waitcnt lgkmcnt(12)
  v_mfma_f32_16x16x32_bf16 v[200:203], v[148:151], v[120:123], v[200:203]
  ds_read_b64_tr_b16 v[144:145], v253 offset:50208
  v_mfma_f32_16x16x32_bf16 v[204:207], v[148:151], v[124:127], v[204:207]
  ds_read_b64_tr_b16 v[146:147], v253 offset:53792
  s_waitcnt lgkmcnt(12)
  v_mfma_f32_16x16x32_bf16 v[208:211], v[152:155], v[120:123], v[208:211]
  ds_read_b64_tr_b16 v[148:149], v253 offset:50240
  v_mfma_f32_16x16x32_bf16 v[212:215], v[152:155], v[124:127], v[212:215]
  ds_read_b64_tr_b16 v[150:151], v253 offset:53824
  s_waitcnt lgkmcnt(12)
  v_mfma_f32_16x16x32_bf16 v[216:219], v[156:159], v[120:123], v[216:219]
  ds_read_b64_tr_b16 v[152:153], v253 offset:50272
  v_mfma_f32_16x16x32_bf16 v[220:223], v[156:159], v[124:127], v[220:223]
  ds_read_b64_tr_b16 v[154:155], v253 offset:53856
  s_waitcnt lgkmcnt(12)
  v_mfma_f32_16x16x32_bf16 v[224:227], v[160:163], v[120:123], v[224:227]
  ds_read_b64_tr_b16 v[156:157], v253 offset:50304
  v_mfma_f32_16x16x32_bf16 v[228:231], v[160:163], v[124:127], v[228:231]
  ds_read_b64_tr_b16 v[158:159], v253 offset:53888
  s_waitcnt lgkmcnt(12)
  v_mfma_f32_16x16x32_bf16 v[232:235], v[164:167], v[120:123], v[232:235]
  ds_read_b64_tr_b16 v[160:161], v253 offset:50336
  v_mfma_f32_16x16x32_bf16 v[236:239], v[164:167], v[124:127], v[236:239]
  ds_read_b64_tr_b16 v[162:163], v253 offset:53920
  s_waitcnt lgkmcnt(12)
  v_mfma_f32_16x16x32_bf16 v[240:243], v[136:139], v[120:123], v[240:243]
  ds_read_b64_tr_b16 v[164:165], v253 offset:50368
  v_mfma_f32_16x16x32_bf16 v[244:247], v[136:139], v[124:127], v[244:247]
  ds_read_b64_tr_b16 v[166:167], v253 offset:53952
  s_waitcnt vmcnt(29)
  s_waitcnt lgkmcnt(12)
  v_mfma_f32_16x16x32_bf16 v[192:195], v[140:143], v[128:131], v[192:195]
  v_mfma_f32_16x16x32_bf16 v[196:199], v[140:143], v[132:135], v[196:199]
  s_waitcnt lgkmcnt(10)
  v_mfma_f32_16x16x32_bf16 v[200:203], v[144:147], v[128:131], v[200:203]
  v_mfma_f32_16x16x32_bf16 v[204:207], v[144:147], v[132:135], v[204:207]
  s_waitcnt lgkmcnt(8)
  v_mfma_f32_16x16x32_bf16 v[208:211], v[148:151], v[128:131], v[208:211]
  v_mfma_f32_16x16x32_bf16 v[212:215], v[148:151], v[132:135], v[212:215]
  s_nop 0
  v_cvt_pk_bf16_f32 v8, v192, v193
  v_cvt_pk_bf16_f32 v9, v194, v195
  v_pk_max_i16 v8, v8, 0
  v_pk_max_i16 v9, v9, 0
  v_cvt_pk_bf16_f32 v24, v196, v197
  v_cvt_pk_bf16_f32 v25, v198, v199
  v_pk_max_i16 v24, v24, 0
  v_pk_max_i16 v25, v25, 0
  s_waitcnt lgkmcnt(6)
  v_mfma_f32_16x16x32_bf16 v[216:219], v[152:155], v[128:131], v[216:219]
  v_mfma_f32_16x16x32_bf16 v[220:223], v[152:155], v[132:135], v[220:223]
  v_cvt_pk_bf16_f32 v10, v200, v201
  v_cvt_pk_bf16_f32 v11, v202, v203
  v_pk_max_i16 v10, v10, 0
  v_pk_max_i16 v11, v11, 0
  v_cvt_pk_bf16_f32 v26, v204, v205
  v_cvt_pk_bf16_f32 v27, v206, v207
  v_pk_max_i16 v26, v26, 0
  v_pk_max_i16 v27, v27, 0
  s_waitcnt lgkmcnt(4)
  v_mfma_f32_16x16x32_bf16 v[224:227], v[156:159], v[128:131], v[224:227]
  v_mfma_f32_16x16x32_bf16 v[228:231], v[156:159], v[132:135], v[228:231]
  v_cvt_pk_bf16_f32 v12, v208, v209
  v_cvt_pk_bf16_f32 v13, v210, v211
  v_pk_max_i16 v12, v12, 0
  v_pk_max_i16 v13, v13, 0
  v_cvt_pk_bf16_f32 v28, v212, v213
  v_cvt_pk_bf16_f32 v29, v214, v215
  v_pk_max_i16 v28, v28, 0
  v_pk_max_i16 v29, v29, 0
  s_waitcnt lgkmcnt(2)
  v_mfma_f32_16x16x32_bf16 v[232:235], v[160:163], v[128:131], v[232:235]
  v_mfma_f32_16x16x32_bf16 v[236:239], v[160:163], v[132:135], v[236:239]
  v_cvt_pk_bf16_f32 v14, v216, v217
  v_cvt_pk_bf16_f32 v15, v218, v219
  v_pk_max_i16 v14, v14, 0
  v_pk_max_i16 v15, v15, 0
  v_cvt_pk_bf16_f32 v30, v220, v221
  v_cvt_pk_bf16_f32 v31, v222, v223
  v_pk_max_i16 v30, v30, 0
  v_pk_max_i16 v31, v31, 0
  s_waitcnt lgkmcnt(0)
  v_mfma_f32_16x16x32_bf16 v[240:243], v[164:167], v[128:131], v[240:243]
  v_mfma_f32_16x16x32_bf16 v[244:247], v[164:167], v[132:135], v[244:247]
  v_cvt_pk_bf16_f32 v16, v224, v225
  v_cvt_pk_bf16_f32 v17, v226, v227
  v_pk_max_i16 v16, v16, 0
  v_pk_max_i16 v17, v17, 0
  v_cvt_pk_bf16_f32 v32, v228, v229
  v_cvt_pk_bf16_f32 v33, v230, v231
  v_pk_max_i16 v32, v32, 0
  v_pk_max_i16 v33, v33, 0
  v_cvt_pk_bf16_f32 v18, v232, v233
  v_cvt_pk_bf16_f32 v19, v234, v235
  v_pk_max_i16 v18, v18, 0
  v_pk_max_i16 v19, v19, 0
  v_cvt_pk_bf16_f32 v34, v236, v237
  v_cvt_pk_bf16_f32 v35, v238, v239
  v_pk_max_i16 v34, v34, 0
  v_pk_max_i16 v35, v35, 0
  v_cvt_pk_bf16_f32 v20, v240, v241
  v_cvt_pk_bf16_f32 v21, v242, v243
  v_pk_max_i16 v20, v20, 0
  v_pk_max_i16 v21, v21, 0
  v_cvt_pk_bf16_f32 v36, v244, v245
  v_cvt_pk_bf16_f32 v37, v246, v247
  v_pk_max_i16 v36, v36, 0
  v_pk_max_i16 v37, v37, 0
  s_bitcmp1_b32 s40, 0
  s_cbranch_scc1 ODD_20
  s_cmp_eq_u32 s43, 0
  s_cbranch_scc1 SLOW_22
  buffer_store_dwordx4 v[8:11], v5, s[28:31], s47 offen offset:0
  buffer_store_dwordx4 v[12:15], v5, s[28:31], s47 offen offset:1024
  buffer_store_dwordx4 v[16:19], v5, s[28:31], s47 offen offset:2048
  buffer_store_dwordx2 v[20:21], v249, s[28:31], s47 offen offset:3072
  buffer_store_dwordx4 v[24:27], v5, s[28:31], s48 offen offset:0
  buffer_store_dwordx4 v[28:31], v5, s[28:31], s48 offen offset:1024
  buffer_store_dwordx4 v[32:35], v5, s[28:31], s48 offen offset:2048
  buffer_store_dwordx2 v[36:37], v249, s[28:31], s48 offen offset:3072
  s_branch JOIN_23
SLOW_22:
  buffer_store_dwordx4 v[8:11], v5, s[28:31], s47 offen offset:0 sc1
  buffer_store_dwordx4 v[12:15], v5, s[28:31], s47 offen offset:1024 sc1
  buffer_store_dwordx4 v[16:19], v5, s[28:31], s47 offen offset:2048 sc1
  buffer_store_dwordx2 v[20:21], v249, s[28:31], s47 offen offset:3072 sc1
  buffer_store_dwordx4 v[24:27], v5, s[28:31], s48 offen offset:0 sc1
  buffer_store_dwordx4 v[28:31], v5, s[28:31], s48 offen offset:1024 sc1
  buffer_store_dwordx4 v[32:35], v5, s[28:31], s48 offen offset:2048 sc1
  buffer_store_dwordx2 v[36:37], v249, s[28:31], s48 offen offset:3072 sc1
JOIN_23:
  s_branch GJ_21
ODD_20:
  s_cmp_eq_u32 s43, 0
  s_cbranch_scc1 SLOW_24
  buffer_store_dwordx2 v[8:9], v249, s[28:31], s47 offen offset:512
  buffer_store_dwordx4 v[10:13], v5, s[28:31], s47 offen offset:1024
  buffer_store_dwordx4 v[14:17], v5, s[28:31], s47 offen offset:2048
  buffer_store_dwordx4 v[18:21], v5, s[28:31], s47 offen offset:3072
  buffer_store_dwordx2 v[24:25], v249, s[28:31], s48 offen offset:512
  buffer_store_dwordx4 v[26:29], v5, s[28:31], s48 offen offset:1024
  buffer_store_dwordx4 v[30:33], v5, s[28:31], s48 offen offset:2048
  buffer_store_dwordx4 v[34:37], v5, s[28:31], s48 offen offset:3072
  s_branch JOIN_25
SLOW_24:
  buffer_store_dwordx2 v[8:9], v249, s[28:31], s47 offen offset:512 sc1
  buffer_store_dwordx4 v[10:13], v5, s[28:31], s47 offen offset:1024 sc1
  buffer_store_dwordx4 v[14:17], v5, s[28:31], s47 offen offset:2048 sc1
  buffer_store_dwordx4 v[18:21], v5, s[28:31], s47 offen offset:3072 sc1
  buffer_store_dwordx2 v[24:25], v249, s[28:31], s48 offen offset:512 sc1
  buffer_store_dwordx4 v[26:29], v5, s[28:31], s48 offen offset:1024 sc1
  buffer_store_dwordx4 v[30:33], v5, s[28:31], s48 offen offset:2048 sc1
  buffer_store_dwordx4 v[34:37], v5, s[28:31], s48 offen offset:3072 sc1
JOIN_25:
GJ_21:
  s_lshr_b32 s54, s37, 4
  s_lshl_b32 s48, s36, 1
  s_add_u32 s54, s54, s48
  s_lshl_b32 s54, s54, 8
  s_add_u32 s54, s54, 19988480
  s_lshl_b32 s48, s40, 4
  s_add_u32 s54, s54, s48
  s_lshl_b32 s48, s41, 2
  s_add_u32 s54, s54, s48
  s_add_u32 s57, s42, 32
  v_mov_b32 v222, s57
  v_mov_b32 v223, s54
  s_waitcnt vmcnt(0)
  s_mov_b64 exec, 1
  s_cmp_eq_u32 s43, 0
  s_cbranch_scc1 SLOW_26
  buffer_store_dword v222, v223, s[28:31], 0 offen
  s_branch JOIN_27
SLOW_26:
  buffer_store_dword v222, v223, s[28:31], 0 offen sc1
JOIN_27:
  s_mov_b64 exec, -1
  s_lshl_b32 s47, s41, 12
  s_add_u32 s47, s47, 147456
  v_bfe_u32 v230, v0, 1, 2
  v_bfe_u32 v231, v0, 4, 2
  v_xor_b32 v230, v230, v231
  v_lshlrev_b32 v230, 5, v230
  v_and_b32 v231, 1, v0
  v_lshl_add_u32 v230, v231, 4, v230
  v_lshrrev_b32 v231, 3, v0
  v_lshl_add_u32 v230, v231, 7, v230
  v_add_u32 v230, s47, v230
  v_and_b32 v231, 1, v2
  v_lshrrev_b32 v232, 1, v3
  v_lshl_or_b32 v231, v231, 1, v232
  v_lshlrev_b32 v231, 5, v231
  v_lshl_add_u32 v231, v4, 3, v231
  v_lshl_add_u32 v232, v2, 2, v3
  v_lshl_add_u32 v231, v232, 7, v231
  v_add_u32 v231, s47, v231
  v_xor_b32 v232, 32, v231
  v_xor_b32 v233, 64, v231
  v_xor_b32 v234, 96, v231
  ds_write_b128 v230, a[0:3] offset:0
  ds_write_b128 v230, a[4:7] offset:1024
  ds_write_b128 v230, a[8:11] offset:2048
  ds_write_b128 v230, a[12:15] offset:3072
  ds_read_b64_tr_b16 a[0:1], v231 offset:0
  ds_read_b64_tr_b16 a[2:3], v231 offset:2048
  ds_read_b64_tr_b16 a[4:5], v232 offset:0
  ds_read_b64_tr_b16 a[6:7], v232 offset:2048
  ds_read_b64_tr_b16 a[8:9], v233 offset:0
  ds_read_b64_tr_b16 a[10:11], v233 offset:2048
  ds_read_b64_tr_b16 a[12:13], v234 offset:0
  ds_read_b64_tr_b16 a[14:15], v234 offset:2048
  ds_write_b128 v230, a[16:19] offset:0
  ds_write_b128 v230, a[20:23] offset:1024
  ds_write_b128 v230, a[24:27] offset:2048
  ds_write_b128 v230, a[28:31] offset:3072
  ds_read_b64_tr_b16 a[16:17], v231 offset:0
  ds_read_b64_tr_b16 a[18:19], v231 offset:2048
  ds_read_b64_tr_b16 a[20:21], v232 offset:0
  ds_read_b64_tr_b16 a[22:23], v232 offset:2048
  ds_read_b64_tr_b16 a[24:25], v233 offset:0
  ds_read_b64_tr_b16 a[26:27], v233 offset:2048
  ds_read_b64_tr_b16 a[28:29], v234 offset:0
  ds_read_b64_tr_b16 a[30:31], v234 offset:2048
  s_lshl_b32 s47, s38, 16
  s_lshl_b32 s48, s41, 14
  s_add_u32 s47, s47, s48
  s_lshl_b32 s48, s39, 7
  s_add_u32 s47, s47, s48
  v_lshlrev_b32 v6, 10, v1
  v_lshl_add_u32 v6, v2, 3, v6
  v_add_u32 v6, s47, v6
  v_lshlrev_b32 v5, 4, v0
  s_mul_i32 s48, s41, 12288
  s_add_u32 s48, s48, 114688
  v_bfe_u32 v226, v1, 1, 1
  v_bfe_u32 v227, v1, 3, 1
  v_lshl_or_b32 v226, v227, 1, v226
  v_and_b32 v227, 1, v2
  v_xor_b32 v226, v226, v227
  v_lshlrev_b32 v226, 5, v226
  v_lshrrev_b32 v227, 1, v2
  v_lshl_add_u32 v226, v227, 3, v226
  v_lshl_add_u32 v226, v1, 7, v226
  v_add_u32 v226, s48, v226
  v_xor_b32 v227, 64, v226
  s_lshr_b32 s47, s37, 4
  s_lshl_b32 s48, s36, 1
  s_add_u32 s47, s47, s48
  s_lshl_b32 s47, s47, 8
  s_add_u32 s47, s47, 19988480
  s_lshl_b32 s48, s41, 6
  s_add_u32 s47, s47, s48
  v_lshlrev_b32 v222, 2, v1
  v_add_u32 v222, s47, v222
  s_add_u32 s56, s42, 32
  s_mov_b32 s58, 0x40000
POLL_28:
  buffer_load_dword v223, v222, s[28:31], 0 offen sc1
  s_waitcnt vmcnt(0)
  v_cmp_ne_u32 vcc, s56, v223
  s_nop 4
  s_cbranch_vccz PD_29
  s_sub_u32 s58, s58, 1
  s_cmp_lg_u32 s58, 0
  s_cbranch_scc1 POLL_28
PD_29:
  s_mov_b32 s49, 4194304
  v_lshlrev_b32 v7, 3, v0
  s_mul_i32 s47, s38, 229376
  s_mul_i32 s48, s41, 14336
  s_add_u32 s47, s47, s48
  s_add_u32 s47, s47, 10485760
  s_add_u32 s48, s41, 0
  s_and_b32 s48, s48, 3
  s_mul_i32 s48, s48, 57344
  s_add_u32 s50, s47, s48
  s_add_u32 s48, s41, 1
  s_and_b32 s48, s48, 3
  s_mul_i32 s48, s48, 57344
  s_add_u32 s51, s47, s48
  s_add_u32 s48, s41, 2
  s_and_b32 s48, s48, 3
  s_mul_i32 s48, s48, 57344
  s_add_u32 s52, s47, s48
  s_add_u32 s48, s41, 3
  s_and_b32 s48, s48, 3
  s_mul_i32 s48, s48, 57344
  s_add_u32 s53, s47, s48
  buffer_load_dwordx4 v[72:75], v5, s[28:31], s50 offen offset:0 sc1
  buffer_load_dwordx4 v[76:79], v5, s[28:31], s51 offen offset:0 sc1
  buffer_load_dwordx4 v[80:83], v5, s[28:31], s52 offen offset:0 sc1
  buffer_load_dwordx4 v[84:87], v5, s[28:31], s53 offen offset:0 sc1
  buffer_load_dwordx4 v[88:91], v5, s[28:31], s50 offen offset:1024 sc1
  buffer_load_dwordx4 v[92:95], v5, s[28:31], s51 offen offset:1024 sc1
  buffer_load_dwordx4 v[96:99], v5, s[28:31], s52 offen offset:1024 sc1
  buffer_load_dwordx4 v[100:103], v5, s[28:31], s53 offen offset:1024 sc1
  buffer_load_dwordx4 v[104:107], v5, s[28:31], s50 offen offset:2048 sc1
  buffer_load_dwordx4 v[108:111], v5, s[28:31], s51 offen offset:2048 sc1
  buffer_load_dwordx4 v[112:115], v5, s[28:31], s52 offen offset:2048 sc1
  buffer_load_dwordx4 v[116:119], v5, s[28:31], s53 offen offset:2048 sc1
  s_waitcnt vmcnt(8) lgkmcnt(12)
  v_mfma_f32_16x16x32_bf16 v[8:11], a[0:3], v[72:75], 0
  ds_write_b128 v230, a[32:35] offset:0
  v_mfma_f32_16x16x32_bf16 v[12:15], a[4:7], v[72:75], 0
  ds_write_b128 v230, a[36:39] offset:1024
  v_mfma_f32_16x16x32_bf16 v[16:19], a[8:11], v[72:75], 0
  ds_write_b128 v230, a[40:43] offset:2048
  v_mfma_f32_16x16x32_bf16 v[20:23], a[12:15], v[72:75], 0
  ds_write_b128 v230, a[44:47] offset:3072
  v_mfma_f32_16x16x32_bf16 v[24:27], a[0:3], v[76:79], 0
  ds_read_b64_tr_b16 a[32:33], v231 offset:0
  v_mfma_f32_16x16x32_bf16 v[28:31], a[4:7], v[76:79], 0
  ds_read_b64_tr_b16 a[34:35], v231 offset:2048
  v_mfma_f32_16x16x32_bf16 v[32:35], a[8:11], v[76:79], 0
  ds_read_b64_tr_b16 a[36:37], v232 offset:0
  v_mfma_f32_16x16x32_bf16 v[36:39], a[12:15], v[76:79], 0
  ds_read_b64_tr_b16 a[38:39], v232 offset:2048
  v_mfma_f32_16x16x32_bf16 v[40:43], a[0:3], v[80:83], 0
  ds_read_b64_tr_b16 a[40:41], v233 offset:0
  v_mfma_f32_16x16x32_bf16 v[44:47], a[4:7], v[80:83], 0
  ds_read_b64_tr_b16 a[42:43], v233 offset:2048
  v_mfma_f32_16x16x32_bf16 v[48:51], a[8:11], v[80:83], 0
  ds_read_b64_tr_b16 a[44:45], v234 offset:0
  v_mfma_f32_16x16x32_bf16 v[52:55], a[12:15], v[80:83], 0
  ds_read_b64_tr_b16 a[46:47], v234 offset:2048
  v_mfma_f32_16x16x32_bf16 v[56:59], a[0:3], v[84:87], 0
  v_mfma_f32_16x16x32_bf16 v[60:63], a[4:7], v[84:87], 0
  v_mfma_f32_16x16x32_bf16 v[64:67], a[8:11], v[84:87], 0
  v_mfma_f32_16x16x32_bf16 v[68:71], a[12:15], v[84:87], 0
  buffer_load_dwordx2 v[120:121], v7, s[28:31], s50 offen offset:3072 sc1
  buffer_load_dwordx2 v[122:123], v7, s[28:31], s50 offen offset:3584 sc1
  buffer_load_dwordx2 v[124:125], v7, s[28:31], s51 offen offset:3072 sc1
  buffer_load_dwordx2 v[126:127], v7, s[28:31], s51 offen offset:3584 sc1
  buffer_load_dwordx2 v[128:129], v7, s[28:31], s52 offen offset:3072 sc1
  buffer_load_dwordx2 v[130:131], v7, s[28:31], s52 offen offset:3584 sc1
  buffer_load_dwordx2 v[132:133], v7, s[28:31], s53 offen offset:3072 sc1
  buffer_load_dwordx2 v[134:135], v7, s[28:31], s53 offen offset:3584 sc1
  s_add_u32 s50, s50, 4096
  s_add_u32 s51, s51, 4096
  s_add_u32 s52, s52, 4096
  s_add_u32 s53, s53, 4096
  buffer_load_dwordx4 v[136:139], v5, s[28:31], s50 offen offset:0 sc1
  buffer_load_dwordx4 v[140:143], v5, s[28:31], s51 offen offset:0 sc1
  buffer_load_dwordx4 v[144:147], v5, s[28:31], s52 offen offset:0 sc1
  buffer_load_dwordx4 v[148:151], v5, s[28:31], s53 offen offset:0 sc1
  s_waitcnt vmcnt(16) lgkmcnt(12)
  v_mfma_f32_16x16x32_bf16 v[8:11], a[16:19], v[88:91], v[8:11]
  ds_write_b128 v230, a[48:51] offset:0
  v_mfma_f32_16x16x32_bf16 v[12:15], a[20:23], v[88:91], v[12:15]
  ds_write_b128 v230, a[52:55] offset:1024
  v_mfma_f32_16x16x32_bf16 v[16:19], a[24:27], v[88:91], v[16:19]
  ds_write_b128 v230, a[56:59] offset:2048
  v_mfma_f32_16x16x32_bf16 v[20:23], a[28:31], v[88:91], v[20:23]
  ds_write_b128 v230, a[60:63] offset:3072
  v_mfma_f32_16x16x32_bf16 v[24:27], a[16:19], v[92:95], v[24:27]
  ds_read_b64_tr_b16 a[48:49], v231 offset:0
  v_mfma_f32_16x16x32_bf16 v[28:31], a[20:23], v[92:95], v[28:31]
  ds_read_b64_tr_b16 a[50:51], v231 offset:2048
  v_mfma_f32_16x16x32_bf16 v[32:35], a[24:27], v[92:95], v[32:35]
  ds_read_b64_tr_b16 a[52:53], v232 offset:0
  v_mfma_f32_16x16x32_bf16 v[36:39], a[28:31], v[92:95], v[36:39]
  ds_read_b64_tr_b16 a[54:55], v232 offset:2048
  v_mfma_f32_16x16x32_bf16 v[40:43], a[16:19], v[96:99], v[40:43]
  ds_read_b64_tr_b16 a[56:57], v233 offset:0
  v_mfma_f32_16x16x32_bf16 v[44:47], a[20:23], v[96:99], v[44:47]
  ds_read_b64_tr_b16 a[58:59], v233 offset:2048
  v_mfma_f32_16x16x32_bf16 v[48:51], a[24:27], v[96:99], v[48:51]
  ds_read_b64_tr_b16 a[60:61], v234 offset:0
  v_mfma_f32_16x16x32_bf16 v[52:55], a[28:31], v[96:99], v[52:55]
  ds_read_b64_tr_b16 a[62:63], v234 offset:2048
  v_mfma_f32_16x16x32_bf16 v[56:59], a[16:19], v[100:103], v[56:59]
  v_mfma_f32_16x16x32_bf16 v[60:63], a[20:23], v[100:103], v[60:63]
  v_mfma_f32_16x16x32_bf16 v[64:67], a[24:27], v[100:103], v[64:67]
  v_mfma_f32_16x16x32_bf16 v[68:71], a[28:31], v[100:103], v[68:71]
  buffer_load_dwordx4 v[152:155], v5, s[28:31], s50 offen offset:1024 sc1
  buffer_load_dwordx4 v[156:159], v5, s[28:31], s51 offen offset:1024 sc1
  buffer_load_dwordx4 v[160:163], v5, s[28:31], s52 offen offset:1024 sc1
  buffer_load_dwordx4 v[164:167], v5, s[28:31], s53 offen offset:1024 sc1
  buffer_load_dwordx4 v[168:171], v5, s[28:31], s50 offen offset:2048 sc1
  buffer_load_dwordx4 v[172:175], v5, s[28:31], s51 offen offset:2048 sc1
  buffer_load_dwordx4 v[176:179], v5, s[28:31], s52 offen offset:2048 sc1
  buffer_load_dwordx4 v[180:183], v5, s[28:31], s53 offen offset:2048 sc1
  s_waitcnt vmcnt(20) lgkmcnt(12)
  v_mfma_f32_16x16x32_bf16 v[8:11], a[32:35], v[104:107], v[8:11]
  ds_write_b128 v230, a[64:67] offset:0
  v_mfma_f32_16x16x32_bf16 v[12:15], a[36:39], v[104:107], v[12:15]
  ds_write_b128 v230, a[68:71] offset:1024
  v_mfma_f32_16x16x32_bf16 v[16:19], a[40:43], v[104:107], v[16:19]
  ds_write_b128 v230, a[72:75] offset:2048
  v_mfma_f32_16x16x32_bf16 v[20:23], a[44:47], v[104:107], v[20:23]
  ds_write_b128 v230, a[76:79] offset:3072
  v_mfma_f32_16x16x32_bf16 v[24:27], a[32:35], v[108:111], v[24:27]
  ds_read_b64_tr_b16 a[64:65], v231 offset:0
  v_mfma_f32_16x16x32_bf16 v[28:31], a[36:39], v[108:111], v[28:31]
  ds_read_b64_tr_b16 a[66:67], v231 offset:2048
  v_mfma_f32_16x16x32_bf16 v[32:35], a[40:43], v[108:111], v[32:35]
  ds_read_b64_tr_b16 a[68:69], v232 offset:0
  v_mfma_f32_16x16x32_bf16 v[36:39], a[44:47], v[108:111], v[36:39]
  ds_read_b64_tr_b16 a[70:71], v232 offset:2048
  v_mfma_f32_16x16x32_bf16 v[40:43], a[32:35], v[112:115], v[40:43]
  ds_read_b64_tr_b16 a[72:73], v233 offset:0
  v_mfma_f32_16x16x32_bf16 v[44:47], a[36:39], v[112:115], v[44:47]
  ds_read_b64_tr_b16 a[74:75], v233 offset:2048
  v_mfma_f32_16x16x32_bf16 v[48:51], a[40:43], v[112:115], v[48:51]
  ds_read_b64_tr_b16 a[76:77], v234 offset:0
  v_mfma_f32_16x16x32_bf16 v[52:55], a[44:47], v[112:115], v[52:55]
  ds_read_b64_tr_b16 a[78:79], v234 offset:2048
  v_mfma_f32_16x16x32_bf16 v[56:59], a[32:35], v[116:119], v[56:59]
  v_mfma_f32_16x16x32_bf16 v[60:63], a[36:39], v[116:119], v[60:63]
  v_mfma_f32_16x16x32_bf16 v[64:67], a[40:43], v[116:119], v[64:67]
  v_mfma_f32_16x16x32_bf16 v[68:71], a[44:47], v[116:119], v[68:71]
  buffer_load_dwordx4 v[184:187], v5, s[28:31], s50 offen offset:3072 sc1
  buffer_load_dwordx4 v[188:191], v5, s[28:31], s51 offen offset:3072 sc1
  buffer_load_dwordx4 v[192:195], v5, s[28:31], s52 offen offset:3072 sc1
  buffer_load_dwordx4 v[196:199], v5, s[28:31], s53 offen offset:3072 sc1
  s_add_u32 s50, s50, 4096
  s_add_u32 s51, s51, 4096
  s_add_u32 s52, s52, 4096
  s_add_u32 s53, s53, 4096
  buffer_load_dwordx4 v[72:75], v5, s[28:31], s50 offen offset:0 sc1
  buffer_load_dwordx4 v[76:79], v5, s[28:31], s51 offen offset:0 sc1
  buffer_load_dwordx4 v[80:83], v5, s[28:31], s52 offen offset:0 sc1
  buffer_load_dwordx4 v[84:87], v5, s[28:31], s53 offen offset:0 sc1
  s_waitcnt vmcnt(20) lgkmcnt(12)
  v_mfma_f32_16x16x32_bf16 v[8:11], a[48:51], v[120:123], v[8:11]
  ds_write_b128 v230, a[80:83] offset:0
  v_mfma_f32_16x16x32_bf16 v[12:15], a[52:55], v[120:123], v[12:15]
  ds_write_b128 v230, a[84:87] offset:1024
  v_mfma_f32_16x16x32_bf16 v[16:19], a[56:59], v[120:123], v[16:19]
  ds_write_b128 v230, a[88:91] offset:2048
  v_mfma_f32_16x16x32_bf16 v[20:23], a[60:63], v[120:123], v[20:23]
  ds_write_b128 v230, a[92:95] offset:3072
  v_mfma_f32_16x16x32_bf16 v[24:27], a[48:51], v[124:127], v[24:27]
  ds_read_b64_tr_b16 a[80:81], v231 offset:0
  v_mfma_f32_16x16x32_bf16 v[28:31], a[52:55], v[124:127], v[28:31]
  ds_read_b64_tr_b16 a[82:83], v231 offset:2048
  v_mfma_f32_16x16x32_bf16 v[32:35], a[56:59], v[124:127], v[32:35]
  ds_read_b64_tr_b16 a[84:85], v232 offset:0
  v_mfma_f32_16x16x32_bf16 v[36:39], a[60:63], v[124:127], v[36:39]
  ds_read_b64_tr_b16 a[86:87], v232 offset:2048
  v_mfma_f32_16x16x32_bf16 v[40:43], a[48:51], v[128:131], v[40:43]
  ds_read_b64_tr_b16 a[88:89], v233 offset:0
  v_mfma_f32_16x16x32_bf16 v[44:47], a[52:55], v[128:131], v[44:47]
  ds_read_b64_tr_b16 a[90:91], v233 offset:2048
  v_mfma_f32_16x16x32_bf16 v[48:51], a[56:59], v[128:131], v[48:51]
  ds_read_b64_tr_b16 a[92:93], v234 offset:0
  v_mfma_f32_16x16x32_bf16 v[52:55], a[60:63], v[128:131], v[52:55]
  ds_read_b64_tr_b16 a[94:95], v234 offset:2048
  v_mfma_f32_16x16x32_bf16 v[56:59], a[48:51], v[132:135], v[56:59]
  v_mfma_f32_16x16x32_bf16 v[60:63], a[52:55], v[132:135], v[60:63]
  v_mfma_f32_16x16x32_bf16 v[64:67], a[56:59], v[132:135], v[64:67]
  v_mfma_f32_16x16x32_bf16 v[68:71], a[60:63], v[132:135], v[68:71]
  buffer_load_dwordx4 v[88:91], v5, s[28:31], s50 offen offset:1024 sc1
  buffer_load_dwordx4 v[92:95], v5, s[28:31], s51 offen offset:1024 sc1
  buffer_load_dwordx4 v[96:99], v5, s[28:31], s52 offen offset:1024 sc1
  buffer_load_dwordx4 v[100:103], v5, s[28:31], s53 offen offset:1024 sc1
  buffer_load_dwordx2 v[104:105], v7, s[28:31], s50 offen offset:2048 sc1
  buffer_load_dwordx2 v[106:107], v7, s[28:31], s50 offen offset:2560 sc1
  buffer_load_dwordx2 v[108:109], v7, s[28:31], s51 offen offset:2048 sc1
  buffer_load_dwordx2 v[110:111], v7, s[28:31], s51 offen offset:2560 sc1
  buffer_load_dwordx2 v[112:113], v7, s[28:31], s52 offen offset:2048 sc1
  buffer_load_dwordx2 v[114:115], v7, s[28:31], s52 offen offset:2560 sc1
  buffer_load_dwordx2 v[116:117], v7, s[28:31], s53 offen offset:2048 sc1
  buffer_load_dwordx2 v[118:119], v7, s[28:31], s53 offen offset:2560 sc1
  s_waitcnt vmcnt(28) lgkmcnt(12)
  v_mfma_f32_16x16x32_bf16 v[8:11], a[64:67], v[136:139], v[8:11]
  ds_write_b128 v230, a[96:99] offset:0
  v_mfma_f32_16x16x32_bf16 v[12:15], a[68:71], v[136:139], v[12:15]
  ds_write_b128 v230, a[100:103] offset:1024
  v_mfma_f32_16x16x32_bf16 v[16:19], a[72:75], v[136:139], v[16:19]
  ds_write_b128 v230, a[104:107] offset:2048
  v_mfma_f32_16x16x32_bf16 v[20:23], a[76:79], v[136:139], v[20:23]
  ds_write_b128 v230, a[108:111] offset:3072
  v_mfma_f32_16x16x32_bf16 v[24:27], a[64:67], v[140:143], v[24:27]
  ds_read_b64_tr_b16 a[96:97], v231 offset:0
  v_mfma_f32_16x16x32_bf16 v[28:31], a[68:71], v[140:143], v[28:31]
  ds_read_b64_tr_b16 a[98:99], v231 offset:2048
  v_mfma_f32_16x16x32_bf16 v[32:35], a[72:75], v[140:143], v[32:35]
  ds_read_b64_tr_b16 a[100:101], v232 offset:0
  v_mfma_f32_16x16x32_bf16 v[36:39], a[76:79], v[140:143], v[36:39]
  ds_read_b64_tr_b16 a[102:103], v232 offset:2048
  v_mfma_f32_16x16x32_bf16 v[40:43], a[64:67], v[144:147], v[40:43]
  ds_read_b64_tr_b16 a[104:105], v233 offset:0
  v_mfma_f32_16x16x32_bf16 v[44:47], a[68:71], v[144:147], v[44:47]
  ds_read_b64_tr_b16 a[106:107], v233 offset:2048
  v_mfma_f32_16x16x32_bf16 v[48:51], a[72:75], v[144:147], v[48:51]
  ds_read_b64_tr_b16 a[108:109], v234 offset:0
  v_mfma_f32_16x16x32_bf16 v[52:55], a[76:79], v[144:147], v[52:55]
  ds_read_b64_tr_b16 a[110:111], v234 offset:2048
  v_mfma_f32_16x16x32_bf16 v[56:59], a[64:67], v[148:151], v[56:59]
  v_mfma_f32_16x16x32_bf16 v[60:63], a[68:71], v[148:151], v[60:63]
  v_mfma_f32_16x16x32_bf16 v[64:67], a[72:75], v[148:151], v[64:67]
  v_mfma_f32_16x16x32_bf16 v[68:71], a[76:79], v[148:151], v[68:71]
  buffer_load_dwordx4 v[120:123], v5, s[28:31], s50 offen offset:3072 sc1
  buffer_load_dwordx4 v[124:127], v5, s[28:31], s51 offen offset:3072 sc1
  buffer_load_dwordx4 v[128:131], v5, s[28:31], s52 offen offset:3072 sc1
  buffer_load_dwordx4 v[132:135], v5, s[28:31], s53 offen offset:3072 sc1
  s_add_u32 s50, s50, 4096
  s_add_u32 s51, s51, 4096
  s_add_u32 s52, s52, 4096
  s_add_u32 s53, s53, 4096
  buffer_load_dwordx4 v[136:139], v5, s[28:31], s50 offen offset:0 sc1
  buffer_load_dwordx4 v[140:143], v5, s[28:31], s51 offen offset:0 sc1
  buffer_load_dwordx4 v[144:147], v5, s[28:31], s52 offen offset:0 sc1
  buffer_load_dwordx4 v[148:151], v5, s[28:31], s53 offen offset:0 sc1
  s_waitcnt vmcnt(32) lgkmcnt(12)
  v_mfma_f32_16x16x32_bf16 v[8:11], a[80:83], v[152:155], v[8:11]
  ds_write_b128 v230, a[112:115] offset:0
  v_mfma_f32_16x16x32_bf16 v[12:15], a[84:87], v[152:155], v[12:15]
  ds_write_b128 v230, a[116:119] offset:1024
  v_mfma_f32_16x16x32_bf16 v[16:19], a[88:91], v[152:155], v[16:19]
  ds_write_b128 v230, a[120:123] offset:2048
  v_mfma_f32_16x16x32_bf16 v[20:23], a[92:95], v[152:155], v[20:23]
  ds_write_b128 v230, a[124:127] offset:3072
  v_mfma_f32_16x16x32_bf16 v[24:27], a[80:83], v[156:159], v[24:27]
  ds_read_b64_tr_b16 a[112:113], v231 offset:0
  v_mfma_f32_16x16x32_bf16 v[28:31], a[84:87], v[156:159], v[28:31]
  ds_read_b64_tr_b16 a[114:115], v231 offset:2048
  v_mfma_f32_16x16x32_bf16 v[32:35], a[88:91], v[156:159], v[32:35]
  ds_read_b64_tr_b16 a[116:117], v232 offset:0
  v_mfma_f32_16x16x32_bf16 v[36:39], a[92:95], v[156:159], v[36:39]
  ds_read_b64_tr_b16 a[118:119], v232 offset:2048
  v_mfma_f32_16x16x32_bf16 v[40:43], a[80:83], v[160:163], v[40:43]
  ds_read_b64_tr_b16 a[120:121], v233 offset:0
  v_mfma_f32_16x16x32_bf16 v[44:47], a[84:87], v[160:163], v[44:47]
  ds_read_b64_tr_b16 a[122:123], v233 offset:2048
  v_mfma_f32_16x16x32_bf16 v[48:51], a[88:91], v[160:163], v[48:51]
  ds_read_b64_tr_b16 a[124:125], v234 offset:0
  v_mfma_f32_16x16x32_bf16 v[52:55], a[92:95], v[160:163], v[52:55]
  ds_read_b64_tr_b16 a[126:127], v234 offset:2048
  v_mfma_f32_16x16x32_bf16 v[56:59], a[80:83], v[164:167], v[56:59]
  v_mfma_f32_16x16x32_bf16 v[60:63], a[84:87], v[164:167], v[60:63]
  v_mfma_f32_16x16x32_bf16 v[64:67], a[88:91], v[164:167], v[64:67]
  v_mfma_f32_16x16x32_bf16 v[68:71], a[92:95], v[164:167], v[68:71]
  buffer_load_dwordx4 v[152:155], v5, s[28:31], s50 offen offset:1024 sc1
  buffer_load_dwordx4 v[156:159], v5, s[28:31], s51 offen offset:1024 sc1
  buffer_load_dwordx4 v[160:163], v5, s[28:31], s52 offen offset:1024 sc1
  buffer_load_dwordx4 v[164:167], v5, s[28:31], s53 offen offset:1024 sc1
  s_waitcnt vmcnt(32) lgkmcnt(12)
  v_mfma_f32_16x16x32_bf16 v[8:11], a[96:99], v[168:171], v[8:11]
  ds_write_b128 v230, a[128:131] offset:0
  v_mfma_f32_16x16x32_bf16 v[12:15], a[100:103], v[168:171], v[12:15]
  ds_write_b128 v230, a[132:135] offset:1024
  v_mfma_f32_16x16x32_bf16 v[16:19], a[104:107], v[168:171], v[16:19]
  ds_write_b128 v230, a[136:139] offset:2048
  v_mfma_f32_16x16x32_bf16 v[20:23], a[108:111], v[168:171], v[20:23]
  ds_write_b128 v230, a[140:143] offset:3072
  v_mfma_f32_16x16x32_bf16 v[24:27], a[96:99], v[172:175], v[24:27]
  ds_read_b64_tr_b16 a[128:129], v231 offset:0
  v_mfma_f32_16x16x32_bf16 v[28:31], a[100:103], v[172:175], v[28:31]
  ds_read_b64_tr_b16 a[130:131], v231 offset:2048
  v_mfma_f32_16x16x32_bf16 v[32:35], a[104:107], v[172:175], v[32:35]
  ds_read_b64_tr_b16 a[132:133], v232 offset:0
  v_mfma_f32_16x16x32_bf16 v[36:39], a[108:111], v[172:175], v[36:39]
  ds_read_b64_tr_b16 a[134:135], v232 offset:2048
  v_mfma_f32_16x16x32_bf16 v[40:43], a[96:99], v[176:179], v[40:43]
  ds_read_b64_tr_b16 a[136:137], v233 offset:0
  v_mfma_f32_16x16x32_bf16 v[44:47], a[100:103], v[176:179], v[44:47]
  ds_read_b64_tr_b16 a[138:139], v233 offset:2048
  v_mfma_f32_16x16x32_bf16 v[48:51], a[104:107], v[176:179], v[48:51]
  ds_read_b64_tr_b16 a[140:141], v234 offset:0
  v_mfma_f32_16x16x32_bf16 v[52:55], a[108:111], v[176:179], v[52:55]
  ds_read_b64_tr_b16 a[142:143], v234 offset:2048
  v_mfma_f32_16x16x32_bf16 v[56:59], a[96:99], v[180:183], v[56:59]
  v_mfma_f32_16x16x32_bf16 v[60:63], a[100:103], v[180:183], v[60:63]
  v_mfma_f32_16x16x32_bf16 v[64:67], a[104:107], v[180:183], v[64:67]
  v_mfma_f32_16x16x32_bf16 v[68:71], a[108:111], v[180:183], v[68:71]
  buffer_load_dwordx2 v[200:201], v6, s[28:31], s49 offen offset:0 sc1
  buffer_load_dwordx2 v[202:203], v6, s[28:31], s49 offen offset:32 sc1
  buffer_load_dwordx2 v[204:205], v6, s[28:31], s49 offen offset:64 sc1
  buffer_load_dwordx2 v[206:207], v6, s[28:31], s49 offen offset:96 sc1
  s_lshr_b32 s47, s41, 1
  s_lshl_b32 s47, s47, 12
  v_lshlrev_b32 v228, 4, v0
  v_add_u32 v228, s47, v228
  global_load_dwordx4 v[208:211], v228, s[44:45] offset:0
  global_load_dwordx4 v[212:215], v228, s[44:45] offset:1024
  global_load_dwordx4 v[216:219], v228, s[44:45] offset:2048
  global_load_dwordx4 v[220:223], v228, s[44:45] offset:3072
  s_waitcnt vmcnt(36) lgkmcnt(12)
  v_mfma_f32_16x16x32_bf16 v[8:11], a[112:115], v[184:187], v[8:11]
  ds_write_b128 v230, a[144:147] offset:0
  v_mfma_f32_16x16x32_bf16 v[12:15], a[116:119], v[184:187], v[12:15]
  ds_write_b128 v230, a[148:151] offset:1024
  v_mfma_f32_16x16x32_bf16 v[16:19], a[120:123], v[184:187], v[16:19]
  ds_write_b128 v230, a[152:155] offset:2048
  v_mfma_f32_16x16x32_bf16 v[20:23], a[124:127], v[184:187], v[20:23]
  ds_write_b128 v230, a[156:159] offset:3072
  v_mfma_f32_16x16x32_bf16 v[24:27], a[112:115], v[188:191], v[24:27]
  ds_read_b64_tr_b16 a[144:145], v231 offset:0
  v_mfma_f32_16x16x32_bf16 v[28:31], a[116:119], v[188:191], v[28:31]
  ds_read_b64_tr_b16 a[146:147], v231 offset:2048
  v_mfma_f32_16x16x32_bf16 v[32:35], a[120:123], v[188:191], v[32:35]
  ds_read_b64_tr_b16 a[148:149], v232 offset:0
  v_mfma_f32_16x16x32_bf16 v[36:39], a[124:127], v[188:191], v[36:39]
  ds_read_b64_tr_b16 a[150:151], v232 offset:2048
  v_mfma_f32_16x16x32_bf16 v[40:43], a[112:115], v[192:195], v[40:43]
  ds_read_b64_tr_b16 a[152:153], v233 offset:0
  v_mfma_f32_16x16x32_bf16 v[44:47], a[116:119], v[192:195], v[44:47]
  ds_read_b64_tr_b16 a[154:155], v233 offset:2048
  v_mfma_f32_16x16x32_bf16 v[48:51], a[120:123], v[192:195], v[48:51]
  ds_read_b64_tr_b16 a[156:157], v234 offset:0
  v_mfma_f32_16x16x32_bf16 v[52:55], a[124:127], v[192:195], v[52:55]
  ds_read_b64_tr_b16 a[158:159], v234 offset:2048
  v_mfma_f32_16x16x32_bf16 v[56:59], a[112:115], v[196:199], v[56:59]
  v_mfma_f32_16x16x32_bf16 v[60:63], a[116:119], v[196:199], v[60:63]
  v_mfma_f32_16x16x32_bf16 v[64:67], a[120:123], v[196:199], v[64:67]
  v_mfma_f32_16x16x32_bf16 v[68:71], a[124:127], v[196:199], v[68:71]
  s_waitcnt vmcnt(32) lgkmcnt(12)
  v_mfma_f32_16x16x32_bf16 v[8:11], a[128:131], v[72:75], v[8:11]
  ds_write_b128 v230, a[160:163] offset:0
  v_mfma_f32_16x16x32_bf16 v[12:15], a[132:135], v[72:75], v[12:15]
  ds_write_b128 v230, a[164:167] offset:1024
  v_mfma_f32_16x16x32_bf16 v[16:19], a[136:139], v[72:75], v[16:19]
  ds_write_b128 v230, a[168:171] offset:2048
  v_mfma_f32_16x16x32_bf16 v[20:23], a[140:143], v[72:75], v[20:23]
  ds_write_b128 v230, a[172:175] offset:3072
  v_mfma_f32_16x16x32_bf16 v[24:27], a[128:131], v[76:79], v[24:27]
  ds_read_b64_tr_b16 a[160:161], v231 offset:0
  v_mfma_f32_16x16x32_bf16 v[28:31], a[132:135], v[76:79], v[28:31]
  ds_read_b64_tr_b16 a[162:163], v231 offset:2048
  v_mfma_f32_16x16x32_bf16 v[32:35], a[136:139], v[76:79], v[32:35]
  ds_read_b64_tr_b16 a[164:165], v232 offset:0
  v_mfma_f32_16x16x32_bf16 v[36:39], a[140:143], v[76:79], v[36:39]
  ds_read_b64_tr_b16 a[166:167], v232 offset:2048
  v_mfma_f32_16x16x32_bf16 v[40:43], a[128:131], v[80:83], v[40:43]
  ds_read_b64_tr_b16 a[168:169], v233 offset:0
  v_mfma_f32_16x16x32_bf16 v[44:47], a[132:135], v[80:83], v[44:47]
  ds_read_b64_tr_b16 a[170:171], v233 offset:2048
  v_mfma_f32_16x16x32_bf16 v[48:51], a[136:139], v[80:83], v[48:51]
  ds_read_b64_tr_b16 a[172:173], v234 offset:0
  v_mfma_f32_16x16x32_bf16 v[52:55], a[140:143], v[80:83], v[52:55]
  ds_read_b64_tr_b16 a[174:175], v234 offset:2048
  v_mfma_f32_16x16x32_bf16 v[56:59], a[128:131], v[84:87], v[56:59]
  v_mfma_f32_16x16x32_bf16 v[60:63], a[132:135], v[84:87], v[60:63]
  v_mfma_f32_16x16x32_bf16 v[64:67], a[136:139], v[84:87], v[64:67]
  v_mfma_f32_16x16x32_bf16 v[68:71], a[140:143], v[84:87], v[68:71]
  s_waitcnt vmcnt(28) lgkmcnt(12)
  v_mfma_f32_16x16x32_bf16 v[8:11], a[144:147], v[88:91], v[8:11]
  ds_write_b128 v230, a[176:179] offset:0
  v_mfma_f32_16x16x32_bf16 v[12:15], a[148:151], v[88:91], v[12:15]
  ds_write_b128 v230, a[180:183] offset:1024
  v_mfma_f32_16x16x32_bf16 v[16:19], a[152:155], v[88:91], v[16:19]
  ds_write_b128 v230, a[184:187] offset:2048
  v_mfma_f32_16x16x32_bf16 v[20:23], a[156:159], v[88:91], v[20:23]
  ds_write_b128 v230, a[188:191] offset:3072
  v_mfma_f32_16x16x32_bf16 v[24:27], a[144:147], v[92:95], v[24:27]
  ds_read_b64_tr_b16 a[176:177], v231 offset:0
  v_mfma_f32_16x16x32_bf16 v[28:31], a[148:151], v[92:95], v[28:31]
  ds_read_b64_tr_b16 a[178:179], v231 offset:2048
  v_mfma_f32_16x16x32_bf16 v[32:35], a[152:155], v[92:95], v[32:35]
  ds_read_b64_tr_b16 a[180:181], v232 offset:0
  v_mfma_f32_16x16x32_bf16 v[36:39], a[156:159], v[92:95], v[36:39]
  ds_read_b64_tr_b16 a[182:183], v232 offset:2048
  v_mfma_f32_16x16x32_bf16 v[40:43], a[144:147], v[96:99], v[40:43]
  ds_read_b64_tr_b16 a[184:185], v233 offset:0
  v_mfma_f32_16x16x32_bf16 v[44:47], a[148:151], v[96:99], v[44:47]
  ds_read_b64_tr_b16 a[186:187], v233 offset:2048
  v_mfma_f32_16x16x32_bf16 v[48:51], a[152:155], v[96:99], v[48:51]
  ds_read_b64_tr_b16 a[188:189], v234 offset:0
  v_mfma_f32_16x16x32_bf16 v[52:55], a[156:159], v[96:99], v[52:55]
  ds_read_b64_tr_b16 a[190:191], v234 offset:2048
  v_mfma_f32_16x16x32_bf16 v[56:59], a[144:147], v[100:103], v[56:59]
  v_mfma_f32_16x16x32_bf16 v[60:63], a[148:151], v[100:103], v[60:63]
  v_mfma_f32_16x16x32_bf16 v[64:67], a[152:155], v[100:103], v[64:67]
  v_mfma_f32_16x16x32_bf16 v[68:71], a[156:159], v[100:103], v[68:71]
  s_waitcnt vmcnt(20) lgkmcnt(12)
  v_mfma_f32_16x16x32_bf16 v[8:11], a[160:163], v[104:107], v[8:11]
  ds_write_b128 v230, a[192:195] offset:0
  v_mfma_f32_16x16x32_bf16 v[12:15], a[164:167], v[104:107], v[12:15]
  ds_write_b128 v230, a[196:199] offset:1024
  v_mfma_f32_16x16x32_bf16 v[16:19], a[168:171], v[104:107], v[16:19]
  ds_write_b128 v230, a[200:203] offset:2048
  v_mfma_f32_16x16x32_bf16 v[20:23], a[172:175], v[104:107], v[20:23]
  ds_write_b128 v230, a[204:207] offset:3072
  v_mfma_f32_16x16x32_bf16 v[24:27], a[160:163], v[108:111], v[24:27]
  ds_read_b64_tr_b16 a[192:193], v231 offset:0
  v_mfma_f32_16x16x32_bf16 v[28:31], a[164:167], v[108:111], v[28:31]
  ds_read_b64_tr_b16 a[194:195], v231 offset:2048
  v_mfma_f32_16x16x32_bf16 v[32:35], a[168:171], v[108:111], v[32:35]
  ds_read_b64_tr_b16 a[196:197], v232 offset:0
  v_mfma_f32_16x16x32_bf16 v[36:39], a[172:175], v[108:111], v[36:39]
  ds_read_b64_tr_b16 a[198:199], v232 offset:2048
  v_mfma_f32_16x16x32_bf16 v[40:43], a[160:163], v[112:115], v[40:43]
  ds_read_b64_tr_b16 a[200:201], v233 offset:0
  v_mfma_f32_16x16x32_bf16 v[44:47], a[164:167], v[112:115], v[44:47]
  ds_read_b64_tr_b16 a[202:203], v233 offset:2048
  v_mfma_f32_16x16x32_bf16 v[48:51], a[168:171], v[112:115], v[48:51]
  ds_read_b64_tr_b16 a[204:205], v234 offset:0
  v_mfma_f32_16x16x32_bf16 v[52:55], a[172:175], v[112:115], v[52:55]
  ds_read_b64_tr_b16 a[206:207], v234 offset:2048
  v_mfma_f32_16x16x32_bf16 v[56:59], a[160:163], v[116:119], v[56:59]
  v_mfma_f32_16x16x32_bf16 v[60:63], a[164:167], v[116:119], v[60:63]
  v_mfma_f32_16x16x32_bf16 v[64:67], a[168:171], v[116:119], v[64:67]
  v_mfma_f32_16x16x32_bf16 v[68:71], a[172:175], v[116:119], v[68:71]
  v_add_u32 v72, 114688, v5
  s_add_u32 s47, s41, 1
  s_and_b32 s47, s47, 3
  s_mul_i32 s47, s47, 12288
  v_add_u32 v73, s47, v72
  s_add_u32 s47, s41, 2
  s_and_b32 s47, s47, 3
  s_mul_i32 s47, s47, 12288
  v_add_u32 v74, s47, v72
  s_add_u32 s47, s41, 3
  s_and_b32 s47, s47, 3
  s_mul_i32 s47, s47, 12288
  v_add_u32 v75, s47, v72
  s_mul_i32 s47, s41, 12288
  v_add_u32 v72, s47, v72
  s_lshl_b32 s47, s38, 13
  s_lshl_b32 s48, s41, 11
  s_add_u32 s47, s47, s48
  s_add_u32 s47, s47, 18874368
  s_lshl_b32 s48, s39, 4
  s_add_u32 s48, s48, s47
  v_lshlrev_b32 v80, 7, v1
  s_add_u32 s56, s42, 48
  v_mov_b32 v81, s56
  s_waitcnt vmcnt(16) lgkmcnt(12)
  v_mfma_f32_16x16x32_bf16 v[8:11], a[176:179], v[120:123], v[8:11]
  ds_write_b128 v230, a[208:211] offset:0
  v_mfma_f32_16x16x32_bf16 v[12:15], a[180:183], v[120:123], v[12:15]
  ds_write_b128 v230, a[212:215] offset:1024
  v_mfma_f32_16x16x32_bf16 v[16:19], a[184:187], v[120:123], v[16:19]
  ds_write_b128 v230, a[216:219] offset:2048
  v_mfma_f32_16x16x32_bf16 v[20:23], a[188:191], v[120:123], v[20:23]
  ds_write_b128 v230, a[220:223] offset:3072
  v_mfma_f32_16x16x32_bf16 v[24:27], a[176:179], v[124:127], v[24:27]
  ds_read_b64_tr_b16 a[208:209], v231 offset:0
  v_mfma_f32_16x16x32_bf16 v[28:31], a[180:183], v[124:127], v[28:31]
  ds_read_b64_tr_b16 a[210:211], v231 offset:2048
  v_mfma_f32_16x16x32_bf16 v[32:35], a[184:187], v[124:127], v[32:35]
  ds_read_b64_tr_b16 a[212:213], v232 offset:0
  v_mfma_f32_16x16x32_bf16 v[36:39], a[188:191], v[124:127], v[36:39]
  ds_read_b64_tr_b16 a[214:215], v232 offset:2048
  v_mfma_f32_16x16x32_bf16 v[40:43], a[176:179], v[128:131], v[40:43]
  ds_read_b64_tr_b16 a[216:217], v233 offset:0
  v_mfma_f32_16x16x32_bf16 v[44:47], a[180:183], v[128:131], v[44:47]
  ds_read_b64_tr_b16 a[218:219], v233 offset:2048
  v_mfma_f32_16x16x32_bf16 v[48:51], a[184:187], v[128:131], v[48:51]
  ds_read_b64_tr_b16 a[220:221], v234 offset:0
  v_mfma_f32_16x16x32_bf16 v[52:55], a[188:191], v[128:131], v[52:55]
  ds_read_b64_tr_b16 a[222:223], v234 offset:2048
  v_mfma_f32_16x16x32_bf16 v[56:59], a[176:179], v[132:135], v[56:59]
  v_mfma_f32_16x16x32_bf16 v[60:63], a[180:183], v[132:135], v[60:63]
  v_mfma_f32_16x16x32_bf16 v[64:67], a[184:187], v[132:135], v[64:67]
  v_mfma_f32_16x16x32_bf16 v[68:71], a[188:191], v[132:135], v[68:71]
  s_waitcnt vmcnt(12) lgkmcnt(12)
  v_mfma_f32_16x16x32_bf16 v[8:11], a[192:195], v[136:139], v[8:11]
  v_mfma_f32_16x16x32_bf16 v[12:15], a[196:199], v[136:139], v[12:15]
  v_mfma_f32_16x16x32_bf16 v[16:19], a[200:203], v[136:139], v[16:19]
  v_mfma_f32_16x16x32_bf16 v[20:23], a[204:207], v[136:139], v[20:23]
  v_mfma_f32_16x16x32_bf16 v[24:27], a[192:195], v[140:143], v[24:27]
  v_mfma_f32_16x16x32_bf16 v[28:31], a[196:199], v[140:143], v[28:31]
  v_mfma_f32_16x16x32_bf16 v[32:35], a[200:203], v[140:143], v[32:35]
  v_mfma_f32_16x16x32_bf16 v[36:39], a[204:207], v[140:143], v[36:39]
  v_mfma_f32_16x16x32_bf16 v[40:43], a[192:195], v[144:147], v[40:43]
  v_mfma_f32_16x16x32_bf16 v[44:47], a[196:199], v[144:147], v[44:47]
  v_mfma_f32_16x16x32_bf16 v[48:51], a[200:203], v[144:147], v[48:51]
  v_mfma_f32_16x16x32_bf16 v[52:55], a[204:207], v[144:147], v[52:55]
  v_mfma_f32_16x16x32_bf16 v[56:59], a[192:195], v[148:151], v[56:59]
  v_mfma_f32_16x16x32_bf16 v[60:63], a[196:199], v[148:151], v[60:63]
  v_mfma_f32_16x16x32_bf16 v[64:67], a[200:203], v[148:151], v[64:67]
  v_mfma_f32_16x16x32_bf16 v[68:71], a[204:207], v[148:151], v[68:71]
  s_waitcnt vmcnt(8) lgkmcnt(0)
  s_barrier
  v_mfma_f32_16x16x32_bf16 v[24:27], a[208:211], v[156:159], v[24:27]
  v_mfma_f32_16x16x32_bf16 v[28:31], a[212:215], v[156:159], v[28:31]
  v_mfma_f32_16x16x32_bf16 v[32:35], a[216:219], v[156:159], v[32:35]
  v_mfma_f32_16x16x32_bf16 v[36:39], a[220:223], v[156:159], v[36:39]
  v_mfma_f32_16x16x32_bf16 v[40:43], a[208:211], v[160:163], v[40:43]
  v_mfma_f32_16x16x32_bf16 v[44:47], a[212:215], v[160:163], v[44:47]
  v_mfma_f32_16x16x32_bf16 v[48:51], a[216:219], v[160:163], v[48:51]
  v_mfma_f32_16x16x32_bf16 v[52:55], a[220:223], v[160:163], v[52:55]
  s_nop 0
  ds_write_b128 v73, v[24:27] offset:0
  ds_write_b128 v73, v[28:31] offset:1024
  ds_write_b128 v73, v[32:35] offset:2048
  ds_write_b128 v73, v[36:39] offset:3072
  v_mfma_f32_16x16x32_bf16 v[56:59], a[208:211], v[164:167], v[56:59]
  v_mfma_f32_16x16x32_bf16 v[60:63], a[212:215], v[164:167], v[60:63]
  v_mfma_f32_16x16x32_bf16 v[64:67], a[216:219], v[164:167], v[64:67]
  v_mfma_f32_16x16x32_bf16 v[68:71], a[220:223], v[164:167], v[68:71]
  ds_write_b128 v74, v[40:43] offset:4096
  ds_write_b128 v74, v[44:47] offset:5120
  ds_write_b128 v74, v[48:51] offset:6144
  ds_write_b128 v74, v[52:55] offset:7168
  v_mfma_f32_16x16x32_bf16 v[8:11], a[208:211], v[152:155], v[8:11]
  v_mfma_f32_16x16x32_bf16 v[12:15], a[212:215], v[152:155], v[12:15]
  v_mfma_f32_16x16x32_bf16 v[16:19], a[216:219], v[152:155], v[16:19]
  v_mfma_f32_16x16x32_bf16 v[20:23], a[220:223], v[152:155], v[20:23]
  ds_write_b128 v75, v[56:59] offset:8192
  ds_write_b128 v75, v[60:63] offset:9216
  ds_write_b128 v75, v[64:67] offset:10240
  ds_write_b128 v75, v[68:71] offset:11264
  s_waitcnt lgkmcnt(0)
  s_barrier
  ds_read_b128 v[24:27], v72 offset:0
  ds_read_b128 v[28:31], v72 offset:1024
  ds_read_b128 v[32:35], v72 offset:2048
  ds_read_b128 v[36:39], v72 offset:3072
  ds_read_b128 v[40:43], v72 offset:4096
  ds_read_b128 v[44:47], v72 offset:5120
  ds_read_b128 v[48:51], v72 offset:6144
  ds_read_b128 v[52:55], v72 offset:7168
  ds_read_b128 v[56:59], v72 offset:8192
  ds_read_b128 v[60:63], v72 offset:9216
  ds_read_b128 v[64:67], v72 offset:10240
  ds_read_b128 v[68:71], v72 offset:11264
  s_waitcnt vmcnt(0)
  v_lshlrev_b32 v76, 16, v200
  v_and_b32 v77, 0xffff0000, v200
  v_pk_add_f32 v[8:9], v[8:9], v[76:77]
  v_lshlrev_b32 v76, 16, v201
  v_and_b32 v77, 0xffff0000, v201
  v_pk_add_f32 v[10:11], v[10:11], v[76:77]
  v_lshlrev_b32 v76, 16, v202
  v_and_b32 v77, 0xffff0000, v202
  v_pk_add_f32 v[12:13], v[12:13], v[76:77]
  v_lshlrev_b32 v76, 16, v203
  v_and_b32 v77, 0xffff0000, v203
  v_pk_add_f32 v[14:15], v[14:15], v[76:77]
  v_lshlrev_b32 v76, 16, v204
  v_and_b32 v77, 0xffff0000, v204
  v_pk_add_f32 v[16:17], v[16:17], v[76:77]
  v_lshlrev_b32 v76, 16, v205
  v_and_b32 v77, 0xffff0000, v205
  v_pk_add_f32 v[18:19], v[18:19], v[76:77]
  v_lshlrev_b32 v76, 16, v206
  v_and_b32 v77, 0xffff0000, v206
  v_pk_add_f32 v[20:21], v[20:21], v[76:77]
  v_lshlrev_b32 v76, 16, v207
  v_and_b32 v77, 0xffff0000, v207
  v_pk_add_f32 v[22:23], v[22:23], v[76:77]
  s_waitcnt lgkmcnt(8)
  v_pk_add_f32 v[8:9], v[8:9], v[24:25]
  v_pk_add_f32 v[10:11], v[10:11], v[26:27]
  v_pk_add_f32 v[12:13], v[12:13], v[28:29]
  v_pk_add_f32 v[14:15], v[14:15], v[30:31]
  v_pk_add_f32 v[16:17], v[16:17], v[32:33]
  v_pk_add_f32 v[18:19], v[18:19], v[34:35]
  v_pk_add_f32 v[20:21], v[20:21], v[36:37]
  v_pk_add_f32 v[22:23], v[22:23], v[38:39]
  s_waitcnt lgkmcnt(4)
  v_pk_add_f32 v[8:9], v[8:9], v[40:41]
  v_pk_add_f32 v[10:11], v[10:11], v[42:43]
  v_pk_add_f32 v[12:13], v[12:13], v[44:45]
  v_pk_add_f32 v[14:15], v[14:15], v[46:47]
  v_pk_add_f32 v[16:17], v[16:17], v[48:49]
  v_pk_add_f32 v[18:19], v[18:19], v[50:51]
  v_pk_add_f32 v[20:21], v[20:21], v[52:53]
  v_pk_add_f32 v[22:23], v[22:23], v[54:55]
  s_waitcnt lgkmcnt(0)
  v_pk_add_f32 v[8:9], v[8:9], v[56:57]
  v_pk_add_f32 v[10:11], v[10:11], v[58:59]
  v_pk_add_f32 v[12:13], v[12:13], v[60:61]
  v_pk_add_f32 v[14:15], v[14:15], v[62:63]
  v_pk_add_f32 v[16:17], v[16:17], v[64:65]
  v_pk_add_f32 v[18:19], v[18:19], v[66:67]
  v_pk_add_f32 v[20:21], v[20:21], v[68:69]
  v_pk_add_f32 v[22:23], v[22:23], v[70:71]
  v_cvt_pk_bf16_f32 v200, v8, v9
  v_cvt_pk_bf16_f32 v201, v10, v11
  v_cvt_pk_bf16_f32 v202, v12, v13
  v_cvt_pk_bf16_f32 v203, v14, v15
  v_cvt_pk_bf16_f32 v204, v16, v17
  v_cvt_pk_bf16_f32 v205, v18, v19
  v_cvt_pk_bf16_f32 v206, v20, v21
  v_cvt_pk_bf16_f32 v207, v22, v23
  v_pk_add_f32 v[24:25], v[8:9], v[10:11]
  v_pk_mul_f32 v[26:27], v[8:9], v[8:9]
  v_pk_fma_f32 v[26:27], v[10:11], v[10:11], v[26:27]
  v_pk_add_f32 v[24:25], v[24:25], v[12:13]
  v_pk_fma_f32 v[26:27], v[12:13], v[12:13], v[26:27]
  v_pk_add_f32 v[24:25], v[24:25], v[14:15]
  v_pk_fma_f32 v[26:27], v[14:15], v[14:15], v[26:27]
  v_pk_add_f32 v[24:25], v[24:25], v[16:17]
  v_pk_fma_f32 v[26:27], v[16:17], v[16:17], v[26:27]
  v_pk_add_f32 v[24:25], v[24:25], v[18:19]
  v_pk_fma_f32 v[26:27], v[18:19], v[18:19], v[26:27]
  v_pk_add_f32 v[24:25], v[24:25], v[20:21]
  v_pk_fma_f32 v[26:27], v[20:21], v[20:21], v[26:27]
  v_pk_add_f32 v[24:25], v[24:25], v[22:23]
  v_pk_fma_f32 v[26:27], v[22:23], v[22:23], v[26:27]
  v_add_f32 v76, v24, v25
  v_add_f32 v78, v26, v27
  v_mov_b32 v82, v76
  v_mov_b32 v83, v78
  s_nop 0
  v_permlane16_swap_b32 v76, v82
  v_permlane16_swap_b32 v78, v83
  v_add_f32 v76, v76, v82
  v_add_f32 v78, v78, v83
  v_mov_b32 v82, v76
  v_mov_b32 v83, v78
  s_nop 0
  v_permlane32_swap_b32 v76, v82
  v_permlane32_swap_b32 v78, v83
  v_add_f32 v76, v76, v82
  v_add_f32 v78, v78, v83
  v_mov_b32 v77, v81
  v_mov_b32 v79, v81
  s_cmp_eq_u32 s43, 0
  s_cbranch_scc1 SLOW_30
  s_mov_b64 exec, 0xffff
  buffer_store_dwordx4 v[76:79], v80, s[28:31], s48 offen
  s_mov_b64 exec, -1
  s_branch JOIN_31
SLOW_30:
  s_mov_b64 exec, 0xffff
  buffer_store_dwordx4 v[76:79], v80, s[28:31], s48 offen sc1
  s_mov_b64 exec, -1
JOIN_31:
  v_lshl_add_u32 v80, v2, 5, v80
  s_mov_b32 s58, 0x40000
SP_32:
  buffer_load_dwordx4 v[72:75], v80, s[28:31], s47 offen sc1
  buffer_load_dwordx4 v[76:79], v80, s[28:31], s47 offen offset:16 sc1
  s_waitcnt vmcnt(0)
  v_cmp_ne_u32 vcc, s56, v73
  v_cmp_ne_u32 s[48:49], s56, v75
  s_nop 1
  s_or_b64 vcc, vcc, s[48:49]
  v_cmp_ne_u32 s[48:49], s56, v77
  s_nop 1
  s_or_b64 vcc, vcc, s[48:49]
  v_cmp_ne_u32 s[48:49], s56, v79
  s_nop 1
  s_or_b64 vcc, vcc, s[48:49]
  s_cbranch_vccz SD_33
  s_sub_u32 s58, s58, 1
  s_cmp_lg_u32 s58, 0
  s_cbranch_scc1 SP_32
SD_33:
  v_add_f32 v76, v72, v76
  v_add_f32 v77, v74, v78
  s_mov_b32 s57, 4194304
  s_cmp_eq_u32 s43, 0
  s_cbranch_scc1 SLOW_34
  buffer_store_dwordx2 v[200:201], v6, s[28:31], s57 offen offset:0
  buffer_store_dwordx2 v[202:203], v6, s[28:31], s57 offen offset:32
  buffer_store_dwordx2 v[204:205], v6, s[28:31], s57 offen offset:64
  buffer_store_dwordx2 v[206:207], v6, s[28:31], s57 offen offset:96
  s_branch JOIN_35
SLOW_34:
  buffer_store_dwordx2 v[200:201], v6, s[28:31], s57 offen offset:0 sc1
  buffer_store_dwordx2 v[202:203], v6, s[28:31], s57 offen offset:32 sc1
  buffer_store_dwordx2 v[204:205], v6, s[28:31], s57 offen offset:64 sc1
  buffer_store_dwordx2 v[206:207], v6, s[28:31], s57 offen offset:96 sc1
JOIN_35:
  v_mov_b32 v78, v76
  v_mov_b32 v79, v77
  s_nop 0
  v_permlane16_swap_b32 v76, v78
  v_permlane16_swap_b32 v77, v79
  v_add_f32 v76, v76, v78
  v_add_f32 v77, v77, v79
  v_mov_b32 v78, v76
  v_mov_b32 v79, v77
  s_nop 0
  v_permlane32_swap_b32 v76, v78
  v_permlane32_swap_b32 v77, v79
  v_add_f32 v76, v76, v78
  v_add_f32 v77, v77, v79
  v_mul_f32 v76, 0x3b000000, v76
  v_mul_f32 v77, 0x3b000000, v77
  v_fma_f32 v77, -v76, v76, v77
  v_max_f32 v77, 0, v77
  v_add_f32 v77, 0x3727c5ac, v77
  v_rsq_f32 v77, v77
  s_nop 0
  v_mul_f32 v76, v76, v77
  v_sub_f32 v76, 0, v76
  v_swap_b32 v76, v77
  v_pk_fma_f32 v[8:9], v[8:9], v[76:77], v[76:77] op_sel:[0,0,1] op_sel_hi:[1,0,1]
  v_pk_fma_f32 v[10:11], v[10:11], v[76:77], v[76:77] op_sel:[0,0,1] op_sel_hi:[1,0,1]
  v_pk_fma_f32 v[12:13], v[12:13], v[76:77], v[76:77] op_sel:[0,0,1] op_sel_hi:[1,0,1]
  v_pk_fma_f32 v[14:15], v[14:15], v[76:77], v[76:77] op_sel:[0,0,1] op_sel_hi:[1,0,1]
  v_pk_fma_f32 v[16:17], v[16:17], v[76:77], v[76:77] op_sel:[0,0,1] op_sel_hi:[1,0,1]
  v_pk_fma_f32 v[18:19], v[18:19], v[76:77], v[76:77] op_sel:[0,0,1] op_sel_hi:[1,0,1]
  v_pk_fma_f32 v[20:21], v[20:21], v[76:77], v[76:77] op_sel:[0,0,1] op_sel_hi:[1,0,1]
  v_pk_fma_f32 v[22:23], v[22:23], v[76:77], v[76:77] op_sel:[0,0,1] op_sel_hi:[1,0,1]
  v_cvt_pk_bf16_f32 v8, v8, v9
  v_cvt_pk_bf16_f32 v9, v10, v11
  v_cvt_pk_bf16_f32 v10, v12, v13
  v_cvt_pk_bf16_f32 v11, v14, v15
  v_cvt_pk_bf16_f32 v12, v16, v17
  v_cvt_pk_bf16_f32 v13, v18, v19
  v_cvt_pk_bf16_f32 v14, v20, v21
  v_cvt_pk_bf16_f32 v15, v22, v23
  ds_write_b64 v226, v[8:9] offset:0
  ds_write_b64 v226, v[10:11] offset:16
  ds_write_b64 v227, v[12:13] offset:0
  ds_write_b64 v227, v[14:15] offset:16
  s_waitcnt lgkmcnt(0)
  s_barrier
  s_and_b32 s47, s41, 1
  s_lshl_b32 s47, s47, 1
  v_lshrrev_b32 v6, 1, v3
  v_and_b32 v7, 1, v2
  v_lshl_or_b32 v6, v7, 1, v6
  v_xor_b32 v6, s47, v6
  v_lshlrev_b32 v6, 5, v6
  v_lshl_add_u32 v6, v4, 3, v6
  v_and_b32 v7, 1, v2
  v_lshl_add_u32 v7, v7, 3, v3
  v_lshl_add_u32 v6, v7, 7, v6
  v_lshrrev_b32 v7, 1, v2
  v_mul_u32_u24 v7, 12288, v7
  v_add_u32 v6, v7, v6
  v_add_u32 v6, 114688, v6
  v_xor_b32 v7, 32, v6
  ds_read_b64_tr_b16 v[96:97], v6 offset:0
  ds_read_b64_tr_b16 v[98:99], v6 offset:512
  ds_read_b64_tr_b16 v[100:101], v6 offset:24576
  ds_read_b64_tr_b16 v[102:103], v6 offset:25088
  ds_read_b64_tr_b16 v[104:105], v7 offset:0
  ds_read_b64_tr_b16 v[106:107], v7 offset:512
  ds_read_b64_tr_b16 v[108:109], v7 offset:24576
  ds_read_b64_tr_b16 v[110:111], v7 offset:25088
  s_lshr_b32 s47, s41, 1
  s_lshl_b32 s47, s47, 20
  s_lshl_b32 s48, s38, 10
  s_add_u32 s47, s47, s48
  s_lshl_b32 s48, s39, 7
  s_add_u32 s47, s47, s48
  s_and_b32 s48, s41, 1
  s_lshl_b32 s48, s48, 6
  s_add_u32 s47, s47, s48
  s_add_u32 s47, s47, 2097152
  v_lshlrev_b32 v8, 15, v1
  v_lshl_add_u32 v8, v2, 4, v8
  s_add_u32 s48, s47, 0x80000
  s_waitcnt lgkmcnt(0)
  v_mfma_f32_16x16x32_bf16 v[112:115], v[96:99], v[208:211], 0
  v_mfma_f32_16x16x32_bf16 v[112:115], v[100:103], v[212:215], v[112:115]
  v_mfma_f32_16x16x32_bf16 v[116:119], v[104:107], v[208:211], 0
  v_mfma_f32_16x16x32_bf16 v[116:119], v[108:111], v[212:215], v[116:119]
  v_mfma_f32_16x16x32_bf16 v[120:123], v[96:99], v[216:219], 0
  v_mfma_f32_16x16x32_bf16 v[120:123], v[100:103], v[220:223], v[120:123]
  v_mfma_f32_16x16x32_bf16 v[124:127], v[104:107], v[216:219], 0
  v_mfma_f32_16x16x32_bf16 v[124:127], v[108:111], v[220:223], v[124:127]
  s_nop 1
  v_cvt_pk_bf16_f32 v112, v112, v113
  v_cvt_pk_bf16_f32 v113, v114, v115
  v_cvt_pk_bf16_f32 v114, v116, v117
  v_cvt_pk_bf16_f32 v115, v118, v119
  buffer_store_dwordx4 v[112:115], v8, s[28:31], s47 offen sc1
  v_cvt_pk_bf16_f32 v120, v120, v121
  v_cvt_pk_bf16_f32 v121, v122, v123
  v_cvt_pk_bf16_f32 v122, v124, v125
  v_cvt_pk_bf16_f32 v123, v126, v127
  buffer_store_dwordx4 v[120:123], v8, s[28:31], s48 offen sc1
  s_lshl_b32 s54, s2, 6
  s_waitcnt vmcnt(0)
  s_barrier
  s_cmp_lg_u32 s41, 0
  s_cbranch_scc1 SIG_36
  s_add_u32 s57, s42, 64
  v_mov_b32 v5, s57
  v_mov_b32 v6, 20054016
  v_add_u32 v6, s54, v6
  s_mov_b64 exec, 1
  buffer_store_dword v5, v6, s[28:31], 0 offen sc1
  s_mov_b64 exec, -1
SIG_36:
  v_lshlrev_b32 v5, 4, v0
  v_add_u32 v5, 8192, v5
  v_add_u32 v6, 4096, v5
  global_load_dwordx4 v[8:11], v5, s[44:45] offset:0
  global_load_dwordx4 v[12:15], v5, s[44:45] offset:1024
  global_load_dwordx4 v[16:19], v5, s[44:45] offset:2048
  global_load_dwordx4 v[20:23], v5, s[44:45] offset:3072
  global_load_dwordx4 v[24:27], v6, s[44:45] offset:0
  global_load_dwordx4 v[28:31], v6, s[44:45] offset:1024
  global_load_dwordx4 v[32:35], v6, s[44:45] offset:2048
  global_load_dwordx4 v[36:39], v6, s[44:45] offset:3072
  v_add_u32 v6, 4096, v6
  global_load_dwordx4 v[40:43], v6, s[44:45] offset:0
  global_load_dwordx4 v[44:47], v6, s[44:45] offset:1024
  s_lshl_b32 s47, s41, 8
  v_lshlrev_b32 v48, 10, v2
  v_lshl_add_u32 v48, v1, 4, v48
  v_add_u32 v48, s47, v48
  s_lshl_b32 s47, s41, 13
  s_add_u32 s47, s47, 114688
  v_lshrrev_b32 v49, 1, v1
  v_xor_b32 v49, v49, v2
  v_lshlrev_b32 v49, 5, v49
  v_and_b32 v50, 1, v1
  v_lshl_add_u32 v49, v50, 4, v49
  v_lshl_add_u32 v49, v2, 8, v49
  v_add_u32 v49, s47, v49
  v_xor_b32 v50, 128, v49
  v_lshrrev_b32 v96, 1, v1
  v_xor_b32 v96, v96, v2
  v_lshlrev_b32 v96, 5, v96
  v_and_b32 v97, 1, v1
  v_lshl_add_u32 v96, v97, 4, v96
  v_lshl_add_u32 v96, v2, 10, v96
  s_lshl_b32 s48, s41, 8
  v_add_u32 v96, s48, v96
  v_xor_b32 v97, 128, v96
  s_lshl_b32 s48, s41, 12
  s_sub_u32 s48, 32768, s48
  v_mov_b32 v98, s48
  v_cmp_gt_u32 vcc, 2, v2
  s_nop 1
  v_cndmask_b32 v98, 0, v98, vcc
  v_and_b32 v51, 1, v2
  v_lshl_or_b32 v51, v51, 2, v3
  v_lshlrev_b32 v51, 5, v51
  v_lshl_add_u32 v51, v4, 3, v51
  v_lshl_add_u32 v52, v2, 3, v3
  v_lshl_add_u32 v51, v52, 8, v51
  v_add_u32 v51, s47, v51
  v_xor_b32 v52, 32, v51
  v_xor_b32 v53, 64, v51
  v_xor_b32 v54, 96, v51
  v_xor_b32 v55, 128, v51
  v_xor_b32 v56, 160, v51
  v_xor_b32 v57, 192, v51
  v_xor_b32 v58, 224, v51
  s_lshl_b32 s47, s41, 12
  s_lshr_b32 s48, s41, 1
  s_lshl_b32 s48, s48, 5
  s_add_u32 s47, s47, s48
  v_lshlrev_b32 v59, 3, v2
  v_add_u32 v59, s47, v59
  v_lshlrev_b32 v60, 3, v1
  v_xor_b32 v59, v59, v60
  v_lshl_add_u32 v59, v1, 8, v59
  v_add_u32 v59, 147456, v59
  v_xor_b32 v60, 32, v59
  v_xor_b32 v61, 64, v59
  v_xor_b32 v62, 96, v59
  s_lshl_b32 s47, s41, 2
  v_lshrrev_b32 v63, 1, v2
  v_add_u32 v63, s47, v63
  v_and_b32 v64, 1, v2
  v_mul_u32_u24 v64, 8224, v64
  v_lshl_add_u32 v64, v3, 6, v64
  v_lshl_add_u32 v64, v4, 3, v64
  v_lshlrev_b32 v65, 3, v63
  v_xor_b32 v64, v64, v65
  v_lshl_add_u32 v63, v63, 8, v64
  v_add_u32 v63, 147456, v63
  v_xor_b32 v64, 32, v63
  v_xor_b32 v65, 16, v63
  v_add_u32 v65, 512, v65
  v_xor_b32 v66, 32, v65
  v_lshlrev_b32 v67, 5, v1
  v_lshl_add_u32 v67, v2, 3, v67
  s_lshl_b32 s47, s38, 16
  s_lshl_b32 s48, s39, 13
  s_add_u32 s47, s47, s48
  s_lshl_b32 s48, s41, 11
  s_add_u32 s47, s47, s48
  v_add_u32 v68, s47, v67
  s_lshl_b32 s47, s41, 1
  v_lshrrev_b32 v71, 1, v1
  v_xor_b32 v72, s47, v71
  v_lshlrev_b32 v72, 4, v72
  v_lshl_add_u32 v72, v71, 9, v72
  v_lshl_add_u32 v72, v2, 7, v72
  v_and_b32 v71, 1, v1
  v_lshl_add_u32 v71, v71, 3, v72
  v_add_u32 v71, 123136, v71
  v_xor_b32 v72, 16, v71
  s_lshl_b32 s47, s41, 2
  v_lshrrev_b32 v73, 5, v0
  v_add_u32 v73, s47, v73
  v_and_b32 v74, 7, v0
  v_xor_b32 v75, v74, v73
  v_and_b32 v75, 7, v75
  v_lshlrev_b32 v75, 4, v75
  v_lshl_add_u32 v75, v73, 9, v75
  v_bfe_u32 v84, v0, 3, 2
  v_lshl_add_u32 v75, v84, 7, v75
  v_lshlrev_b32 v73, 10, v73
  v_lshl_add_u32 v73, v84, 8, v73
  v_lshl_add_u32 v73, v74, 4, v73
  s_lshl_b32 s47, s38, 16
  s_lshr_b32 s48, s39, 1
  s_lshl_b32 s48, s48, 14
  s_add_u32 s47, s47, s48
  s_and_b32 s48, s39, 1
  s_lshl_b32 s48, s48, 7
  s_add_u32 s47, s47, s48
  v_add_u32 v74, s47, v73
  v_add_u32 v73, 123136, v75
  v_xor_b32 v85, 32, v73
  v_lshrrev_b32 v222, 1, v0
  v_and_b32 v223, 3, v222
  v_lshrrev_b32 v222, 2, v222
  v_lshl_add_u32 v222, v223, 6, v222
  v_and_b32 v223, 1, v0
  v_lshl_add_u32 v222, v223, 3, v222
  s_lshl_b32 s47, s41, 4
  v_add_u32 v222, s47, v222
  v_lshlrev_b32 v222, 6, v222
  v_add_u32 v222, 20054016, v222
  s_add_u32 s56, s42, 64
  s_mov_b32 s58, 0x40000
POLL_37:
  buffer_load_dword v223, v222, s[28:31], 0 offen sc1
  s_waitcnt vmcnt(0)
  v_cmp_ne_u32 vcc, s56, v223
  s_nop 4
  s_cbranch_vccz PD_38
  s_sub_u32 s58, s58, 1
  s_cmp_lg_u32 s58, 0
  s_cbranch_scc1 POLL_37
PD_38:
  s_sub_u32 s47, 32, s38
  s_cmp_lt_u32 s39, 4
  s_cselect_b32 s47, s38, s47
  s_add_u32 s48, s47, 32
  s_cmp_eq_u32 s38, 0
  s_cselect_b32 s48, 0, s48
  s_lshl_b32 s47, s47, 15
  s_lshl_b32 s48, s48, 15
  s_add_u32 s47, s47, 2097152
  s_add_u32 s48, s48, 2097152
  s_mov_b32 s49, 4194304
  s_lshl_b32 s50, s41, 13
  s_add_u32 s50, s50, 114688
  s_lshl_b32 s51, s41, 12
  s_add_u32 s51, s51, 147456
  s_add_u32 m0, s50, 0
  s_nop 0
  buffer_load_dwordx4 v96, s[28:31], s47 offen sc1 lds
  s_add_u32 m0, s50, 1024
  s_add_u32 s47, s47, 4096
  buffer_load_dwordx4 v96, s[28:31], s47 offen sc1 lds
  s_add_u32 m0, s50, 2048
  s_add_u32 s47, s47, 4096
  buffer_load_dwordx4 v97, s[28:31], s47 offen sc1 lds
  s_add_u32 m0, s50, 3072
  s_add_u32 s47, s47, 4096
  buffer_load_dwordx4 v97, s[28:31], s47 offen sc1 lds
  s_add_u32 m0, s50, 4096
  s_add_u32 s47, s47, 4096
  buffer_load_dwordx4 v96, s[28:31], s47 offen sc1 lds
  s_add_u32 m0, s50, 5120
  s_add_u32 s47, s47, 4096
  buffer_load_dwordx4 v96, s[28:31], s47 offen sc1 lds
  s_add_u32 m0, s50, 6144
  s_add_u32 s47, s47, 4096
  buffer_load_dwordx4 v97, s[28:31], s47 offen sc1 lds
  s_add_u32 m0, s50, 7168
  s_add_u32 s47, s47, 4096
  buffer_load_dwordx4 v97, s[28:31], s47 offen sc1 lds
  s_add_u32 s48, s48, 16384
  buffer_load_dwordx4 v[144:147], v48, s[28:31], s48 offen sc1
  s_add_u32 s48, s48, 4096
  buffer_load_dwordx4 v[148:151], v48, s[28:31], s48 offen sc1
  s_add_u32 s48, s48, 4096
  buffer_load_dwordx4 v[152:155], v48, s[28:31], s48 offen sc1
  s_add_u32 s48, s48, 4096
  buffer_load_dwordx4 v[156:159], v48, s[28:31], s48 offen sc1
  s_add_u32 m0, s51, 0
  s_sub_u32 s48, s48, 28672
  buffer_load_dwordx4 v96, s[28:31], s48 offen sc1 lds
  s_add_u32 m0, s51, 1024
  s_add_u32 s48, s48, 4096
  buffer_load_dwordx4 v96, s[28:31], s48 offen sc1 lds
  s_add_u32 m0, s51, 2048
  s_add_u32 s48, s48, 4096
  buffer_load_dwordx4 v97, s[28:31], s48 offen sc1 lds
  s_add_u32 m0, s51, 3072
  s_add_u32 s48, s48, 4096
  buffer_load_dwordx4 v97, s[28:31], s48 offen sc1 lds
  s_waitcnt vmcnt(8)
  ds_read_b64_tr_b16 v[160:161], v51 offset:0
  ds_read_b64_tr_b16 v[162:163], v51 offset:1024
  ds_read_b64_tr_b16 v[164:165], v52 offset:0
  ds_read_b64_tr_b16 v[166:167], v52 offset:1024
  ds_read_b64_tr_b16 v[168:169], v53 offset:0
  ds_read_b64_tr_b16 v[170:171], v53 offset:1024
  ds_read_b64_tr_b16 v[172:173], v54 offset:0
  ds_read_b64_tr_b16 v[174:175], v54 offset:1024
  ds_read_b64_tr_b16 v[176:177], v55 offset:0
  ds_read_b64_tr_b16 v[178:179], v55 offset:1024
  ds_read_b64_tr_b16 v[180:181], v56 offset:0
  ds_read_b64_tr_b16 v[182:183], v56 offset:1024
  ds_read_b64_tr_b16 v[184:185], v57 offset:0
  ds_read_b64_tr_b16 v[186:187], v57 offset:1024
  ds_read_b64_tr_b16 v[188:189], v58 offset:0
  ds_read_b64_tr_b16 v[190:191], v58 offset:1024
  s_waitcnt lgkmcnt(14)
  v_mfma_f32_16x16x32_bf16 v[192:195], v[160:163], a[224:227], 0
  s_waitcnt lgkmcnt(12)
  v_mfma_f32_16x16x32_bf16 v[196:199], v[164:167], a[224:227], 0
  s_waitcnt lgkmcnt(10)
  v_mfma_f32_16x16x32_bf16 v[200:203], v[168:171], a[224:227], 0
  s_waitcnt lgkmcnt(8)
  v_mfma_f32_16x16x32_bf16 v[204:207], v[172:175], a[224:227], 0
  s_waitcnt lgkmcnt(6)
  v_mfma_f32_16x16x32_bf16 v[208:211], v[176:179], a[224:227], 0
  s_waitcnt lgkmcnt(4)
  v_mfma_f32_16x16x32_bf16 v[212:215], v[180:183], a[224:227], 0
  s_waitcnt lgkmcnt(2)
  v_mfma_f32_16x16x32_bf16 v[216:219], v[184:187], a[224:227], 0
  s_waitcnt lgkmcnt(0)
  v_mfma_f32_16x16x32_bf16 v[220:223], v[188:191], a[224:227], 0
  s_waitcnt vmcnt(4)
  ds_write_b128 v49, v[144:147] offset:4096
  ds_write_b128 v49, v[148:151] offset:5120
  ds_write_b128 v50, v[152:155] offset:6144
  ds_write_b128 v50, v[156:159] offset:7168
  v_add_u32 v51, v98, v51
  v_add_u32 v52, v98, v52
  v_add_u32 v53, v98, v53
  v_add_u32 v54, v98, v54
  v_add_u32 v55, v98, v55
  v_add_u32 v56, v98, v56
  v_add_u32 v57, v98, v57
  v_add_u32 v58, v98, v58
  s_waitcnt vmcnt(0)
  ds_read_b64_tr_b16 v[160:161], v51 offset:0
  ds_read_b64_tr_b16 v[162:163], v51 offset:1024
  ds_read_b64_tr_b16 v[164:165], v52 offset:0
  ds_read_b64_tr_b16 v[166:167], v52 offset:1024
  ds_read_b64_tr_b16 v[168:169], v53 offset:0
  ds_read_b64_tr_b16 v[170:171], v53 offset:1024
  ds_read_b64_tr_b16 v[172:173], v54 offset:0
  ds_read_b64_tr_b16 v[174:175], v54 offset:1024
  ds_read_b64_tr_b16 v[176:177], v55 offset:0
  ds_read_b64_tr_b16 v[178:179], v55 offset:1024
  ds_read_b64_tr_b16 v[180:181], v56 offset:0
  ds_read_b64_tr_b16 v[182:183], v56 offset:1024
  ds_read_b64_tr_b16 v[184:185], v57 offset:0
  ds_read_b64_tr_b16 v[186:187], v57 offset:1024
  ds_read_b64_tr_b16 v[188:189], v58 offset:0
  ds_read_b64_tr_b16 v[190:191], v58 offset:1024
  s_waitcnt lgkmcnt(14)
  v_mfma_f32_16x16x32_bf16 v[192:195], v[160:163], a[228:231], v[192:195]
  s_waitcnt lgkmcnt(12)
  v_mfma_f32_16x16x32_bf16 v[196:199], v[164:167], a[228:231], v[196:199]
  s_waitcnt lgkmcnt(10)
  v_mfma_f32_16x16x32_bf16 v[200:203], v[168:171], a[228:231], v[200:203]
  s_waitcnt lgkmcnt(8)
  v_mfma_f32_16x16x32_bf16 v[204:207], v[172:175], a[228:231], v[204:207]
  s_waitcnt lgkmcnt(6)
  v_mfma_f32_16x16x32_bf16 v[208:211], v[176:179], a[228:231], v[208:211]
  s_waitcnt lgkmcnt(4)
  v_mfma_f32_16x16x32_bf16 v[212:215], v[180:183], a[228:231], v[212:215]
  s_waitcnt lgkmcnt(2)
  v_mfma_f32_16x16x32_bf16 v[216:219], v[184:187], a[228:231], v[216:219]
  s_waitcnt lgkmcnt(0)
  v_mfma_f32_16x16x32_bf16 v[220:223], v[188:191], a[228:231], v[220:223]
  v_cvt_pk_bf16_f32 v192, v192, v193
  v_cvt_pk_bf16_f32 v193, v194, v195
  ds_write_b64 v59, v[192:193] offset:0
  v_cvt_pk_bf16_f32 v196, v196, v197
  v_cvt_pk_bf16_f32 v197, v198, v199
  ds_write_b64 v60, v[196:197] offset:0
  v_cvt_pk_bf16_f32 v200, v200, v201
  v_cvt_pk_bf16_f32 v201, v202, v203
  ds_write_b64 v61, v[200:201] offset:0
  v_cvt_pk_bf16_f32 v204, v204, v205
  v_cvt_pk_bf16_f32 v205, v206, v207
  ds_write_b64 v62, v[204:205] offset:0
  v_cvt_pk_bf16_f32 v208, v208, v209
  v_cvt_pk_bf16_f32 v209, v210, v211
  ds_write_b64 v59, v[208:209] offset:128
  v_cvt_pk_bf16_f32 v212, v212, v213
  v_cvt_pk_bf16_f32 v213, v214, v215
  ds_write_b64 v60, v[212:213] offset:128
  v_cvt_pk_bf16_f32 v216, v216, v217
  v_cvt_pk_bf16_f32 v217, v218, v219
  ds_write_b64 v61, v[216:217] offset:128
  v_cvt_pk_bf16_f32 v220, v220, v221
  v_cvt_pk_bf16_f32 v221, v222, v223
  ds_write_b64 v62, v[220:221] offset:128
  s_waitcnt lgkmcnt(0)
  s_barrier
  buffer_load_dwordx2 v[76:77], v68, s[28:31], s49 offen offset:0 sc1
  buffer_load_dwordx2 v[78:79], v68, s[28:31], s49 offen offset:512 sc1
  buffer_load_dwordx2 v[80:81], v68, s[28:31], s49 offen offset:1024 sc1
  buffer_load_dwordx2 v[82:83], v68, s[28:31], s49 offen offset:1536 sc1
  ds_read_b64_tr_b16 v[96:97], v63 offset:0
  ds_read_b64_tr_b16 v[98:99], v63 offset:4096
  ds_read_b64_tr_b16 v[100:101], v64 offset:0
  ds_read_b64_tr_b16 v[102:103], v64 offset:4096
  ds_read_b64_tr_b16 v[104:105], v65 offset:0
  ds_read_b64_tr_b16 v[106:107], v65 offset:4096
  ds_read_b64_tr_b16 v[108:109], v66 offset:0
  ds_read_b64_tr_b16 v[110:111], v66 offset:4096
  s_waitcnt lgkmcnt(4)
  v_mfma_f32_16x16x32_bf16 v[112:115], v[96:99], v[8:11], 0
  v_mfma_f32_16x16x32_bf16 v[116:119], v[96:99], v[12:15], 0
  v_mfma_f32_16x16x32_bf16 v[120:123], v[100:103], v[8:11], 0
  v_mfma_f32_16x16x32_bf16 v[124:127], v[100:103], v[12:15], 0
  s_waitcnt lgkmcnt(0)
  v_mfma_f32_16x16x32_bf16 v[128:131], v[104:107], v[8:11], 0
  v_mfma_f32_16x16x32_bf16 v[132:135], v[104:107], v[12:15], 0
  v_mfma_f32_16x16x32_bf16 v[136:139], v[108:111], v[8:11], 0
  v_mfma_f32_16x16x32_bf16 v[140:143], v[108:111], v[12:15], 0
  v_pk_mul_f32 v[160:161], v[112:113], v[32:33]
  v_pk_mul_f32 v[164:165], v[116:117], v[32:33]
  v_pk_fma_f32 v[160:161], v[116:117], v[40:41], v[160:161]
  v_pk_fma_f32 v[164:165], v[112:113], v[40:41], v[164:165] neg_lo:[1,0,0] neg_hi:[1,0,0]
  v_pk_mul_f32 v[162:163], v[114:115], v[34:35]
  v_pk_mul_f32 v[166:167], v[118:119], v[34:35]
  v_pk_fma_f32 v[162:163], v[118:119], v[42:43], v[162:163]
  v_pk_fma_f32 v[166:167], v[114:115], v[42:43], v[166:167] neg_lo:[1,0,0] neg_hi:[1,0,0]
  v_cvt_pk_bf16_f32 v144, v160, v161
  v_cvt_pk_bf16_f32 v145, v162, v163
  v_cvt_pk_bf16_f32 v148, v164, v165
  v_cvt_pk_bf16_f32 v149, v166, v167
  v_pk_mul_f32 v[168:169], v[120:121], v[36:37]
  v_pk_mul_f32 v[172:173], v[124:125], v[36:37]
  v_pk_fma_f32 v[168:169], v[124:125], v[44:45], v[168:169]
  v_pk_fma_f32 v[172:173], v[120:121], v[44:45], v[172:173] neg_lo:[1,0,0] neg_hi:[1,0,0]
  v_pk_mul_f32 v[170:171], v[122:123], v[38:39]
  v_pk_mul_f32 v[174:175], v[126:127], v[38:39]
  v_pk_fma_f32 v[170:171], v[126:127], v[46:47], v[170:171]
  v_pk_fma_f32 v[174:175], v[122:123], v[46:47], v[174:175] neg_lo:[1,0,0] neg_hi:[1,0,0]
  v_cvt_pk_bf16_f32 v146, v168, v169
  v_cvt_pk_bf16_f32 v147, v170, v171
  v_cvt_pk_bf16_f32 v150, v172, v173
  v_cvt_pk_bf16_f32 v151, v174, v175
  v_pk_mul_f32 v[160:161], v[128:129], v[32:33]
  v_pk_mul_f32 v[164:165], v[132:133], v[32:33]
  v_pk_fma_f32 v[160:161], v[132:133], v[40:41], v[160:161]
  v_pk_fma_f32 v[164:165], v[128:129], v[40:41], v[164:165] neg_lo:[1,0,0] neg_hi:[1,0,0]
  v_pk_mul_f32 v[162:163], v[130:131], v[34:35]
  v_pk_mul_f32 v[166:167], v[134:135], v[34:35]
  v_pk_fma_f32 v[162:163], v[134:135], v[42:43], v[162:163]
  v_pk_fma_f32 v[166:167], v[130:131], v[42:43], v[166:167] neg_lo:[1,0,0] neg_hi:[1,0,0]
  v_cvt_pk_bf16_f32 v152, v160, v161
  v_cvt_pk_bf16_f32 v153, v162, v163
  v_cvt_pk_bf16_f32 v156, v164, v165
  v_cvt_pk_bf16_f32 v157, v166, v167
  v_pk_mul_f32 v[168:169], v[136:137], v[36:37]
  v_pk_mul_f32 v[172:173], v[140:141], v[36:37]
  v_pk_fma_f32 v[168:169], v[140:141], v[44:45], v[168:169]
  v_pk_fma_f32 v[172:173], v[136:137], v[44:45], v[172:173] neg_lo:[1,0,0] neg_hi:[1,0,0]
  v_pk_mul_f32 v[170:171], v[138:139], v[38:39]
  v_pk_mul_f32 v[174:175], v[142:143], v[38:39]
  v_pk_fma_f32 v[170:171], v[142:143], v[46:47], v[170:171]
  v_pk_fma_f32 v[174:175], v[138:139], v[46:47], v[174:175] neg_lo:[1,0,0] neg_hi:[1,0,0]
  v_cvt_pk_bf16_f32 v154, v168, v169
  v_cvt_pk_bf16_f32 v155, v170, v171
  v_cvt_pk_bf16_f32 v158, v172, v173
  v_cvt_pk_bf16_f32 v159, v174, v175
  v_mfma_f32_16x16x32_bf16 v[176:179], v[144:147], v[16:19], 0
  v_mfma_f32_16x16x32_bf16 v[180:183], v[144:147], v[24:27], 0
  v_mfma_f32_16x16x32_bf16 v[176:179], v[148:151], v[20:23], v[176:179]
  v_mfma_f32_16x16x32_bf16 v[180:183], v[148:151], v[28:31], v[180:183]
  v_mfma_f32_16x16x32_bf16 v[184:187], v[152:155], v[16:19], 0
  v_mfma_f32_16x16x32_bf16 v[188:191], v[152:155], v[24:27], 0
  v_mfma_f32_16x16x32_bf16 v[184:187], v[156:159], v[20:23], v[184:187]
  v_mfma_f32_16x16x32_bf16 v[188:191], v[156:159], v[28:31], v[188:191]
  s_waitcnt vmcnt(0)
  v_lshlrev_b32 v112, 16, v76
  v_and_b32 v113, 0xffff0000, v76
  v_lshlrev_b32 v114, 16, v77
  v_and_b32 v115, 0xffff0000, v77
  v_lshlrev_b32 v116, 16, v78
  v_and_b32 v117, 0xffff0000, v78
  v_lshlrev_b32 v118, 16, v79
  v_and_b32 v119, 0xffff0000, v79
  v_lshlrev_b32 v120, 16, v80
  v_and_b32 v121, 0xffff0000, v80
  v_lshlrev_b32 v122, 16, v81
  v_and_b32 v123, 0xffff0000, v81
  v_lshlrev_b32 v124, 16, v82
  v_and_b32 v125, 0xffff0000, v82
  v_lshlrev_b32 v126, 16, v83
  v_and_b32 v127, 0xffff0000, v83
  v_pk_add_f32 v[176:177], v[176:177], v[112:113]
  v_pk_add_f32 v[178:179], v[178:179], v[114:115]
  v_pk_add_f32 v[180:181], v[180:181], v[116:117]
  v_pk_add_f32 v[182:183], v[182:183], v[118:119]
  v_pk_add_f32 v[184:185], v[184:185], v[120:121]
  v_pk_add_f32 v[186:187], v[186:187], v[122:123]
  v_pk_add_f32 v[188:189], v[188:189], v[124:125]
  v_pk_add_f32 v[190:191], v[190:191], v[126:127]
  v_pk_add_f32 v[104:105], v[176:177], v[178:179]
  v_pk_mul_f32 v[106:107], v[176:177], v[176:177]
  v_pk_fma_f32 v[106:107], v[178:179], v[178:179], v[106:107]
  v_pk_add_f32 v[104:105], v[104:105], v[180:181]
  v_pk_fma_f32 v[106:107], v[180:181], v[180:181], v[106:107]
  v_pk_add_f32 v[104:105], v[104:105], v[182:183]
  v_pk_fma_f32 v[106:107], v[182:183], v[182:183], v[106:107]
  v_pk_add_f32 v[108:109], v[184:185], v[186:187]
  v_pk_mul_f32 v[110:111], v[184:185], v[184:185]
  v_pk_fma_f32 v[110:111], v[186:187], v[186:187], v[110:111]
  v_pk_add_f32 v[108:109], v[108:109], v[188:189]
  v_pk_fma_f32 v[110:111], v[188:189], v[188:189], v[110:111]
  v_pk_add_f32 v[108:109], v[108:109], v[190:191]
  v_pk_fma_f32 v[110:111], v[190:191], v[190:191], v[110:111]
  v_add_f32 v100, v104, v105
  v_add_f32 v101, v106, v107
  v_add_f32 v102, v108, v109
  v_add_f32 v103, v110, v111
  v_add_f32_dpp v100, v100, v100 quad_perm:[1,0,3,2] row_mask:0xf bank_mask:0xf
  v_add_f32_dpp v101, v101, v101 quad_perm:[1,0,3,2] row_mask:0xf bank_mask:0xf
  v_add_f32_dpp v102, v102, v102 quad_perm:[1,0,3,2] row_mask:0xf bank_mask:0xf
  v_add_f32_dpp v103, v103, v103 quad_perm:[1,0,3,2] row_mask:0xf bank_mask:0xf
  v_add_f32_dpp v100, v100, v100 quad_perm:[2,3,0,1] row_mask:0xf bank_mask:0xf
  v_add_f32_dpp v101, v101, v101 quad_perm:[2,3,0,1] row_mask:0xf bank_mask:0xf
  v_add_f32_dpp v102, v102, v102 quad_perm:[2,3,0,1] row_mask:0xf bank_mask:0xf
  v_add_f32_dpp v103, v103, v103 quad_perm:[2,3,0,1] row_mask:0xf bank_mask:0xf
  v_add_f32_dpp v100, v100, v100 row_half_mirror row_mask:0xf bank_mask:0xf
  v_add_f32_dpp v101, v101, v101 row_half_mirror row_mask:0xf bank_mask:0xf
  v_add_f32_dpp v102, v102, v102 row_half_mirror row_mask:0xf bank_mask:0xf
  v_add_f32_dpp v103, v103, v103 row_half_mirror row_mask:0xf bank_mask:0xf
  v_add_f32_dpp v100, v100, v100 row_mirror row_mask:0xf bank_mask:0xf
  v_add_f32_dpp v101, v101, v101 row_mirror row_mask:0xf bank_mask:0xf
  v_add_f32_dpp v102, v102, v102 row_mirror row_mask:0xf bank_mask:0xf
  v_add_f32_dpp v103, v103, v103 row_mirror row_mask:0xf bank_mask:0xf
  v_mov_b32 v104, v100
  v_mov_b32 v105, v101
  v_mov_b32 v106, v102
  v_mov_b32 v107, v103
  v_permlane16_swap_b32 v100, v104
  v_permlane16_swap_b32 v101, v105
  v_permlane16_swap_b32 v102, v106
  v_permlane16_swap_b32 v103, v107
  v_add_f32 v100, v100, v104
  v_add_f32 v101, v101, v105
  v_add_f32 v102, v102, v106
  v_add_f32 v103, v103, v107
  v_mov_b32 v104, v100
  v_mov_b32 v105, v101
  v_mov_b32 v106, v102
  v_mov_b32 v107, v103
  v_permlane32_swap_b32 v100, v104
  v_permlane32_swap_b32 v101, v105
  v_permlane32_swap_b32 v102, v106
  v_permlane32_swap_b32 v103, v107
  v_add_f32 v100, v100, v104
  v_add_f32 v101, v101, v105
  v_add_f32 v102, v102, v106
  v_add_f32 v103, v103, v107
  v_mul_f32 v100, 0x3b000000, v100
  v_mul_f32 v101, 0x3b000000, v101
  v_fma_f32 v101, -v100, v100, v101
  v_max_f32 v101, 0, v101
  v_add_f32 v101, 0x3727c5ac, v101
  v_rsq_f32 v101, v101
  s_nop 0
  v_mul_f32 v100, v100, v101
  v_sub_f32 v100, 0, v100
  v_swap_b32 v100, v101
  v_mul_f32 v102, 0x3b000000, v102
  v_mul_f32 v103, 0x3b000000, v103
  v_fma_f32 v103, -v102, v102, v103
  v_max_f32 v103, 0, v103
  v_add_f32 v103, 0x3727c5ac, v103
  v_rsq_f32 v103, v103
  s_nop 0
  v_mul_f32 v102, v102, v103
  v_sub_f32 v102, 0, v102
  v_swap_b32 v102, v103
  v_cvt_pk_bf16_f32 v208, v176, v177
  v_cvt_pk_bf16_f32 v209, v178, v179
  v_cvt_pk_bf16_f32 v210, v180, v181
  v_cvt_pk_bf16_f32 v211, v182, v183
  v_pk_fma_f32 v[176:177], v[176:177], v[100:101], v[100:101] op_sel:[0,0,1] op_sel_hi:[1,0,1]
  v_pk_fma_f32 v[178:179], v[178:179], v[100:101], v[100:101] op_sel:[0,0,1] op_sel_hi:[1,0,1]
  v_pk_fma_f32 v[180:181], v[180:181], v[100:101], v[100:101] op_sel:[0,0,1] op_sel_hi:[1,0,1]
  v_pk_fma_f32 v[182:183], v[182:183], v[100:101], v[100:101] op_sel:[0,0,1] op_sel_hi:[1,0,1]
  v_cvt_pk_bf16_f32 v216, v176, v177
  v_cvt_pk_bf16_f32 v217, v178, v179
  v_cvt_pk_bf16_f32 v218, v180, v181
  v_cvt_pk_bf16_f32 v219, v182, v183
  v_cvt_pk_bf16_f32 v212, v184, v185
  v_cvt_pk_bf16_f32 v213, v186, v187
  v_cvt_pk_bf16_f32 v214, v188, v189
  v_cvt_pk_bf16_f32 v215, v190, v191
  v_pk_fma_f32 v[184:185], v[184:185], v[102:103], v[102:103] op_sel:[0,0,1] op_sel_hi:[1,0,1]
  v_pk_fma_f32 v[186:187], v[186:187], v[102:103], v[102:103] op_sel:[0,0,1] op_sel_hi:[1,0,1]
  v_pk_fma_f32 v[188:189], v[188:189], v[102:103], v[102:103] op_sel:[0,0,1] op_sel_hi:[1,0,1]
  v_pk_fma_f32 v[190:191], v[190:191], v[102:103], v[102:103] op_sel:[0,0,1] op_sel_hi:[1,0,1]
  v_cvt_pk_bf16_f32 v220, v184, v185
  v_cvt_pk_bf16_f32 v221, v186, v187
  v_cvt_pk_bf16_f32 v222, v188, v189
  v_cvt_pk_bf16_f32 v223, v190, v191
  s_mov_b32 s47, 4194304
  s_mov_b32 s48, 8388608
  ds_write_b64 v71, v[216:217] offset:0
  ds_write_b64 v71, v[218:219] offset:4096
  ds_write_b64 v72, v[220:221] offset:0
  ds_write_b64 v72, v[222:223] offset:4096
  s_cmp_eq_u32 s43, 0
  s_cbranch_scc1 SLOW_39
  buffer_store_dwordx2 v[208:209], v68, s[28:31], s47 offen offset:0
  buffer_store_dwordx2 v[210:211], v68, s[28:31], s47 offen offset:512
  buffer_store_dwordx2 v[212:213], v68, s[28:31], s47 offen offset:1024
  buffer_store_dwordx2 v[214:215], v68, s[28:31], s47 offen offset:1536
  s_branch JOIN_40
SLOW_39:
  buffer_store_dwordx2 v[208:209], v68, s[28:31], s47 offen offset:0 sc1
  buffer_store_dwordx2 v[210:211], v68, s[28:31], s47 offen offset:512 sc1
  buffer_store_dwordx2 v[212:213], v68, s[28:31], s47 offen offset:1024 sc1
  buffer_store_dwordx2 v[214:215], v68, s[28:31], s47 offen offset:1536 sc1
JOIN_40:
  s_waitcnt lgkmcnt(0)
  s_barrier
  ds_read_b128 v[216:219], v73
  ds_read_b128 v[220:223], v85 offset:1024
  s_cmp_eq_u32 s43, 0
  s_cbranch_scc1 SLOW_41
  s_waitcnt lgkmcnt(1)
  buffer_store_dwordx4 v[216:219], v74, s[28:31], s48 offen
  s_waitcnt lgkmcnt(0)
  buffer_store_dwordx4 v[220:223], v74, s[28:31], s48 offen offset:2048
  s_branch JOIN_42
SLOW_41:
  s_waitcnt lgkmcnt(1)
  buffer_store_dwordx4 v[216:219], v74, s[28:31], s48 offen sc1
  s_waitcnt lgkmcnt(0)
  buffer_store_dwordx4 v[220:223], v74, s[28:31], s48 offen offset:2048 sc1
JOIN_42:
  s_lshr_b32 s54, s37, 4
  s_lshl_b32 s48, s36, 1
  s_add_u32 s54, s54, s48
  s_lshl_b32 s54, s54, 8
  s_add_u32 s54, s54, 20086784
  s_lshl_b32 s48, s40, 4
  s_add_u32 s54, s54, s48
  s_lshl_b32 s48, s41, 2
  s_add_u32 s54, s54, s48
  s_add_u32 s57, s42, 80
  v_mov_b32 v222, s57
  v_mov_b32 v223, s54
  s_waitcnt vmcnt(0)
  s_mov_b64 exec, 1
  s_cmp_eq_u32 s43, 0
  s_cbranch_scc1 SLOW_43
  buffer_store_dword v222, v223, s[28:31], 0 offen
  s_branch JOIN_44
SLOW_43:
  buffer_store_dword v222, v223, s[28:31], 0 offen sc1
JOIN_44:
  s_mov_b64 exec, -1
  s_lshr_b32 s47, s37, 4
  s_lshl_b32 s48, s36, 1
  s_add_u32 s47, s47, s48
  s_lshl_b32 s47, s47, 8
  s_add_u32 s47, s47, 20086784
  s_lshl_b32 s48, s41, 6
  s_add_u32 s47, s47, s48
  v_lshlrev_b32 v222, 2, v1
  v_add_u32 v222, s47, v222
  s_add_u32 s56, s42, 80
  s_mov_b32 s58, 0x40000
POLL_45:
  buffer_load_dword v223, v222, s[28:31], 0 offen sc1
  s_waitcnt vmcnt(0)
  v_cmp_ne_u32 vcc, s56, v223
  s_nop 4
  s_cbranch_vccz PD_46
  s_sub_u32 s58, s58, 1
  s_cmp_lg_u32 s58, 0
  s_cbranch_scc1 POLL_45
PD_46:
  v_lshlrev_b32 v5, 4, v0
  s_lshl_b32 s47, s46, 16
  s_and_b32 s48, s41, 1
  s_lshl_b32 s48, s48, 15
  s_add_u32 s47, s47, s48
  s_add_u32 s47, s47, 8388608
  s_add_u32 s48, s47, 16384
  buffer_load_dwordx4 v[8:11], v5, s[28:31], s47 offen offset:0 sc1
  buffer_load_dwordx4 v[12:15], v5, s[28:31], s48 offen offset:0 sc1
  buffer_load_dwordx4 v[16:19], v5, s[28:31], s47 offen offset:1024 sc1
  buffer_load_dwordx4 v[20:23], v5, s[28:31], s48 offen offset:1024 sc1
  buffer_load_dwordx4 v[24:27], v5, s[28:31], s47 offen offset:2048 sc1
  buffer_load_dwordx4 v[28:31], v5, s[28:31], s48 offen offset:2048 sc1
  buffer_load_dwordx4 v[32:35], v5, s[28:31], s47 offen offset:3072 sc1
  buffer_load_dwordx4 v[36:39], v5, s[28:31], s48 offen offset:3072 sc1
  s_add_u32 s47, s47, 4096
  s_add_u32 s48, s48, 4096
  v_lshl_add_u32 v252, v2, 2, v3
  v_mul_u32_u24 v252, 224, v252
  v_lshl_add_u32 v252, v4, 3, v252
  v_add_u32 v252, 0, v252
  v_add_u32 v253, 57344, v252
  ds_read_b64_tr_b16 v[136:137], v252 offset:0
  ds_read_b64_tr_b16 v[138:139], v252 offset:3584
  ds_read_b64_tr_b16 v[140:141], v252 offset:32
  ds_read_b64_tr_b16 v[142:143], v252 offset:3616
  ds_read_b64_tr_b16 v[144:145], v252 offset:64
  ds_read_b64_tr_b16 v[146:147], v252 offset:3648
  ds_read_b64_tr_b16 v[148:149], v252 offset:96
  ds_read_b64_tr_b16 v[150:151], v252 offset:3680
  ds_read_b64_tr_b16 v[152:153], v252 offset:128
  ds_read_b64_tr_b16 v[154:155], v252 offset:3712
  ds_read_b64_tr_b16 v[156:157], v252 offset:160
  ds_read_b64_tr_b16 v[158:159], v252 offset:3744
  ds_read_b64_tr_b16 v[160:161], v252 offset:192
  ds_read_b64_tr_b16 v[162:163], v252 offset:3776
  s_waitcnt vmcnt(6)
  s_waitcnt lgkmcnt(12)
  v_mfma_f32_16x16x32_bf16 v[192:195], v[136:139], v[8:11], 0
  ds_read_b64_tr_b16 v[164:165], v252 offset:7168
  v_mfma_f32_16x16x32_bf16 v[196:199], v[136:139], v[12:15], 0
  ds_read_b64_tr_b16 v[166:167], v252 offset:10752
  s_waitcnt lgkmcnt(12)
  v_mfma_f32_16x16x32_bf16 v[200:203], v[140:143], v[8:11], 0
  ds_read_b64_tr_b16 v[136:137], v252 offset:7200
  v_mfma_f32_16x16x32_bf16 v[204:207], v[140:143], v[12:15], 0
  ds_read_b64_tr_b16 v[138:139], v252 offset:10784
  buffer_load_dwordx4 v[40:43], v5, s[28:31], s47 offen offset:0 sc1
  buffer_load_dwordx4 v[44:47], v5, s[28:31], s48 offen offset:0 sc1
  s_waitcnt lgkmcnt(12)
  v_mfma_f32_16x16x32_bf16 v[208:211], v[144:147], v[8:11], 0
  ds_read_b64_tr_b16 v[140:141], v252 offset:7232
  v_mfma_f32_16x16x32_bf16 v[212:215], v[144:147], v[12:15], 0
  ds_read_b64_tr_b16 v[142:143], v252 offset:10816
  s_waitcnt lgkmcnt(12)
  v_mfma_f32_16x16x32_bf16 v[216:219], v[148:151], v[8:11], 0
  ds_read_b64_tr_b16 v[144:145], v252 offset:7264
  v_mfma_f32_16x16x32_bf16 v[220:223], v[148:151], v[12:15], 0
  ds_read_b64_tr_b16 v[146:147], v252 offset:10848
  s_waitcnt lgkmcnt(12)
  v_mfma_f32_16x16x32_bf16 v[224:227], v[152:155], v[8:11], 0
  ds_read_b64_tr_b16 v[148:149], v252 offset:7296
  v_mfma_f32_16x16x32_bf16 v[228:231], v[152:155], v[12:15], 0
  ds_read_b64_tr_b16 v[150:151], v252 offset:10880
  buffer_load_dwordx4 v[48:51], v5, s[28:31], s47 offen offset:1024 sc1
  buffer_load_dwordx4 v[52:55], v5, s[28:31], s48 offen offset:1024 sc1
  s_waitcnt lgkmcnt(12)
  v_mfma_f32_16x16x32_bf16 v[232:235], v[156:159], v[8:11], 0
  ds_read_b64_tr_b16 v[152:153], v252 offset:7328
  v_mfma_f32_16x16x32_bf16 v[236:239], v[156:159], v[12:15], 0
  ds_read_b64_tr_b16 v[154:155], v252 offset:10912
  s_waitcnt lgkmcnt(12)
  v_mfma_f32_16x16x32_bf16 v[240:243], v[160:163], v[8:11], 0
  ds_read_b64_tr_b16 v[156:157], v252 offset:7360
  v_mfma_f32_16x16x32_bf16 v[244:247], v[160:163], v[12:15], 0
  ds_read_b64_tr_b16 v[158:159], v252 offset:10944
  s_waitcnt vmcnt(8)
  s_waitcnt lgkmcnt(12)
  v_mfma_f32_16x16x32_bf16 v[192:195], v[164:167], v[16:19], v[192:195]
  ds_read_b64_tr_b16 v[160:161], v252 offset:14336
  v_mfma_f32_16x16x32_bf16 v[196:199], v[164:167], v[20:23], v[196:199]
  ds_read_b64_tr_b16 v[162:163], v252 offset:17920
  s_waitcnt lgkmcnt(12)
  v_mfma_f32_16x16x32_bf16 v[200:203], v[136:139], v[16:19], v[200:203]
  ds_read_b64_tr_b16 v[164:165], v252 offset:14368
  v_mfma_f32_16x16x32_bf16 v[204:207], v[136:139], v[20:23], v[204:207]
  ds_read_b64_tr_b16 v[166:167], v252 offset:17952
  buffer_load_dwordx4 v[56:59], v5, s[28:31], s47 offen offset:2048 sc1
  buffer_load_dwordx4 v[60:63], v5, s[28:31], s48 offen offset:2048 sc1
  s_waitcnt lgkmcnt(12)
  v_mfma_f32_16x16x32_bf16 v[208:211], v[140:143], v[16:19], v[208:211]
  ds_read_b64_tr_b16 v[136:137], v252 offset:14400
  v_mfma_f32_16x16x32_bf16 v[212:215], v[140:143], v[20:23], v[212:215]
  ds_read_b64_tr_b16 v[138:139], v252 offset:17984
  s_waitcnt lgkmcnt(12)
  v_mfma_f32_16x16x32_bf16 v[216:219], v[144:147], v[16:19], v[216:219]
  ds_read_b64_tr_b16 v[140:141], v252 offset:14432
  v_mfma_f32_16x16x32_bf16 v[220:223], v[144:147], v[20:23], v[220:223]
  ds_read_b64_tr_b16 v[142:143], v252 offset:18016
  s_waitcnt lgkmcnt(12)
  v_mfma_f32_16x16x32_bf16 v[224:227], v[148:151], v[16:19], v[224:227]
  ds_read_b64_tr_b16 v[144:145], v252 offset:14464
  v_mfma_f32_16x16x32_bf16 v[228:231], v[148:151], v[20:23], v[228:231]
  ds_read_b64_tr_b16 v[146:147], v252 offset:18048
  buffer_load_dwordx4 v[64:67], v5, s[28:31], s47 offen offset:3072 sc1
  buffer_load_dwordx4 v[68:71], v5, s[28:31], s48 offen offset:3072 sc1
  s_add_u32 s47, s47, 4096
  s_add_u32 s48, s48, 4096
  s_waitcnt lgkmcnt(12)
  v_mfma_f32_16x16x32_bf16 v[232:235], v[152:155], v[16:19], v[232:235]
  ds_read_b64_tr_b16 v[148:149], v252 offset:14496
  v_mfma_f32_16x16x32_bf16 v[236:239], v[152:155], v[20:23], v[236:239]
  ds_read_b64_tr_b16 v[150:151], v252 offset:18080
  s_waitcnt lgkmcnt(12)
  v_mfma_f32_16x16x32_bf16 v[240:243], v[156:159], v[16:19], v[240:243]
  ds_read_b64_tr_b16 v[152:153], v252 offset:14528
  v_mfma_f32_16x16x32_bf16 v[244:247], v[156:159], v[20:23], v[244:247]
  ds_read_b64_tr_b16 v[154:155], v252 offset:18112
  s_waitcnt vmcnt(10)
  s_waitcnt lgkmcnt(12)
  v_mfma_f32_16x16x32_bf16 v[192:195], v[160:163], v[24:27], v[192:195]
  ds_read_b64_tr_b16 v[156:157], v252 offset:21504
  v_mfma_f32_16x16x32_bf16 v[196:199], v[160:163], v[28:31], v[196:199]
  ds_read_b64_tr_b16 v[158:159], v252 offset:25088
  s_waitcnt lgkmcnt(12)
  v_mfma_f32_16x16x32_bf16 v[200:203], v[164:167], v[24:27], v[200:203]
  ds_read_b64_tr_b16 v[160:161], v252 offset:21536
  v_mfma_f32_16x16x32_bf16 v[204:207], v[164:167], v[28:31], v[204:207]
  ds_read_b64_tr_b16 v[162:163], v252 offset:25120
  buffer_load_dwordx4 v[72:75], v5, s[28:31], s47 offen offset:0 sc1
  buffer_load_dwordx4 v[76:79], v5, s[28:31], s48 offen offset:0 sc1
  s_waitcnt lgkmcnt(12)
  v_mfma_f32_16x16x32_bf16 v[208:211], v[136:139], v[24:27], v[208:211]
  ds_read_b64_tr_b16 v[164:165], v252 offset:21568
  v_mfma_f32_16x16x32_bf16 v[212:215], v[136:139], v[28:31], v[212:215]
  ds_read_b64_tr_b16 v[166:167], v252 offset:25152
  s_waitcnt lgkmcnt(12)
  v_mfma_f32_16x16x32_bf16 v[216:219], v[140:143], v[24:27], v[216:219]
  ds_read_b64_tr_b16 v[136:137], v252 offset:21600
  v_mfma_f32_16x16x32_bf16 v[220:223], v[140:143], v[28:31], v[220:223]
  ds_read_b64_tr_b16 v[138:139], v252 offset:25184
  s_waitcnt lgkmcnt(12)
  v_mfma_f32_16x16x32_bf16 v[224:227], v[144:147], v[24:27], v[224:227]
  ds_read_b64_tr_b16 v[140:141], v252 offset:21632
  v_mfma_f32_16x16x32_bf16 v[228:231], v[144:147], v[28:31], v[228:231]
  ds_read_b64_tr_b16 v[142:143], v252 offset:25216
  buffer_load_dwordx4 v[80:83], v5, s[28:31], s47 offen offset:1024 sc1
  buffer_load_dwordx4 v[84:87], v5, s[28:31], s48 offen offset:1024 sc1
  s_waitcnt lgkmcnt(12)
  v_mfma_f32_16x16x32_bf16 v[232:235], v[148:151], v[24:27], v[232:235]
  ds_read_b64_tr_b16 v[144:145], v252 offset:21664
  v_mfma_f32_16x16x32_bf16 v[236:239], v[148:151], v[28:31], v[236:239]
  ds_read_b64_tr_b16 v[146:147], v252 offset:25248
  s_waitcnt lgkmcnt(12)
  v_mfma_f32_16x16x32_bf16 v[240:243], v[152:155], v[24:27], v[240:243]
  ds_read_b64_tr_b16 v[148:149], v252 offset:21696
  v_mfma_f32_16x16x32_bf16 v[244:247], v[152:155], v[28:31], v[244:247]
  ds_read_b64_tr_b16 v[150:151], v252 offset:25280
  s_waitcnt vmcnt(12)
  s_waitcnt lgkmcnt(12)
  v_mfma_f32_16x16x32_bf16 v[192:195], v[156:159], v[32:35], v[192:195]
  ds_read_b64_tr_b16 v[152:153], v252 offset:28672
  v_mfma_f32_16x16x32_bf16 v[196:199], v[156:159], v[36:39], v[196:199]
  ds_read_b64_tr_b16 v[154:155], v252 offset:32256
  s_waitcnt lgkmcnt(12)
  v_mfma_f32_16x16x32_bf16 v[200:203], v[160:163], v[32:35], v[200:203]
  ds_read_b64_tr_b16 v[156:157], v252 offset:28704
  v_mfma_f32_16x16x32_bf16 v[204:207], v[160:163], v[36:39], v[204:207]
  ds_read_b64_tr_b16 v[158:159], v252 offset:32288
  buffer_load_dwordx4 v[88:91], v5, s[28:31], s47 offen offset:2048 sc1
  buffer_load_dwordx4 v[92:95], v5, s[28:31], s48 offen offset:2048 sc1
  s_waitcnt lgkmcnt(12)
  v_mfma_f32_16x16x32_bf16 v[208:211], v[164:167], v[32:35], v[208:211]
  ds_read_b64_tr_b16 v[160:161], v252 offset:28736
  v_mfma_f32_16x16x32_bf16 v[212:215], v[164:167], v[36:39], v[212:215]
  ds_read_b64_tr_b16 v[162:163], v252 offset:32320
  s_waitcnt lgkmcnt(12)
  v_mfma_f32_16x16x32_bf16 v[216:219], v[136:139], v[32:35], v[216:219]
  ds_read_b64_tr_b16 v[164:165], v252 offset:28768
  v_mfma_f32_16x16x32_bf16 v[220:223], v[136:139], v[36:39], v[220:223]
  ds_read_b64_tr_b16 v[166:167], v252 offset:32352
  s_waitcnt lgkmcnt(12)
  v_mfma_f32_16x16x32_bf16 v[224:227], v[140:143], v[32:35], v[224:227]
  ds_read_b64_tr_b16 v[136:137], v252 offset:28800
  v_mfma_f32_16x16x32_bf16 v[228:231], v[140:143], v[36:39], v[228:231]
  ds_read_b64_tr_b16 v[138:139], v252 offset:32384
  buffer_load_dwordx4 v[96:99], v5, s[28:31], s47 offen offset:3072 sc1
  buffer_load_dwordx4 v[100:103], v5, s[28:31], s48 offen offset:3072 sc1
  s_add_u32 s47, s47, 4096
  s_add_u32 s48, s48, 4096
  s_waitcnt lgkmcnt(12)
  v_mfma_f32_16x16x32_bf16 v[232:235], v[144:147], v[32:35], v[232:235]
  ds_read_b64_tr_b16 v[140:141], v252 offset:28832
  v_mfma_f32_16x16x32_bf16 v[236:239], v[144:147], v[36:39], v[236:239]
  ds_read_b64_tr_b16 v[142:143], v252 offset:32416
  s_waitcnt lgkmcnt(12)
  v_mfma_f32_16x16x32_bf16 v[240:243], v[148:151], v[32:35], v[240:243]
  ds_read_b64_tr_b16 v[144:145], v252 offset:28864
  v_mfma_f32_16x16x32_bf16 v[244:247], v[148:151], v[36:39], v[244:247]
  ds_read_b64_tr_b16 v[146:147], v252 offset:32448
  s_waitcnt vmcnt(14)
  s_waitcnt lgkmcnt(12)
  v_mfma_f32_16x16x32_bf16 v[192:195], v[152:155], v[40:43], v[192:195]
  ds_read_b64_tr_b16 v[148:149], v252 offset:35840
  v_mfma_f32_16x16x32_bf16 v[196:199], v[152:155], v[44:47], v[196:199]
  ds_read_b64_tr_b16 v[150:151], v252 offset:39424
  s_waitcnt lgkmcnt(12)
  v_mfma_f32_16x16x32_bf16 v[200:203], v[156:159], v[40:43], v[200:203]
  ds_read_b64_tr_b16 v[152:153], v252 offset:35872
  v_mfma_f32_16x16x32_bf16 v[204:207], v[156:159], v[44:47], v[204:207]
  ds_read_b64_tr_b16 v[154:155], v252 offset:39456
  buffer_load_dwordx4 v[104:107], v5, s[28:31], s47 offen offset:0 sc1
  buffer_load_dwordx4 v[108:111], v5, s[28:31], s48 offen offset:0 sc1
  s_waitcnt lgkmcnt(12)
  v_mfma_f32_16x16x32_bf16 v[208:211], v[160:163], v[40:43], v[208:211]
  ds_read_b64_tr_b16 v[156:157], v252 offset:35904
  v_mfma_f32_16x16x32_bf16 v[212:215], v[160:163], v[44:47], v[212:215]
  ds_read_b64_tr_b16 v[158:159], v252 offset:39488
  s_waitcnt lgkmcnt(12)
  v_mfma_f32_16x16x32_bf16 v[216:219], v[164:167], v[40:43], v[216:219]
  ds_read_b64_tr_b16 v[160:161], v252 offset:35936
  v_mfma_f32_16x16x32_bf16 v[220:223], v[164:167], v[44:47], v[220:223]
  ds_read_b64_tr_b16 v[162:163], v252 offset:39520
  s_waitcnt lgkmcnt(12)
  v_mfma_f32_16x16x32_bf16 v[224:227], v[136:139], v[40:43], v[224:227]
  ds_read_b64_tr_b16 v[164:165], v252 offset:35968
  v_mfma_f32_16x16x32_bf16 v[228:231], v[136:139], v[44:47], v[228:231]
  ds_read_b64_tr_b16 v[166:167], v252 offset:39552
  buffer_load_dwordx4 v[112:115], v5, s[28:31], s47 offen offset:1024 sc1
  buffer_load_dwordx4 v[116:119], v5, s[28:31], s48 offen offset:1024 sc1
  s_waitcnt lgkmcnt(12)
  v_mfma_f32_16x16x32_bf16 v[232:235], v[140:143], v[40:43], v[232:235]
  ds_read_b64_tr_b16 v[136:137], v252 offset:36000
  v_mfma_f32_16x16x32_bf16 v[236:239], v[140:143], v[44:47], v[236:239]
  ds_read_b64_tr_b16 v[138:139], v252 offset:39584
  s_waitcnt lgkmcnt(12)
  v_mfma_f32_16x16x32_bf16 v[240:243], v[144:147], v[40:43], v[240:243]
  ds_read_b64_tr_b16 v[140:141], v252 offset:36032
  v_mfma_f32_16x16x32_bf16 v[244:247], v[144:147], v[44:47], v[244:247]
  ds_read_b64_tr_b16 v[142:143], v252 offset:39616
  s_waitcnt vmcnt(16)
  s_waitcnt lgkmcnt(12)
  v_mfma_f32_16x16x32_bf16 v[192:195], v[148:151], v[48:51], v[192:195]
  ds_read_b64_tr_b16 v[144:145], v252 offset:43008
  v_mfma_f32_16x16x32_bf16 v[196:199], v[148:151], v[52:55], v[196:199]
  ds_read_b64_tr_b16 v[146:147], v252 offset:46592
  s_waitcnt lgkmcnt(12)
  v_mfma_f32_16x16x32_bf16 v[200:203], v[152:155], v[48:51], v[200:203]
  ds_read_b64_tr_b16 v[148:149], v252 offset:43040
  v_mfma_f32_16x16x32_bf16 v[204:207], v[152:155], v[52:55], v[204:207]
  ds_read_b64_tr_b16 v[150:151], v252 offset:46624
  buffer_load_dwordx4 v[120:123], v5, s[28:31], s47 offen offset:2048 sc1
  buffer_load_dwordx4 v[124:127], v5, s[28:31], s48 offen offset:2048 sc1
  s_waitcnt lgkmcnt(12)
  v_mfma_f32_16x16x32_bf16 v[208:211], v[156:159], v[48:51], v[208:211]
  ds_read_b64_tr_b16 v[152:153], v252 offset:43072
  v_mfma_f32_16x16x32_bf16 v[212:215], v[156:159], v[52:55], v[212:215]
  ds_read_b64_tr_b16 v[154:155], v252 offset:46656
  s_waitcnt lgkmcnt(12)
  v_mfma_f32_16x16x32_bf16 v[216:219], v[160:163], v[48:51], v[216:219]
  ds_read_b64_tr_b16 v[156:157], v252 offset:43104
  v_mfma_f32_16x16x32_bf16 v[220:223], v[160:163], v[52:55], v[220:223]
  ds_read_b64_tr_b16 v[158:159], v252 offset:46688
  s_waitcnt lgkmcnt(12)
  v_mfma_f32_16x16x32_bf16 v[224:227], v[164:167], v[48:51], v[224:227]
  ds_read_b64_tr_b16 v[160:161], v252 offset:43136
  v_mfma_f32_16x16x32_bf16 v[228:231], v[164:167], v[52:55], v[228:231]
  ds_read_b64_tr_b16 v[162:163], v252 offset:46720
  buffer_load_dwordx4 v[128:131], v5, s[28:31], s47 offen offset:3072 sc1
  buffer_load_dwordx4 v[132:135], v5, s[28:31], s48 offen offset:3072 sc1
  s_waitcnt lgkmcnt(12)
  v_mfma_f32_16x16x32_bf16 v[232:235], v[136:139], v[48:51], v[232:235]
  ds_read_b64_tr_b16 v[164:165], v252 offset:43168
  v_mfma_f32_16x16x32_bf16 v[236:239], v[136:139], v[52:55], v[236:239]
  ds_read_b64_tr_b16 v[166:167], v252 offset:46752
  s_waitcnt lgkmcnt(12)
  v_mfma_f32_16x16x32_bf16 v[240:243], v[140:143], v[48:51], v[240:243]
  ds_read_b64_tr_b16 v[136:137], v252 offset:43200
  v_mfma_f32_16x16x32_bf16 v[244:247], v[140:143], v[52:55], v[244:247]
  ds_read_b64_tr_b16 v[138:139], v252 offset:46784
  s_waitcnt vmcnt(18)
  s_waitcnt lgkmcnt(12)
  v_mfma_f32_16x16x32_bf16 v[192:195], v[144:147], v[56:59], v[192:195]
  ds_read_b64_tr_b16 v[140:141], v252 offset:50176
  v_mfma_f32_16x16x32_bf16 v[196:199], v[144:147], v[60:63], v[196:199]
  ds_read_b64_tr_b16 v[142:143], v252 offset:53760
  s_waitcnt lgkmcnt(12)
  v_mfma_f32_16x16x32_bf16 v[200:203], v[148:151], v[56:59], v[200:203]
  ds_read_b64_tr_b16 v[144:145], v252 offset:50208
  v_mfma_f32_16x16x32_bf16 v[204:207], v[148:151], v[60:63], v[204:207]
  ds_read_b64_tr_b16 v[146:147], v252 offset:53792
  s_waitcnt lgkmcnt(12)
  v_mfma_f32_16x16x32_bf16 v[208:211], v[152:155], v[56:59], v[208:211]
  ds_read_b64_tr_b16 v[148:149], v252 offset:50240
  v_mfma_f32_16x16x32_bf16 v[212:215], v[152:155], v[60:63], v[212:215]
  ds_read_b64_tr_b16 v[150:151], v252 offset:53824
  s_waitcnt lgkmcnt(12)
  v_mfma_f32_16x16x32_bf16 v[216:219], v[156:159], v[56:59], v[216:219]
  ds_read_b64_tr_b16 v[152:153], v252 offset:50272
  v_mfma_f32_16x16x32_bf16 v[220:223], v[156:159], v[60:63], v[220:223]
  ds_read_b64_tr_b16 v[154:155], v252 offset:53856
  s_waitcnt lgkmcnt(12)
  v_mfma_f32_16x16x32_bf16 v[224:227], v[160:163], v[56:59], v[224:227]
  ds_read_b64_tr_b16 v[156:157], v252 offset:50304
  v_mfma_f32_16x16x32_bf16 v[228:231], v[160:163], v[60:63], v[228:231]
  ds_read_b64_tr_b16 v[158:159], v252 offset:53888
  s_waitcnt lgkmcnt(12)
  v_mfma_f32_16x16x32_bf16 v[232:235], v[164:167], v[56:59], v[232:235]
  ds_read_b64_tr_b16 v[160:161], v252 offset:50336
  v_mfma_f32_16x16x32_bf16 v[236:239], v[164:167], v[60:63], v[236:239]
  ds_read_b64_tr_b16 v[162:163], v252 offset:53920
  s_waitcnt lgkmcnt(12)
  v_mfma_f32_16x16x32_bf16 v[240:243], v[136:139], v[56:59], v[240:243]
  ds_read_b64_tr_b16 v[164:165], v252 offset:50368
  v_mfma_f32_16x16x32_bf16 v[244:247], v[136:139], v[60:63], v[244:247]
  ds_read_b64_tr_b16 v[166:167], v252 offset:53952
  s_waitcnt vmcnt(16)
  s_waitcnt lgkmcnt(12)
  v_mfma_f32_16x16x32_bf16 v[192:195], v[140:143], v[64:67], v[192:195]
  ds_read_b64_tr_b16 v[136:137], v253 offset:0
  v_mfma_f32_16x16x32_bf16 v[196:199], v[140:143], v[68:71], v[196:199]
  ds_read_b64_tr_b16 v[138:139], v253 offset:3584
  s_waitcnt lgkmcnt(12)
  v_mfma_f32_16x16x32_bf16 v[200:203], v[144:147], v[64:67], v[200:203]
  ds_read_b64_tr_b16 v[140:141], v253 offset:32
  v_mfma_f32_16x16x32_bf16 v[204:207], v[144:147], v[68:71], v[204:207]
  ds_read_b64_tr_b16 v[142:143], v253 offset:3616
  s_waitcnt lgkmcnt(12)
  v_mfma_f32_16x16x32_bf16 v[208:211], v[148:151], v[64:67], v[208:211]
  ds_read_b64_tr_b16 v[144:145], v253 offset:64
  v_mfma_f32_16x16x32_bf16 v[212:215], v[148:151], v[68:71], v[212:215]
  ds_read_b64_tr_b16 v[146:147], v253 offset:3648
  s_waitcnt lgkmcnt(12)
  v_mfma_f32_16x16x32_bf16 v[216:219], v[152:155], v[64:67], v[216:219]
  ds_read_b64_tr_b16 v[148:149], v253 offset:96
  v_mfma_f32_16x16x32_bf16 v[220:223], v[152:155], v[68:71], v[220:223]
  ds_read_b64_tr_b16 v[150:151], v253 offset:3680
  s_waitcnt lgkmcnt(12)
  v_mfma_f32_16x16x32_bf16 v[224:227], v[156:159], v[64:67], v[224:227]
  ds_read_b64_tr_b16 v[152:153], v253 offset:128
  v_mfma_f32_16x16x32_bf16 v[228:231], v[156:159], v[68:71], v[228:231]
  ds_read_b64_tr_b16 v[154:155], v253 offset:3712
  s_waitcnt lgkmcnt(12)
  v_mfma_f32_16x16x32_bf16 v[232:235], v[160:163], v[64:67], v[232:235]
  ds_read_b64_tr_b16 v[156:157], v253 offset:160
  v_mfma_f32_16x16x32_bf16 v[236:239], v[160:163], v[68:71], v[236:239]
  ds_read_b64_tr_b16 v[158:159], v253 offset:3744
  s_waitcnt lgkmcnt(12)
  v_mfma_f32_16x16x32_bf16 v[240:243], v[164:167], v[64:67], v[240:243]
  ds_read_b64_tr_b16 v[160:161], v253 offset:192
  v_mfma_f32_16x16x32_bf16 v[244:247], v[164:167], v[68:71], v[244:247]
  ds_read_b64_tr_b16 v[162:163], v253 offset:3776
  s_waitcnt vmcnt(14)
  s_waitcnt lgkmcnt(12)
  v_mfma_f32_16x16x32_bf16 v[192:195], v[136:139], v[72:75], v[192:195]
  ds_read_b64_tr_b16 v[164:165], v253 offset:7168
  v_mfma_f32_16x16x32_bf16 v[196:199], v[136:139], v[76:79], v[196:199]
  ds_read_b64_tr_b16 v[166:167], v253 offset:10752
  s_waitcnt lgkmcnt(12)
  v_mfma_f32_16x16x32_bf16 v[200:203], v[140:143], v[72:75], v[200:203]
  ds_read_b64_tr_b16 v[136:137], v253 offset:7200
  v_mfma_f32_16x16x32_bf16 v[204:207], v[140:143], v[76:79], v[204:207]
  ds_read_b64_tr_b16 v[138:139], v253 offset:10784
  s_waitcnt lgkmcnt(12)
  v_mfma_f32_16x16x32_bf16 v[208:211], v[144:147], v[72:75], v[208:211]
  ds_read_b64_tr_b16 v[140:141], v253 offset:7232
  v_mfma_f32_16x16x32_bf16 v[212:215], v[144:147], v[76:79], v[212:215]
  ds_read_b64_tr_b16 v[142:143], v253 offset:10816
  s_waitcnt lgkmcnt(12)
  v_mfma_f32_16x16x32_bf16 v[216:219], v[148:151], v[72:75], v[216:219]
  ds_read_b64_tr_b16 v[144:145], v253 offset:7264
  v_mfma_f32_16x16x32_bf16 v[220:223], v[148:151], v[76:79], v[220:223]
  ds_read_b64_tr_b16 v[146:147], v253 offset:10848
  s_waitcnt lgkmcnt(12)
  v_mfma_f32_16x16x32_bf16 v[224:227], v[152:155], v[72:75], v[224:227]
  ds_read_b64_tr_b16 v[148:149], v253 offset:7296
  v_mfma_f32_16x16x32_bf16 v[228:231], v[152:155], v[76:79], v[228:231]
  ds_read_b64_tr_b16 v[150:151], v253 offset:10880
  s_waitcnt lgkmcnt(12)
  v_mfma_f32_16x16x32_bf16 v[232:235], v[156:159], v[72:75], v[232:235]
  ds_read_b64_tr_b16 v[152:153], v253 offset:7328
  v_mfma_f32_16x16x32_bf16 v[236:239], v[156:159], v[76:79], v[236:239]
  ds_read_b64_tr_b16 v[154:155], v253 offset:10912
  s_waitcnt lgkmcnt(12)
  v_mfma_f32_16x16x32_bf16 v[240:243], v[160:163], v[72:75], v[240:243]
  ds_read_b64_tr_b16 v[156:157], v253 offset:7360
  v_mfma_f32_16x16x32_bf16 v[244:247], v[160:163], v[76:79], v[244:247]
  ds_read_b64_tr_b16 v[158:159], v253 offset:10944
  s_waitcnt vmcnt(12)
  s_waitcnt lgkmcnt(12)
  v_mfma_f32_16x16x32_bf16 v[192:195], v[164:167], v[80:83], v[192:195]
  ds_read_b64_tr_b16 v[160:161], v253 offset:14336
  v_mfma_f32_16x16x32_bf16 v[196:199], v[164:167], v[84:87], v[196:199]
  ds_read_b64_tr_b16 v[162:163], v253 offset:17920
  s_waitcnt lgkmcnt(12)
  v_mfma_f32_16x16x32_bf16 v[200:203], v[136:139], v[80:83], v[200:203]
  ds_read_b64_tr_b16 v[164:165], v253 offset:14368
  v_mfma_f32_16x16x32_bf16 v[204:207], v[136:139], v[84:87], v[204:207]
  ds_read_b64_tr_b16 v[166:167], v253 offset:17952
  s_waitcnt lgkmcnt(12)
  v_mfma_f32_16x16x32_bf16 v[208:211], v[140:143], v[80:83], v[208:211]
  ds_read_b64_tr_b16 v[136:137], v253 offset:14400
  v_mfma_f32_16x16x32_bf16 v[212:215], v[140:143], v[84:87], v[212:215]
  ds_read_b64_tr_b16 v[138:139], v253 offset:17984
  s_waitcnt lgkmcnt(12)
  v_mfma_f32_16x16x32_bf16 v[216:219], v[144:147], v[80:83], v[216:219]
  ds_read_b64_tr_b16 v[140:141], v253 offset:14432
  v_mfma_f32_16x16x32_bf16 v[220:223], v[144:147], v[84:87], v[220:223]
  ds_read_b64_tr_b16 v[142:143], v253 offset:18016
  s_waitcnt lgkmcnt(12)
  v_mfma_f32_16x16x32_bf16 v[224:227], v[148:151], v[80:83], v[224:227]
  ds_read_b64_tr_b16 v[144:145], v253 offset:14464
  v_mfma_f32_16x16x32_bf16 v[228:231], v[148:151], v[84:87], v[228:231]
  ds_read_b64_tr_b16 v[146:147], v253 offset:18048
  s_waitcnt lgkmcnt(12)
  v_mfma_f32_16x16x32_bf16 v[232:235], v[152:155], v[80:83], v[232:235]
  ds_read_b64_tr_b16 v[148:149], v253 offset:14496
  v_mfma_f32_16x16x32_bf16 v[236:239], v[152:155], v[84:87], v[236:239]
  ds_read_b64_tr_b16 v[150:151], v253 offset:18080
  s_waitcnt lgkmcnt(12)
  v_mfma_f32_16x16x32_bf16 v[240:243], v[156:159], v[80:83], v[240:243]
  ds_read_b64_tr_b16 v[152:153], v253 offset:14528
  v_mfma_f32_16x16x32_bf16 v[244:247], v[156:159], v[84:87], v[244:247]
  ds_read_b64_tr_b16 v[154:155], v253 offset:18112
  s_waitcnt vmcnt(10)
  s_waitcnt lgkmcnt(12)
  v_mfma_f32_16x16x32_bf16 v[192:195], v[160:163], v[88:91], v[192:195]
  ds_read_b64_tr_b16 v[156:157], v253 offset:21504
  v_mfma_f32_16x16x32_bf16 v[196:199], v[160:163], v[92:95], v[196:199]
  ds_read_b64_tr_b16 v[158:159], v253 offset:25088
  s_waitcnt lgkmcnt(12)
  v_mfma_f32_16x16x32_bf16 v[200:203], v[164:167], v[88:91], v[200:203]
  ds_read_b64_tr_b16 v[160:161], v253 offset:21536
  v_mfma_f32_16x16x32_bf16 v[204:207], v[164:167], v[92:95], v[204:207]
  ds_read_b64_tr_b16 v[162:163], v253 offset:25120
  s_waitcnt lgkmcnt(12)
  v_mfma_f32_16x16x32_bf16 v[208:211], v[136:139], v[88:91], v[208:211]
  ds_read_b64_tr_b16 v[164:165], v253 offset:21568
  v_mfma_f32_16x16x32_bf16 v[212:215], v[136:139], v[92:95], v[212:215]
  ds_read_b64_tr_b16 v[166:167], v253 offset:25152
  s_waitcnt lgkmcnt(12)
  v_mfma_f32_16x16x32_bf16 v[216:219], v[140:143], v[88:91], v[216:219]
  ds_read_b64_tr_b16 v[136:137], v253 offset:21600
  v_mfma_f32_16x16x32_bf16 v[220:223], v[140:143], v[92:95], v[220:223]
  ds_read_b64_tr_b16 v[138:139], v253 offset:25184
  s_waitcnt lgkmcnt(12)
  v_mfma_f32_16x16x32_bf16 v[224:227], v[144:147], v[88:91], v[224:227]
  ds_read_b64_tr_b16 v[140:141], v253 offset:21632
  v_mfma_f32_16x16x32_bf16 v[228:231], v[144:147], v[92:95], v[228:231]
  ds_read_b64_tr_b16 v[142:143], v253 offset:25216
  s_waitcnt lgkmcnt(12)
  v_mfma_f32_16x16x32_bf16 v[232:235], v[148:151], v[88:91], v[232:235]
  ds_read_b64_tr_b16 v[144:145], v253 offset:21664
  v_mfma_f32_16x16x32_bf16 v[236:239], v[148:151], v[92:95], v[236:239]
  ds_read_b64_tr_b16 v[146:147], v253 offset:25248
  s_waitcnt lgkmcnt(12)
  v_mfma_f32_16x16x32_bf16 v[240:243], v[152:155], v[88:91], v[240:243]
  ds_read_b64_tr_b16 v[148:149], v253 offset:21696
  v_mfma_f32_16x16x32_bf16 v[244:247], v[152:155], v[92:95], v[244:247]
  ds_read_b64_tr_b16 v[150:151], v253 offset:25280
  s_waitcnt vmcnt(8)
  s_waitcnt lgkmcnt(12)
  v_mfma_f32_16x16x32_bf16 v[192:195], v[156:159], v[96:99], v[192:195]
  ds_read_b64_tr_b16 v[152:153], v253 offset:28672
  v_mfma_f32_16x16x32_bf16 v[196:199], v[156:159], v[100:103], v[196:199]
  ds_read_b64_tr_b16 v[154:155], v253 offset:32256
  s_waitcnt lgkmcnt(12)
  v_mfma_f32_16x16x32_bf16 v[200:203], v[160:163], v[96:99], v[200:203]
  ds_read_b64_tr_b16 v[156:157], v253 offset:28704
  v_mfma_f32_16x16x32_bf16 v[204:207], v[160:163], v[100:103], v[204:207]
  ds_read_b64_tr_b16 v[158:159], v253 offset:32288
  s_waitcnt lgkmcnt(12)
  v_mfma_f32_16x16x32_bf16 v[208:211], v[164:167], v[96:99], v[208:211]
  ds_read_b64_tr_b16 v[160:161], v253 offset:28736
  v_mfma_f32_16x16x32_bf16 v[212:215], v[164:167], v[100:103], v[212:215]
  ds_read_b64_tr_b16 v[162:163], v253 offset:32320
  s_waitcnt lgkmcnt(12)
  v_mfma_f32_16x16x32_bf16 v[216:219], v[136:139], v[96:99], v[216:219]
  ds_read_b64_tr_b16 v[164:165], v253 offset:28768
  v_mfma_f32_16x16x32_bf16 v[220:223], v[136:139], v[100:103], v[220:223]
  ds_read_b64_tr_b16 v[166:167], v253 offset:32352
  s_waitcnt lgkmcnt(12)
  v_mfma_f32_16x16x32_bf16 v[224:227], v[140:143], v[96:99], v[224:227]
  ds_read_b64_tr_b16 v[136:137], v253 offset:28800
  v_mfma_f32_16x16x32_bf16 v[228:231], v[140:143], v[100:103], v[228:231]
  ds_read_b64_tr_b16 v[138:139], v253 offset:32384
  s_waitcnt lgkmcnt(12)
  v_mfma_f32_16x16x32_bf16 v[232:235], v[144:147], v[96:99], v[232:235]
  ds_read_b64_tr_b16 v[140:141], v253 offset:28832
  v_mfma_f32_16x16x32_bf16 v[236:239], v[144:147], v[100:103], v[236:239]
  ds_read_b64_tr_b16 v[142:143], v253 offset:32416
  s_waitcnt lgkmcnt(12)
  v_mfma_f32_16x16x32_bf16 v[240:243], v[148:151], v[96:99], v[240:243]
  ds_read_b64_tr_b16 v[144:145], v253 offset:28864
  v_mfma_f32_16x16x32_bf16 v[244:247], v[148:151], v[100:103], v[244:247]
  ds_read_b64_tr_b16 v[146:147], v253 offset:32448
  s_waitcnt vmcnt(6)
  s_mul_i32 s47, s46, 229376
  s_and_b32 s48, s41, 1
  s_mul_i32 s48, s48, 114688
  s_add_u32 s47, s47, s48
  s_mul_i32 s48, s40, 7
  s_lshr_b32 s48, s48, 1
  s_lshl_b32 s48, s48, 10
  s_add_u32 s47, s47, s48
  s_add_u32 s47, s47, 10485760
  s_add_u32 s48, s47, 57344
  v_lshlrev_b32 v249, 3, v0
  s_waitcnt lgkmcnt(12)
  v_mfma_f32_16x16x32_bf16 v[192:195], v[152:155], v[104:107], v[192:195]
  ds_read_b64_tr_b16 v[148:149], v253 offset:35840
  v_mfma_f32_16x16x32_bf16 v[196:199], v[152:155], v[108:111], v[196:199]
  ds_read_b64_tr_b16 v[150:151], v253 offset:39424
  s_waitcnt lgkmcnt(12)
  v_mfma_f32_16x16x32_bf16 v[200:203], v[156:159], v[104:107], v[200:203]
  ds_read_b64_tr_b16 v[152:153], v253 offset:35872
  v_mfma_f32_16x16x32_bf16 v[204:207], v[156:159], v[108:111], v[204:207]
  ds_read_b64_tr_b16 v[154:155], v253 offset:39456
  s_waitcnt lgkmcnt(12)
  v_mfma_f32_16x16x32_bf16 v[208:211], v[160:163], v[104:107], v[208:211]
  ds_read_b64_tr_b16 v[156:157], v253 offset:35904
  v_mfma_f32_16x16x32_bf16 v[212:215], v[160:163], v[108:111], v[212:215]
  ds_read_b64_tr_b16 v[158:159], v253 offset:39488
  s_waitcnt lgkmcnt(12)
  v_mfma_f32_16x16x32_bf16 v[216:219], v[164:167], v[104:107], v[216:219]
  ds_read_b64_tr_b16 v[160:161], v253 offset:35936
  v_mfma_f32_16x16x32_bf16 v[220:223], v[164:167], v[108:111], v[220:223]
  ds_read_b64_tr_b16 v[162:163], v253 offset:39520
  s_waitcnt lgkmcnt(12)
  v_mfma_f32_16x16x32_bf16 v[224:227], v[136:139], v[104:107], v[224:227]
  ds_read_b64_tr_b16 v[164:165], v253 offset:35968
  v_mfma_f32_16x16x32_bf16 v[228:231], v[136:139], v[108:111], v[228:231]
  ds_read_b64_tr_b16 v[166:167], v253 offset:39552
  s_waitcnt lgkmcnt(12)
  v_mfma_f32_16x16x32_bf16 v[232:235], v[140:143], v[104:107], v[232:235]
  ds_read_b64_tr_b16 v[136:137], v253 offset:36000
  v_mfma_f32_16x16x32_bf16 v[236:239], v[140:143], v[108:111], v[236:239]
  ds_read_b64_tr_b16 v[138:139], v253 offset:39584
  s_waitcnt lgkmcnt(12)
  v_mfma_f32_16x16x32_bf16 v[240:243], v[144:147], v[104:107], v[240:243]
  ds_read_b64_tr_b16 v[140:141], v253 offset:36032
  v_mfma_f32_16x16x32_bf16 v[244:247], v[144:147], v[108:111], v[244:247]
  ds_read_b64_tr_b16 v[142:143], v253 offset:39616
  s_waitcnt vmcnt(4)
  s_waitcnt lgkmcnt(12)
  v_mfma_f32_16x16x32_bf16 v[192:195], v[148:151], v[112:115], v[192:195]
  ds_read_b64_tr_b16 v[144:145], v253 offset:43008
  v_mfma_f32_16x16x32_bf16 v[196:199], v[148:151], v[116:119], v[196:199]
  ds_read_b64_tr_b16 v[146:147], v253 offset:46592
  s_waitcnt lgkmcnt(12)
  v_mfma_f32_16x16x32_bf16 v[200:203], v[152:155], v[112:115], v[200:203]
  ds_read_b64_tr_b16 v[148:149], v253 offset:43040
  v_mfma_f32_16x16x32_bf16 v[204:207], v[152:155], v[116:119], v[204:207]
  ds_read_b64_tr_b16 v[150:151], v253 offset:46624
  s_waitcnt lgkmcnt(12)
  v_mfma_f32_16x16x32_bf16 v[208:211], v[156:159], v[112:115], v[208:211]
  ds_read_b64_tr_b16 v[152:153], v253 offset:43072
  v_mfma_f32_16x16x32_bf16 v[212:215], v[156:159], v[116:119], v[212:215]
  ds_read_b64_tr_b16 v[154:155], v253 offset:46656
  s_waitcnt lgkmcnt(12)
  v_mfma_f32_16x16x32_bf16 v[216:219], v[160:163], v[112:115], v[216:219]
  ds_read_b64_tr_b16 v[156:157], v253 offset:43104
  v_mfma_f32_16x16x32_bf16 v[220:223], v[160:163], v[116:119], v[220:223]
  ds_read_b64_tr_b16 v[158:159], v253 offset:46688
  s_waitcnt lgkmcnt(12)
  v_mfma_f32_16x16x32_bf16 v[224:227], v[164:167], v[112:115], v[224:227]
  ds_read_b64_tr_b16 v[160:161], v253 offset:43136
  v_mfma_f32_16x16x32_bf16 v[228:231], v[164:167], v[116:119], v[228:231]
  ds_read_b64_tr_b16 v[162:163], v253 offset:46720
  s_waitcnt lgkmcnt(12)
  v_mfma_f32_16x16x32_bf16 v[232:235], v[136:139], v[112:115], v[232:235]
  ds_read_b64_tr_b16 v[164:165], v253 offset:43168
  v_mfma_f32_16x16x32_bf16 v[236:239], v[136:139], v[116:119], v[236:239]
  ds_read_b64_tr_b16 v[166:167], v253 offset:46752
  s_waitcnt lgkmcnt(12)
  v_mfma_f32_16x16x32_bf16 v[240:243], v[140:143], v[112:115], v[240:243]
  ds_read_b64_tr_b16 v[136:137], v253 offset:43200
  v_mfma_f32_16x16x32_bf16 v[244:247], v[140:143], v[116:119], v[244:247]
  ds_read_b64_tr_b16 v[138:139], v253 offset:46784
  s_waitcnt vmcnt(2)
  s_waitcnt lgkmcnt(12)
  v_mfma_f32_16x16x32_bf16 v[192:195], v[144:147], v[120:123], v[192:195]
  ds_read_b64_tr_b16 v[140:141], v253 offset:50176
  v_mfma_f32_16x16x32_bf16 v[196:199], v[144:147], v[124:127], v[196:199]
  ds_read_b64_tr_b16 v[142:143], v253 offset:53760
  s_waitcnt lgkmcnt(12)
  v_mfma_f32_16x16x32_bf16 v[200:203], v[148:151], v[120:123], v[200:203]
  ds_read_b64_tr_b16 v[144:145], v253 offset:50208
  v_mfma_f32_16x16x32_bf16 v[204:207], v[148:151], v[124:127], v[204:207]
  ds_read_b64_tr_b16 v[146:147], v253 offset:53792
  s_waitcnt lgkmcnt(12)
  v_mfma_f32_16x16x32_bf16 v[208:211], v[152:155], v[120:123], v[208:211]
  ds_read_b64_tr_b16 v[148:149], v253 offset:50240
  v_mfma_f32_16x16x32_bf16 v[212:215], v[152:155], v[124:127], v[212:215]
  ds_read_b64_tr_b16 v[150:151], v253 offset:53824
  s_waitcnt lgkmcnt(12)
  v_mfma_f32_16x16x32_bf16 v[216:219], v[156:159], v[120:123], v[216:219]
  ds_read_b64_tr_b16 v[152:153], v253 offset:50272
  v_mfma_f32_16x16x32_bf16 v[220:223], v[156:159], v[124:127], v[220:223]
  ds_read_b64_tr_b16 v[154:155], v253 offset:53856
  s_waitcnt lgkmcnt(12)
  v_mfma_f32_16x16x32_bf16 v[224:227], v[160:163], v[120:123], v[224:227]
  ds_read_b64_tr_b16 v[156:157], v253 offset:50304
  v_mfma_f32_16x16x32_bf16 v[228:231], v[160:163], v[124:127], v[228:231]
  ds_read_b64_tr_b16 v[158:159], v253 offset:53888
  s_waitcnt lgkmcnt(12)
  v_mfma_f32_16x16x32_bf16 v[232:235], v[164:167], v[120:123], v[232:235]
  ds_read_b64_tr_b16 v[160:161], v253 offset:50336
  v_mfma_f32_16x16x32_bf16 v[236:239], v[164:167], v[124:127], v[236:239]
  ds_read_b64_tr_b16 v[162:163], v253 offset:53920
  s_waitcnt lgkmcnt(12)
  v_mfma_f32_16x16x32_bf16 v[240:243], v[136:139], v[120:123], v[240:243]
  ds_read_b64_tr_b16 v[164:165], v253 offset:50368
  v_mfma_f32_16x16x32_bf16 v[244:247], v[136:139], v[124:127], v[244:247]
  ds_read_b64_tr_b16 v[166:167], v253 offset:53952
  s_waitcnt vmcnt(0)
  s_waitcnt lgkmcnt(12)
  v_mfma_f32_16x16x32_bf16 v[192:195], v[140:143], v[128:131], v[192:195]
  v_mfma_f32_16x16x32_bf16 v[196:199], v[140:143], v[132:135], v[196:199]
  s_waitcnt lgkmcnt(10)
  v_mfma_f32_16x16x32_bf16 v[200:203], v[144:147], v[128:131], v[200:203]
  v_mfma_f32_16x16x32_bf16 v[204:207], v[144:147], v[132:135], v[204:207]
  s_waitcnt lgkmcnt(8)
  v_mfma_f32_16x16x32_bf16 v[208:211], v[148:151], v[128:131], v[208:211]
  v_mfma_f32_16x16x32_bf16 v[212:215], v[148:151], v[132:135], v[212:215]
  s_nop 0
  v_cvt_pk_bf16_f32 v8, v192, v193
  v_cvt_pk_bf16_f32 v9, v194, v195
  v_pk_max_i16 v8, v8, 0
  v_pk_max_i16 v9, v9, 0
  v_cvt_pk_bf16_f32 v24, v196, v197
  v_cvt_pk_bf16_f32 v25, v198, v199
  v_pk_max_i16 v24, v24, 0
  v_pk_max_i16 v25, v25, 0
  s_waitcnt lgkmcnt(6)
  v_mfma_f32_16x16x32_bf16 v[216:219], v[152:155], v[128:131], v[216:219]
  v_mfma_f32_16x16x32_bf16 v[220:223], v[152:155], v[132:135], v[220:223]
  v_cvt_pk_bf16_f32 v10, v200, v201
  v_cvt_pk_bf16_f32 v11, v202, v203
  v_pk_max_i16 v10, v10, 0
  v_pk_max_i16 v11, v11, 0
  v_cvt_pk_bf16_f32 v26, v204, v205
  v_cvt_pk_bf16_f32 v27, v206, v207
  v_pk_max_i16 v26, v26, 0
  v_pk_max_i16 v27, v27, 0
  s_waitcnt lgkmcnt(4)
  v_mfma_f32_16x16x32_bf16 v[224:227], v[156:159], v[128:131], v[224:227]
  v_mfma_f32_16x16x32_bf16 v[228:231], v[156:159], v[132:135], v[228:231]
  v_cvt_pk_bf16_f32 v12, v208, v209
  v_cvt_pk_bf16_f32 v13, v210, v211
  v_pk_max_i16 v12, v12, 0
  v_pk_max_i16 v13, v13, 0
  v_cvt_pk_bf16_f32 v28, v212, v213
  v_cvt_pk_bf16_f32 v29, v214, v215
  v_pk_max_i16 v28, v28, 0
  v_pk_max_i16 v29, v29, 0
  s_waitcnt lgkmcnt(2)
  v_mfma_f32_16x16x32_bf16 v[232:235], v[160:163], v[128:131], v[232:235]
  v_mfma_f32_16x16x32_bf16 v[236:239], v[160:163], v[132:135], v[236:239]
  v_cvt_pk_bf16_f32 v14, v216, v217
  v_cvt_pk_bf16_f32 v15, v218, v219
  v_pk_max_i16 v14, v14, 0
  v_pk_max_i16 v15, v15, 0
  v_cvt_pk_bf16_f32 v30, v220, v221
  v_cvt_pk_bf16_f32 v31, v222, v223
  v_pk_max_i16 v30, v30, 0
  v_pk_max_i16 v31, v31, 0
  s_waitcnt lgkmcnt(0)
  v_mfma_f32_16x16x32_bf16 v[240:243], v[164:167], v[128:131], v[240:243]
  v_mfma_f32_16x16x32_bf16 v[244:247], v[164:167], v[132:135], v[244:247]
  v_cvt_pk_bf16_f32 v16, v224, v225
  v_cvt_pk_bf16_f32 v17, v226, v227
  v_pk_max_i16 v16, v16, 0
  v_pk_max_i16 v17, v17, 0
  v_cvt_pk_bf16_f32 v32, v228, v229
  v_cvt_pk_bf16_f32 v33, v230, v231
  v_pk_max_i16 v32, v32, 0
  v_pk_max_i16 v33, v33, 0
  v_cvt_pk_bf16_f32 v18, v232, v233
  v_cvt_pk_bf16_f32 v19, v234, v235
  v_pk_max_i16 v18, v18, 0
  v_pk_max_i16 v19, v19, 0
  v_cvt_pk_bf16_f32 v34, v236, v237
  v_cvt_pk_bf16_f32 v35, v238, v239
  v_pk_max_i16 v34, v34, 0
  v_pk_max_i16 v35, v35, 0
  v_cvt_pk_bf16_f32 v20, v240, v241
  v_cvt_pk_bf16_f32 v21, v242, v243
  v_pk_max_i16 v20, v20, 0
  v_pk_max_i16 v21, v21, 0
  v_cvt_pk_bf16_f32 v36, v244, v245
  v_cvt_pk_bf16_f32 v37, v246, v247
  v_pk_max_i16 v36, v36, 0
  v_pk_max_i16 v37, v37, 0
  s_bitcmp1_b32 s40, 0
  s_cbranch_scc1 ODD_47
  s_cmp_eq_u32 s43, 0
  s_cbranch_scc1 SLOW_49
  buffer_store_dwordx4 v[8:11], v5, s[28:31], s47 offen offset:0
  buffer_store_dwordx4 v[12:15], v5, s[28:31], s47 offen offset:1024
  buffer_store_dwordx4 v[16:19], v5, s[28:31], s47 offen offset:2048
  buffer_store_dwordx2 v[20:21], v249, s[28:31], s47 offen offset:3072
  buffer_store_dwordx4 v[24:27], v5, s[28:31], s48 offen offset:0
  buffer_store_dwordx4 v[28:31], v5, s[28:31], s48 offen offset:1024
  buffer_store_dwordx4 v[32:35], v5, s[28:31], s48 offen offset:2048
  buffer_store_dwordx2 v[36:37], v249, s[28:31], s48 offen offset:3072
  s_branch JOIN_50
SLOW_49:
  buffer_store_dwordx4 v[8:11], v5, s[28:31], s47 offen offset:0 sc1
  buffer_store_dwordx4 v[12:15], v5, s[28:31], s47 offen offset:1024 sc1
  buffer_store_dwordx4 v[16:19], v5, s[28:31], s47 offen offset:2048 sc1
  buffer_store_dwordx2 v[20:21], v249, s[28:31], s47 offen offset:3072 sc1
  buffer_store_dwordx4 v[24:27], v5, s[28:31], s48 offen offset:0 sc1
  buffer_store_dwordx4 v[28:31], v5, s[28:31], s48 offen offset:1024 sc1
  buffer_store_dwordx4 v[32:35], v5, s[28:31], s48 offen offset:2048 sc1
  buffer_store_dwordx2 v[36:37], v249, s[28:31], s48 offen offset:3072 sc1
JOIN_50:
  s_branch GJ_48
ODD_47:
  s_cmp_eq_u32 s43, 0
  s_cbranch_scc1 SLOW_51
  buffer_store_dwordx2 v[8:9], v249, s[28:31], s47 offen offset:512
  buffer_store_dwordx4 v[10:13], v5, s[28:31], s47 offen offset:1024
  buffer_store_dwordx4 v[14:17], v5, s[28:31], s47 offen offset:2048
  buffer_store_dwordx4 v[18:21], v5, s[28:31], s47 offen offset:3072
  buffer_store_dwordx2 v[24:25], v249, s[28:31], s48 offen offset:512
  buffer_store_dwordx4 v[26:29], v5, s[28:31], s48 offen offset:1024
  buffer_store_dwordx4 v[30:33], v5, s[28:31], s48 offen offset:2048
  buffer_store_dwordx4 v[34:37], v5, s[28:31], s48 offen offset:3072
  s_branch JOIN_52
SLOW_51:
  buffer_store_dwordx2 v[8:9], v249, s[28:31], s47 offen offset:512 sc1
  buffer_store_dwordx4 v[10:13], v5, s[28:31], s47 offen offset:1024 sc1
  buffer_store_dwordx4 v[14:17], v5, s[28:31], s47 offen offset:2048 sc1
  buffer_store_dwordx4 v[18:21], v5, s[28:31], s47 offen offset:3072 sc1
  buffer_store_dwordx2 v[24:25], v249, s[28:31], s48 offen offset:512 sc1
  buffer_store_dwordx4 v[26:29], v5, s[28:31], s48 offen offset:1024 sc1
  buffer_store_dwordx4 v[30:33], v5, s[28:31], s48 offen offset:2048 sc1
  buffer_store_dwordx4 v[34:37], v5, s[28:31], s48 offen offset:3072 sc1
JOIN_52:
GJ_48:
  s_lshr_b32 s54, s37, 4
  s_lshl_b32 s48, s36, 1
  s_add_u32 s54, s54, s48
  s_lshl_b32 s54, s54, 8
  s_add_u32 s54, s54, 20119552
  s_lshl_b32 s48, s40, 4
  s_add_u32 s54, s54, s48
  s_lshl_b32 s48, s41, 2
  s_add_u32 s54, s54, s48
  s_add_u32 s57, s42, 96
  v_mov_b32 v222, s57
  v_mov_b32 v223, s54
  s_waitcnt vmcnt(0)
  s_mov_b64 exec, 1
  s_cmp_eq_u32 s43, 0
  s_cbranch_scc1 SLOW_53
  buffer_store_dword v222, v223, s[28:31], 0 offen
  s_branch JOIN_54
SLOW_53:
  buffer_store_dword v222, v223, s[28:31], 0 offen sc1
JOIN_54:
  s_mov_b64 exec, -1
  s_lshl_b32 s47, s38, 16
  s_lshl_b32 s48, s41, 14
  s_add_u32 s47, s47, s48
  s_lshl_b32 s48, s39, 7
  s_add_u32 s47, s47, s48
  v_lshlrev_b32 v6, 10, v1
  v_lshl_add_u32 v6, v2, 3, v6
  v_add_u32 v6, s47, v6
  v_lshlrev_b32 v5, 4, v0
  s_lshr_b32 s47, s37, 4
  s_lshl_b32 s48, s36, 1
  s_add_u32 s47, s47, s48
  s_lshl_b32 s47, s47, 8
  s_add_u32 s47, s47, 20119552
  s_lshl_b32 s48, s41, 6
  s_add_u32 s47, s47, s48
  v_lshlrev_b32 v222, 2, v1
  v_add_u32 v222, s47, v222
  s_add_u32 s56, s42, 96
  s_mov_b32 s58, 0x40000
POLL_55:
  buffer_load_dword v223, v222, s[28:31], 0 offen sc1
  s_waitcnt vmcnt(0)
  v_cmp_ne_u32 vcc, s56, v223
  s_nop 4
  s_cbranch_vccz PD_56
  s_sub_u32 s58, s58, 1
  s_cmp_lg_u32 s58, 0
  s_cbranch_scc1 POLL_55
PD_56:
  s_mov_b32 s49, 4194304
  v_lshlrev_b32 v7, 3, v0
  s_mul_i32 s47, s38, 229376
  s_mul_i32 s48, s41, 14336
  s_add_u32 s47, s47, s48
  s_add_u32 s47, s47, 10485760
  s_add_u32 s48, s41, 0
  s_and_b32 s48, s48, 3
  s_mul_i32 s48, s48, 57344
  s_add_u32 s50, s47, s48
  s_add_u32 s48, s41, 1
  s_and_b32 s48, s48, 3
  s_mul_i32 s48, s48, 57344
  s_add_u32 s51, s47, s48
  s_add_u32 s48, s41, 2
  s_and_b32 s48, s48, 3
  s_mul_i32 s48, s48, 57344
  s_add_u32 s52, s47, s48
  s_add_u32 s48, s41, 3
  s_and_b32 s48, s48, 3
  s_mul_i32 s48, s48, 57344
  s_add_u32 s53, s47, s48
  buffer_load_dwordx4 v[72:75], v5, s[28:31], s50 offen offset:0 sc1
  buffer_load_dwordx4 v[76:79], v5, s[28:31], s51 offen offset:0 sc1
  buffer_load_dwordx4 v[80:83], v5, s[28:31], s52 offen offset:0 sc1
  buffer_load_dwordx4 v[84:87], v5, s[28:31], s53 offen offset:0 sc1
  buffer_load_dwordx4 v[88:91], v5, s[28:31], s50 offen offset:1024 sc1
  buffer_load_dwordx4 v[92:95], v5, s[28:31], s51 offen offset:1024 sc1
  buffer_load_dwordx4 v[96:99], v5, s[28:31], s52 offen offset:1024 sc1
  buffer_load_dwordx4 v[100:103], v5, s[28:31], s53 offen offset:1024 sc1
  buffer_load_dwordx4 v[104:107], v5, s[28:31], s50 offen offset:2048 sc1
  buffer_load_dwordx4 v[108:111], v5, s[28:31], s51 offen offset:2048 sc1
  buffer_load_dwordx4 v[112:115], v5, s[28:31], s52 offen offset:2048 sc1
  buffer_load_dwordx4 v[116:119], v5, s[28:31], s53 offen offset:2048 sc1
  s_waitcnt vmcnt(8)
  v_mfma_f32_16x16x32_bf16 v[8:11], a[0:3], v[72:75], 0
  v_mfma_f32_16x16x32_bf16 v[12:15], a[4:7], v[72:75], 0
  v_mfma_f32_16x16x32_bf16 v[16:19], a[8:11], v[72:75], 0
  v_mfma_f32_16x16x32_bf16 v[20:23], a[12:15], v[72:75], 0
  v_mfma_f32_16x16x32_bf16 v[24:27], a[0:3], v[76:79], 0
  v_mfma_f32_16x16x32_bf16 v[28:31], a[4:7], v[76:79], 0
  v_mfma_f32_16x16x32_bf16 v[32:35], a[8:11], v[76:79], 0
  v_mfma_f32_16x16x32_bf16 v[36:39], a[12:15], v[76:79], 0
  v_mfma_f32_16x16x32_bf16 v[40:43], a[0:3], v[80:83], 0
  v_mfma_f32_16x16x32_bf16 v[44:47], a[4:7], v[80:83], 0
  v_mfma_f32_16x16x32_bf16 v[48:51], a[8:11], v[80:83], 0
  v_mfma_f32_16x16x32_bf16 v[52:55], a[12:15], v[80:83], 0
  v_mfma_f32_16x16x32_bf16 v[56:59], a[0:3], v[84:87], 0
  v_mfma_f32_16x16x32_bf16 v[60:63], a[4:7], v[84:87], 0
  v_mfma_f32_16x16x32_bf16 v[64:67], a[8:11], v[84:87], 0
  v_mfma_f32_16x16x32_bf16 v[68:71], a[12:15], v[84:87], 0
  buffer_load_dwordx2 v[120:121], v7, s[28:31], s50 offen offset:3072 sc1
  buffer_load_dwordx2 v[122:123], v7, s[28:31], s50 offen offset:3584 sc1
  buffer_load_dwordx2 v[124:125], v7, s[28:31], s51 offen offset:3072 sc1
  buffer_load_dwordx2 v[126:127], v7, s[28:31], s51 offen offset:3584 sc1
  buffer_load_dwordx2 v[128:129], v7, s[28:31], s52 offen offset:3072 sc1
  buffer_load_dwordx2 v[130:131], v7, s[28:31], s52 offen offset:3584 sc1
  buffer_load_dwordx2 v[132:133], v7, s[28:31], s53 offen offset:3072 sc1
  buffer_load_dwordx2 v[134:135], v7, s[28:31], s53 offen offset:3584 sc1
  s_add_u32 s50, s50, 4096
  s_add_u32 s51, s51, 4096
  s_add_u32 s52, s52, 4096
  s_add_u32 s53, s53, 4096
  buffer_load_dwordx4 v[136:139], v5, s[28:31], s50 offen offset:0 sc1
  buffer_load_dwordx4 v[140:143], v5, s[28:31], s51 offen offset:0 sc1
  buffer_load_dwordx4 v[144:147], v5, s[28:31], s52 offen offset:0 sc1
  buffer_load_dwordx4 v[148:151], v5, s[28:31], s53 offen offset:0 sc1
  s_waitcnt vmcnt(16)
  v_mfma_f32_16x16x32_bf16 v[8:11], a[16:19], v[88:91], v[8:11]
  v_mfma_f32_16x16x32_bf16 v[12:15], a[20:23], v[88:91], v[12:15]
  v_mfma_f32_16x16x32_bf16 v[16:19], a[24:27], v[88:91], v[16:19]
  v_mfma_f32_16x16x32_bf16 v[20:23], a[28:31], v[88:91], v[20:23]
  v_mfma_f32_16x16x32_bf16 v[24:27], a[16:19], v[92:95], v[24:27]
  v_mfma_f32_16x16x32_bf16 v[28:31], a[20:23], v[92:95], v[28:31]
  v_mfma_f32_16x16x32_bf16 v[32:35], a[24:27], v[92:95], v[32:35]
  v_mfma_f32_16x16x32_bf16 v[36:39], a[28:31], v[92:95], v[36:39]
  v_mfma_f32_16x16x32_bf16 v[40:43], a[16:19], v[96:99], v[40:43]
  v_mfma_f32_16x16x32_bf16 v[44:47], a[20:23], v[96:99], v[44:47]
  v_mfma_f32_16x16x32_bf16 v[48:51], a[24:27], v[96:99], v[48:51]
  v_mfma_f32_16x16x32_bf16 v[52:55], a[28:31], v[96:99], v[52:55]
  v_mfma_f32_16x16x32_bf16 v[56:59], a[16:19], v[100:103], v[56:59]
  v_mfma_f32_16x16x32_bf16 v[60:63], a[20:23], v[100:103], v[60:63]
  v_mfma_f32_16x16x32_bf16 v[64:67], a[24:27], v[100:103], v[64:67]
  v_mfma_f32_16x16x32_bf16 v[68:71], a[28:31], v[100:103], v[68:71]
  buffer_load_dwordx4 v[152:155], v5, s[28:31], s50 offen offset:1024 sc1
  buffer_load_dwordx4 v[156:159], v5, s[28:31], s51 offen offset:1024 sc1
  buffer_load_dwordx4 v[160:163], v5, s[28:31], s52 offen offset:1024 sc1
  buffer_load_dwordx4 v[164:167], v5, s[28:31], s53 offen offset:1024 sc1
  buffer_load_dwordx4 v[168:171], v5, s[28:31], s50 offen offset:2048 sc1
  buffer_load_dwordx4 v[172:175], v5, s[28:31], s51 offen offset:2048 sc1
  buffer_load_dwordx4 v[176:179], v5, s[28:31], s52 offen offset:2048 sc1
  buffer_load_dwordx4 v[180:183], v5, s[28:31], s53 offen offset:2048 sc1
  s_waitcnt vmcnt(20)
  v_mfma_f32_16x16x32_bf16 v[8:11], a[32:35], v[104:107], v[8:11]
  v_mfma_f32_16x16x32_bf16 v[12:15], a[36:39], v[104:107], v[12:15]
  v_mfma_f32_16x16x32_bf16 v[16:19], a[40:43], v[104:107], v[16:19]
  v_mfma_f32_16x16x32_bf16 v[20:23], a[44:47], v[104:107], v[20:23]
  v_mfma_f32_16x16x32_bf16 v[24:27], a[32:35], v[108:111], v[24:27]
  v_mfma_f32_16x16x32_bf16 v[28:31], a[36:39], v[108:111], v[28:31]
  v_mfma_f32_16x16x32_bf16 v[32:35], a[40:43], v[108:111], v[32:35]
  v_mfma_f32_16x16x32_bf16 v[36:39], a[44:47], v[108:111], v[36:39]
  v_mfma_f32_16x16x32_bf16 v[40:43], a[32:35], v[112:115], v[40:43]
  v_mfma_f32_16x16x32_bf16 v[44:47], a[36:39], v[112:115], v[44:47]
  v_mfma_f32_16x16x32_bf16 v[48:51], a[40:43], v[112:115], v[48:51]
  v_mfma_f32_16x16x32_bf16 v[52:55], a[44:47], v[112:115], v[52:55]
  v_mfma_f32_16x16x32_bf16 v[56:59], a[32:35], v[116:119], v[56:59]
  v_mfma_f32_16x16x32_bf16 v[60:63], a[36:39], v[116:119], v[60:63]
  v_mfma_f32_16x16x32_bf16 v[64:67], a[40:43], v[116:119], v[64:67]
  v_mfma_f32_16x16x32_bf16 v[68:71], a[44:47], v[116:119], v[68:71]
  buffer_load_dwordx4 v[184:187], v5, s[28:31], s50 offen offset:3072 sc1
  buffer_load_dwordx4 v[188:191], v5, s[28:31], s51 offen offset:3072 sc1
  buffer_load_dwordx4 v[192:195], v5, s[28:31], s52 offen offset:3072 sc1
  buffer_load_dwordx4 v[196:199], v5, s[28:31], s53 offen offset:3072 sc1
  s_add_u32 s50, s50, 4096
  s_add_u32 s51, s51, 4096
  s_add_u32 s52, s52, 4096
  s_add_u32 s53, s53, 4096
  buffer_load_dwordx4 v[72:75], v5, s[28:31], s50 offen offset:0 sc1
  buffer_load_dwordx4 v[76:79], v5, s[28:31], s51 offen offset:0 sc1
  buffer_load_dwordx4 v[80:83], v5, s[28:31], s52 offen offset:0 sc1
  buffer_load_dwordx4 v[84:87], v5, s[28:31], s53 offen offset:0 sc1
  s_waitcnt vmcnt(20)
  v_mfma_f32_16x16x32_bf16 v[8:11], a[48:51], v[120:123], v[8:11]
  v_mfma_f32_16x16x32_bf16 v[12:15], a[52:55], v[120:123], v[12:15]
  v_mfma_f32_16x16x32_bf16 v[16:19], a[56:59], v[120:123], v[16:19]
  v_mfma_f32_16x16x32_bf16 v[20:23], a[60:63], v[120:123], v[20:23]
  v_mfma_f32_16x16x32_bf16 v[24:27], a[48:51], v[124:127], v[24:27]
  v_mfma_f32_16x16x32_bf16 v[28:31], a[52:55], v[124:127], v[28:31]
  v_mfma_f32_16x16x32_bf16 v[32:35], a[56:59], v[124:127], v[32:35]
  v_mfma_f32_16x16x32_bf16 v[36:39], a[60:63], v[124:127], v[36:39]
  v_mfma_f32_16x16x32_bf16 v[40:43], a[48:51], v[128:131], v[40:43]
  v_mfma_f32_16x16x32_bf16 v[44:47], a[52:55], v[128:131], v[44:47]
  v_mfma_f32_16x16x32_bf16 v[48:51], a[56:59], v[128:131], v[48:51]
  v_mfma_f32_16x16x32_bf16 v[52:55], a[60:63], v[128:131], v[52:55]
  v_mfma_f32_16x16x32_bf16 v[56:59], a[48:51], v[132:135], v[56:59]
  v_mfma_f32_16x16x32_bf16 v[60:63], a[52:55], v[132:135], v[60:63]
  v_mfma_f32_16x16x32_bf16 v[64:67], a[56:59], v[132:135], v[64:67]
  v_mfma_f32_16x16x32_bf16 v[68:71], a[60:63], v[132:135], v[68:71]
  buffer_load_dwordx4 v[88:91], v5, s[28:31], s50 offen offset:1024 sc1
  buffer_load_dwordx4 v[92:95], v5, s[28:31], s51 offen offset:1024 sc1
  buffer_load_dwordx4 v[96:99], v5, s[28:31], s52 offen offset:1024 sc1
  buffer_load_dwordx4 v[100:103], v5, s[28:31], s53 offen offset:1024 sc1
  buffer_load_dwordx2 v[104:105], v7, s[28:31], s50 offen offset:2048 sc1
  buffer_load_dwordx2 v[106:107], v7, s[28:31], s50 offen offset:2560 sc1
  buffer_load_dwordx2 v[108:109], v7, s[28:31], s51 offen offset:2048 sc1
  buffer_load_dwordx2 v[110:111], v7, s[28:31], s51 offen offset:2560 sc1
  buffer_load_dwordx2 v[112:113], v7, s[28:31], s52 offen offset:2048 sc1
  buffer_load_dwordx2 v[114:115], v7, s[28:31], s52 offen offset:2560 sc1
  buffer_load_dwordx2 v[116:117], v7, s[28:31], s53 offen offset:2048 sc1
  buffer_load_dwordx2 v[118:119], v7, s[28:31], s53 offen offset:2560 sc1
  s_waitcnt vmcnt(28)
  v_mfma_f32_16x16x32_bf16 v[8:11], a[64:67], v[136:139], v[8:11]
  v_mfma_f32_16x16x32_bf16 v[12:15], a[68:71], v[136:139], v[12:15]
  v_mfma_f32_16x16x32_bf16 v[16:19], a[72:75], v[136:139], v[16:19]
  v_mfma_f32_16x16x32_bf16 v[20:23], a[76:79], v[136:139], v[20:23]
  v_mfma_f32_16x16x32_bf16 v[24:27], a[64:67], v[140:143], v[24:27]
  v_mfma_f32_16x16x32_bf16 v[28:31], a[68:71], v[140:143], v[28:31]
  v_mfma_f32_16x16x32_bf16 v[32:35], a[72:75], v[140:143], v[32:35]
  v_mfma_f32_16x16x32_bf16 v[36:39], a[76:79], v[140:143], v[36:39]
  v_mfma_f32_16x16x32_bf16 v[40:43], a[64:67], v[144:147], v[40:43]
  v_mfma_f32_16x16x32_bf16 v[44:47], a[68:71], v[144:147], v[44:47]
  v_mfma_f32_16x16x32_bf16 v[48:51], a[72:75], v[144:147], v[48:51]
  v_mfma_f32_16x16x32_bf16 v[52:55], a[76:79], v[144:147], v[52:55]
  v_mfma_f32_16x16x32_bf16 v[56:59], a[64:67], v[148:151], v[56:59]
  v_mfma_f32_16x16x32_bf16 v[60:63], a[68:71], v[148:151], v[60:63]
  v_mfma_f32_16x16x32_bf16 v[64:67], a[72:75], v[148:151], v[64:67]
  v_mfma_f32_16x16x32_bf16 v[68:71], a[76:79], v[148:151], v[68:71]
  buffer_load_dwordx4 v[120:123], v5, s[28:31], s50 offen offset:3072 sc1
  buffer_load_dwordx4 v[124:127], v5, s[28:31], s51 offen offset:3072 sc1
  buffer_load_dwordx4 v[128:131], v5, s[28:31], s52 offen offset:3072 sc1
  buffer_load_dwordx4 v[132:135], v5, s[28:31], s53 offen offset:3072 sc1
  s_add_u32 s50, s50, 4096
  s_add_u32 s51, s51, 4096
  s_add_u32 s52, s52, 4096
  s_add_u32 s53, s53, 4096
  buffer_load_dwordx4 v[136:139], v5, s[28:31], s50 offen offset:0 sc1
  buffer_load_dwordx4 v[140:143], v5, s[28:31], s51 offen offset:0 sc1
  buffer_load_dwordx4 v[144:147], v5, s[28:31], s52 offen offset:0 sc1
  buffer_load_dwordx4 v[148:151], v5, s[28:31], s53 offen offset:0 sc1
  s_waitcnt vmcnt(32)
  v_mfma_f32_16x16x32_bf16 v[8:11], a[80:83], v[152:155], v[8:11]
  v_mfma_f32_16x16x32_bf16 v[12:15], a[84:87], v[152:155], v[12:15]
  v_mfma_f32_16x16x32_bf16 v[16:19], a[88:91], v[152:155], v[16:19]
  v_mfma_f32_16x16x32_bf16 v[20:23], a[92:95], v[152:155], v[20:23]
  v_mfma_f32_16x16x32_bf16 v[24:27], a[80:83], v[156:159], v[24:27]
  v_mfma_f32_16x16x32_bf16 v[28:31], a[84:87], v[156:159], v[28:31]
  v_mfma_f32_16x16x32_bf16 v[32:35], a[88:91], v[156:159], v[32:35]
  v_mfma_f32_16x16x32_bf16 v[36:39], a[92:95], v[156:159], v[36:39]
  v_mfma_f32_16x16x32_bf16 v[40:43], a[80:83], v[160:163], v[40:43]
  v_mfma_f32_16x16x32_bf16 v[44:47], a[84:87], v[160:163], v[44:47]
  v_mfma_f32_16x16x32_bf16 v[48:51], a[88:91], v[160:163], v[48:51]
  v_mfma_f32_16x16x32_bf16 v[52:55], a[92:95], v[160:163], v[52:55]
  v_mfma_f32_16x16x32_bf16 v[56:59], a[80:83], v[164:167], v[56:59]
  v_mfma_f32_16x16x32_bf16 v[60:63], a[84:87], v[164:167], v[60:63]
  v_mfma_f32_16x16x32_bf16 v[64:67], a[88:91], v[164:167], v[64:67]
  v_mfma_f32_16x16x32_bf16 v[68:71], a[92:95], v[164:167], v[68:71]
  buffer_load_dwordx4 v[152:155], v5, s[28:31], s50 offen offset:1024 sc1
  buffer_load_dwordx4 v[156:159], v5, s[28:31], s51 offen offset:1024 sc1
  buffer_load_dwordx4 v[160:163], v5, s[28:31], s52 offen offset:1024 sc1
  buffer_load_dwordx4 v[164:167], v5, s[28:31], s53 offen offset:1024 sc1
  s_waitcnt vmcnt(32)
  v_mfma_f32_16x16x32_bf16 v[8:11], a[96:99], v[168:171], v[8:11]
  v_mfma_f32_16x16x32_bf16 v[12:15], a[100:103], v[168:171], v[12:15]
  v_mfma_f32_16x16x32_bf16 v[16:19], a[104:107], v[168:171], v[16:19]
  v_mfma_f32_16x16x32_bf16 v[20:23], a[108:111], v[168:171], v[20:23]
  v_mfma_f32_16x16x32_bf16 v[24:27], a[96:99], v[172:175], v[24:27]
  v_mfma_f32_16x16x32_bf16 v[28:31], a[100:103], v[172:175], v[28:31]
  v_mfma_f32_16x16x32_bf16 v[32:35], a[104:107], v[172:175], v[32:35]
  v_mfma_f32_16x16x32_bf16 v[36:39], a[108:111], v[172:175], v[36:39]
  v_mfma_f32_16x16x32_bf16 v[40:43], a[96:99], v[176:179], v[40:43]
  v_mfma_f32_16x16x32_bf16 v[44:47], a[100:103], v[176:179], v[44:47]
  v_mfma_f32_16x16x32_bf16 v[48:51], a[104:107], v[176:179], v[48:51]
  v_mfma_f32_16x16x32_bf16 v[52:55], a[108:111], v[176:179], v[52:55]
  v_mfma_f32_16x16x32_bf16 v[56:59], a[96:99], v[180:183], v[56:59]
  v_mfma_f32_16x16x32_bf16 v[60:63], a[100:103], v[180:183], v[60:63]
  v_mfma_f32_16x16x32_bf16 v[64:67], a[104:107], v[180:183], v[64:67]
  v_mfma_f32_16x16x32_bf16 v[68:71], a[108:111], v[180:183], v[68:71]
  buffer_load_dwordx2 v[200:201], v6, s[28:31], s49 offen offset:0 sc1
  buffer_load_dwordx2 v[202:203], v6, s[28:31], s49 offen offset:32 sc1
  buffer_load_dwordx2 v[204:205], v6, s[28:31], s49 offen offset:64 sc1
  buffer_load_dwordx2 v[206:207], v6, s[28:31], s49 offen offset:96 sc1
  s_waitcnt vmcnt(32)
  v_mfma_f32_16x16x32_bf16 v[8:11], a[112:115], v[184:187], v[8:11]
  v_mfma_f32_16x16x32_bf16 v[12:15], a[116:119], v[184:187], v[12:15]
  v_mfma_f32_16x16x32_bf16 v[16:19], a[120:123], v[184:187], v[16:19]
  v_mfma_f32_16x16x32_bf16 v[20:23], a[124:127], v[184:187], v[20:23]
  v_mfma_f32_16x16x32_bf16 v[24:27], a[112:115], v[188:191], v[24:27]
  v_mfma_f32_16x16x32_bf16 v[28:31], a[116:119], v[188:191], v[28:31]
  v_mfma_f32_16x16x32_bf16 v[32:35], a[120:123], v[188:191], v[32:35]
  v_mfma_f32_16x16x32_bf16 v[36:39], a[124:127], v[188:191], v[36:39]
  v_mfma_f32_16x16x32_bf16 v[40:43], a[112:115], v[192:195], v[40:43]
  v_mfma_f32_16x16x32_bf16 v[44:47], a[116:119], v[192:195], v[44:47]
  v_mfma_f32_16x16x32_bf16 v[48:51], a[120:123], v[192:195], v[48:51]
  v_mfma_f32_16x16x32_bf16 v[52:55], a[124:127], v[192:195], v[52:55]
  v_mfma_f32_16x16x32_bf16 v[56:59], a[112:115], v[196:199], v[56:59]
  v_mfma_f32_16x16x32_bf16 v[60:63], a[116:119], v[196:199], v[60:63]
  v_mfma_f32_16x16x32_bf16 v[64:67], a[120:123], v[196:199], v[64:67]
  v_mfma_f32_16x16x32_bf16 v[68:71], a[124:127], v[196:199], v[68:71]
  s_waitcnt vmcnt(28)
  v_mfma_f32_16x16x32_bf16 v[8:11], a[128:131], v[72:75], v[8:11]
  v_mfma_f32_16x16x32_bf16 v[12:15], a[132:135], v[72:75], v[12:15]
  v_mfma_f32_16x16x32_bf16 v[16:19], a[136:139], v[72:75], v[16:19]
  v_mfma_f32_16x16x32_bf16 v[20:23], a[140:143], v[72:75], v[20:23]
  v_mfma_f32_16x16x32_bf16 v[24:27], a[128:131], v[76:79], v[24:27]
  v_mfma_f32_16x16x32_bf16 v[28:31], a[132:135], v[76:79], v[28:31]
  v_mfma_f32_16x16x32_bf16 v[32:35], a[136:139], v[76:79], v[32:35]
  v_mfma_f32_16x16x32_bf16 v[36:39], a[140:143], v[76:79], v[36:39]
  v_mfma_f32_16x16x32_bf16 v[40:43], a[128:131], v[80:83], v[40:43]
  v_mfma_f32_16x16x32_bf16 v[44:47], a[132:135], v[80:83], v[44:47]
  v_mfma_f32_16x16x32_bf16 v[48:51], a[136:139], v[80:83], v[48:51]
  v_mfma_f32_16x16x32_bf16 v[52:55], a[140:143], v[80:83], v[52:55]
  v_mfma_f32_16x16x32_bf16 v[56:59], a[128:131], v[84:87], v[56:59]
  v_mfma_f32_16x16x32_bf16 v[60:63], a[132:135], v[84:87], v[60:63]
  v_mfma_f32_16x16x32_bf16 v[64:67], a[136:139], v[84:87], v[64:67]
  v_mfma_f32_16x16x32_bf16 v[68:71], a[140:143], v[84:87], v[68:71]
  s_waitcnt vmcnt(24)
  v_mfma_f32_16x16x32_bf16 v[8:11], a[144:147], v[88:91], v[8:11]
  v_mfma_f32_16x16x32_bf16 v[12:15], a[148:151], v[88:91], v[12:15]
  v_mfma_f32_16x16x32_bf16 v[16:19], a[152:155], v[88:91], v[16:19]
  v_mfma_f32_16x16x32_bf16 v[20:23], a[156:159], v[88:91], v[20:23]
  v_mfma_f32_16x16x32_bf16 v[24:27], a[144:147], v[92:95], v[24:27]
  v_mfma_f32_16x16x32_bf16 v[28:31], a[148:151], v[92:95], v[28:31]
  v_mfma_f32_16x16x32_bf16 v[32:35], a[152:155], v[92:95], v[32:35]
  v_mfma_f32_16x16x32_bf16 v[36:39], a[156:159], v[92:95], v[36:39]
  v_mfma_f32_16x16x32_bf16 v[40:43], a[144:147], v[96:99], v[40:43]
  v_mfma_f32_16x16x32_bf16 v[44:47], a[148:151], v[96:99], v[44:47]
  v_mfma_f32_16x16x32_bf16 v[48:51], a[152:155], v[96:99], v[48:51]
  v_mfma_f32_16x16x32_bf16 v[52:55], a[156:159], v[96:99], v[52:55]
  v_mfma_f32_16x16x32_bf16 v[56:59], a[144:147], v[100:103], v[56:59]
  v_mfma_f32_16x16x32_bf16 v[60:63], a[148:151], v[100:103], v[60:63]
  v_mfma_f32_16x16x32_bf16 v[64:67], a[152:155], v[100:103], v[64:67]
  v_mfma_f32_16x16x32_bf16 v[68:71], a[156:159], v[100:103], v[68:71]
  s_waitcnt vmcnt(16)
  v_mfma_f32_16x16x32_bf16 v[8:11], a[160:163], v[104:107], v[8:11]
  v_mfma_f32_16x16x32_bf16 v[12:15], a[164:167], v[104:107], v[12:15]
  v_mfma_f32_16x16x32_bf16 v[16:19], a[168:171], v[104:107], v[16:19]
  v_mfma_f32_16x16x32_bf16 v[20:23], a[172:175], v[104:107], v[20:23]
  v_mfma_f32_16x16x32_bf16 v[24:27], a[160:163], v[108:111], v[24:27]
  v_mfma_f32_16x16x32_bf16 v[28:31], a[164:167], v[108:111], v[28:31]
  v_mfma_f32_16x16x32_bf16 v[32:35], a[168:171], v[108:111], v[32:35]
  v_mfma_f32_16x16x32_bf16 v[36:39], a[172:175], v[108:111], v[36:39]
  v_mfma_f32_16x16x32_bf16 v[40:43], a[160:163], v[112:115], v[40:43]
  v_mfma_f32_16x16x32_bf16 v[44:47], a[164:167], v[112:115], v[44:47]
  v_mfma_f32_16x16x32_bf16 v[48:51], a[168:171], v[112:115], v[48:51]
  v_mfma_f32_16x16x32_bf16 v[52:55], a[172:175], v[112:115], v[52:55]
  v_mfma_f32_16x16x32_bf16 v[56:59], a[160:163], v[116:119], v[56:59]
  v_mfma_f32_16x16x32_bf16 v[60:63], a[164:167], v[116:119], v[60:63]
  v_mfma_f32_16x16x32_bf16 v[64:67], a[168:171], v[116:119], v[64:67]
  v_mfma_f32_16x16x32_bf16 v[68:71], a[172:175], v[116:119], v[68:71]
  v_add_u32 v72, 114688, v5
  s_add_u32 s47, s41, 1
  s_and_b32 s47, s47, 3
  s_mul_i32 s47, s47, 12288
  v_add_u32 v73, s47, v72
  s_add_u32 s47, s41, 2
  s_and_b32 s47, s47, 3
  s_mul_i32 s47, s47, 12288
  v_add_u32 v74, s47, v72
  s_add_u32 s47, s41, 3
  s_and_b32 s47, s47, 3
  s_mul_i32 s47, s47, 12288
  v_add_u32 v75, s47, v72
  s_mul_i32 s47, s41, 12288
  v_add_u32 v72, s47, v72
  s_lshl_b32 s47, s41, 1
  v_lshrrev_b32 v7, 3, v1
  v_add_u32 v7, s47, v7
  v_lshrrev_b32 v76, 2, v7
  v_and_b32 v7, 3, v7
  v_lshl_add_u32 v76, v7, 4, v76
  v_and_b32 v7, 7, v1
  v_lshl_add_u32 v76, v7, 1, v76
  v_lshlrev_b32 v76, 5, v76
  v_add_u32 v76, s38, v76
  v_lshlrev_b32 v76, 10, v76
  v_lshl_add_u32 v82, v2, 3, v76
  s_lshl_b32 s47, s39, 7
  s_waitcnt vmcnt(12)
  v_mfma_f32_16x16x32_bf16 v[8:11], a[176:179], v[120:123], v[8:11]
  v_mfma_f32_16x16x32_bf16 v[12:15], a[180:183], v[120:123], v[12:15]
  v_mfma_f32_16x16x32_bf16 v[16:19], a[184:187], v[120:123], v[16:19]
  v_mfma_f32_16x16x32_bf16 v[20:23], a[188:191], v[120:123], v[20:23]
  v_mfma_f32_16x16x32_bf16 v[24:27], a[176:179], v[124:127], v[24:27]
  v_mfma_f32_16x16x32_bf16 v[28:31], a[180:183], v[124:127], v[28:31]
  v_mfma_f32_16x16x32_bf16 v[32:35], a[184:187], v[124:127], v[32:35]
  v_mfma_f32_16x16x32_bf16 v[36:39], a[188:191], v[124:127], v[36:39]
  v_mfma_f32_16x16x32_bf16 v[40:43], a[176:179], v[128:131], v[40:43]
  v_mfma_f32_16x16x32_bf16 v[44:47], a[180:183], v[128:131], v[44:47]
  v_mfma_f32_16x16x32_bf16 v[48:51], a[184:187], v[128:131], v[48:51]
  v_mfma_f32_16x16x32_bf16 v[52:55], a[188:191], v[128:131], v[52:55]
  v_mfma_f32_16x16x32_bf16 v[56:59], a[176:179], v[132:135], v[56:59]
  v_mfma_f32_16x16x32_bf16 v[60:63], a[180:183], v[132:135], v[60:63]
  v_mfma_f32_16x16x32_bf16 v[64:67], a[184:187], v[132:135], v[64:67]
  v_mfma_f32_16x16x32_bf16 v[68:71], a[188:191], v[132:135], v[68:71]
  s_waitcnt vmcnt(8)
  v_mfma_f32_16x16x32_bf16 v[8:11], a[192:195], v[136:139], v[8:11]
  v_mfma_f32_16x16x32_bf16 v[12:15], a[196:199], v[136:139], v[12:15]
  v_mfma_f32_16x16x32_bf16 v[16:19], a[200:203], v[136:139], v[16:19]
  v_mfma_f32_16x16x32_bf16 v[20:23], a[204:207], v[136:139], v[20:23]
  v_mfma_f32_16x16x32_bf16 v[24:27], a[192:195], v[140:143], v[24:27]
  v_mfma_f32_16x16x32_bf16 v[28:31], a[196:199], v[140:143], v[28:31]
  v_mfma_f32_16x16x32_bf16 v[32:35], a[200:203], v[140:143], v[32:35]
  v_mfma_f32_16x16x32_bf16 v[36:39], a[204:207], v[140:143], v[36:39]
  v_mfma_f32_16x16x32_bf16 v[40:43], a[192:195], v[144:147], v[40:43]
  v_mfma_f32_16x16x32_bf16 v[44:47], a[196:199], v[144:147], v[44:47]
  v_mfma_f32_16x16x32_bf16 v[48:51], a[200:203], v[144:147], v[48:51]
  v_mfma_f32_16x16x32_bf16 v[52:55], a[204:207], v[144:147], v[52:55]
  v_mfma_f32_16x16x32_bf16 v[56:59], a[192:195], v[148:151], v[56:59]
  v_mfma_f32_16x16x32_bf16 v[60:63], a[196:199], v[148:151], v[60:63]
  v_mfma_f32_16x16x32_bf16 v[64:67], a[200:203], v[148:151], v[64:67]
  v_mfma_f32_16x16x32_bf16 v[68:71], a[204:207], v[148:151], v[68:71]
  s_waitcnt vmcnt(4)
  v_mfma_f32_16x16x32_bf16 v[24:27], a[208:211], v[156:159], v[24:27]
  v_mfma_f32_16x16x32_bf16 v[28:31], a[212:215], v[156:159], v[28:31]
  v_mfma_f32_16x16x32_bf16 v[32:35], a[216:219], v[156:159], v[32:35]
  v_mfma_f32_16x16x32_bf16 v[36:39], a[220:223], v[156:159], v[36:39]
  v_mfma_f32_16x16x32_bf16 v[40:43], a[208:211], v[160:163], v[40:43]
  v_mfma_f32_16x16x32_bf16 v[44:47], a[212:215], v[160:163], v[44:47]
  v_mfma_f32_16x16x32_bf16 v[48:51], a[216:219], v[160:163], v[48:51]
  v_mfma_f32_16x16x32_bf16 v[52:55], a[220:223], v[160:163], v[52:55]
  s_nop 0
  ds_write_b128 v73, v[24:27] offset:0
  ds_write_b128 v73, v[28:31] offset:1024
  ds_write_b128 v73, v[32:35] offset:2048
  ds_write_b128 v73, v[36:39] offset:3072
  v_mfma_f32_16x16x32_bf16 v[56:59], a[208:211], v[164:167], v[56:59]
  v_mfma_f32_16x16x32_bf16 v[60:63], a[212:215], v[164:167], v[60:63]
  v_mfma_f32_16x16x32_bf16 v[64:67], a[216:219], v[164:167], v[64:67]
  v_mfma_f32_16x16x32_bf16 v[68:71], a[220:223], v[164:167], v[68:71]
  ds_write_b128 v74, v[40:43] offset:4096
  ds_write_b128 v74, v[44:47] offset:5120
  ds_write_b128 v74, v[48:51] offset:6144
  ds_write_b128 v74, v[52:55] offset:7168
  v_mfma_f32_16x16x32_bf16 v[8:11], a[208:211], v[152:155], v[8:11]
  v_mfma_f32_16x16x32_bf16 v[12:15], a[212:215], v[152:155], v[12:15]
  v_mfma_f32_16x16x32_bf16 v[16:19], a[216:219], v[152:155], v[16:19]
  v_mfma_f32_16x16x32_bf16 v[20:23], a[220:223], v[152:155], v[20:23]
  ds_write_b128 v75, v[56:59] offset:8192
  ds_write_b128 v75, v[60:63] offset:9216
  ds_write_b128 v75, v[64:67] offset:10240
  ds_write_b128 v75, v[68:71] offset:11264
  s_waitcnt lgkmcnt(0)
  s_barrier
  ds_read_b128 v[24:27], v72 offset:0
  ds_read_b128 v[28:31], v72 offset:1024
  ds_read_b128 v[32:35], v72 offset:2048
  ds_read_b128 v[36:39], v72 offset:3072
  ds_read_b128 v[40:43], v72 offset:4096
  ds_read_b128 v[44:47], v72 offset:5120
  ds_read_b128 v[48:51], v72 offset:6144
  ds_read_b128 v[52:55], v72 offset:7168
  ds_read_b128 v[56:59], v72 offset:8192
  ds_read_b128 v[60:63], v72 offset:9216
  ds_read_b128 v[64:67], v72 offset:10240
  ds_read_b128 v[68:71], v72 offset:11264
  s_waitcnt vmcnt(0)
  v_lshlrev_b32 v76, 16, v200
  v_and_b32 v77, 0xffff0000, v200
  v_pk_add_f32 v[8:9], v[8:9], v[76:77]
  v_lshlrev_b32 v76, 16, v201
  v_and_b32 v77, 0xffff0000, v201
  v_pk_add_f32 v[10:11], v[10:11], v[76:77]
  v_lshlrev_b32 v76, 16, v202
  v_and_b32 v77, 0xffff0000, v202
  v_pk_add_f32 v[12:13], v[12:13], v[76:77]
  v_lshlrev_b32 v76, 16, v203
  v_and_b32 v77, 0xffff0000, v203
  v_pk_add_f32 v[14:15], v[14:15], v[76:77]
  v_lshlrev_b32 v76, 16, v204
  v_and_b32 v77, 0xffff0000, v204
  v_pk_add_f32 v[16:17], v[16:17], v[76:77]
  v_lshlrev_b32 v76, 16, v205
  v_and_b32 v77, 0xffff0000, v205
  v_pk_add_f32 v[18:19], v[18:19], v[76:77]
  v_lshlrev_b32 v76, 16, v206
  v_and_b32 v77, 0xffff0000, v206
  v_pk_add_f32 v[20:21], v[20:21], v[76:77]
  v_lshlrev_b32 v76, 16, v207
  v_and_b32 v77, 0xffff0000, v207
  v_pk_add_f32 v[22:23], v[22:23], v[76:77]
  s_waitcnt lgkmcnt(8)
  v_pk_add_f32 v[8:9], v[8:9], v[24:25]
  v_pk_add_f32 v[10:11], v[10:11], v[26:27]
  v_pk_add_f32 v[12:13], v[12:13], v[28:29]
  v_pk_add_f32 v[14:15], v[14:15], v[30:31]
  v_pk_add_f32 v[16:17], v[16:17], v[32:33]
  v_pk_add_f32 v[18:19], v[18:19], v[34:35]
  v_pk_add_f32 v[20:21], v[20:21], v[36:37]
  v_pk_add_f32 v[22:23], v[22:23], v[38:39]
  s_waitcnt lgkmcnt(4)
  v_pk_add_f32 v[8:9], v[8:9], v[40:41]
  v_pk_add_f32 v[10:11], v[10:11], v[42:43]
  v_pk_add_f32 v[12:13], v[12:13], v[44:45]
  v_pk_add_f32 v[14:15], v[14:15], v[46:47]
  v_pk_add_f32 v[16:17], v[16:17], v[48:49]
  v_pk_add_f32 v[18:19], v[18:19], v[50:51]
  v_pk_add_f32 v[20:21], v[20:21], v[52:53]
  v_pk_add_f32 v[22:23], v[22:23], v[54:55]
  s_waitcnt lgkmcnt(0)
  v_pk_add_f32 v[8:9], v[8:9], v[56:57]
  v_pk_add_f32 v[10:11], v[10:11], v[58:59]
  v_pk_add_f32 v[12:13], v[12:13], v[60:61]
  v_pk_add_f32 v[14:15], v[14:15], v[62:63]
  v_pk_add_f32 v[16:17], v[16:17], v[64:65]
  v_pk_add_f32 v[18:19], v[18:19], v[66:67]
  v_pk_add_f32 v[20:21], v[20:21], v[68:69]
  v_pk_add_f32 v[22:23], v[22:23], v[70:71]
  v_cvt_pk_bf16_f32 v200, v8, v9
  v_cvt_pk_bf16_f32 v201, v10, v11
  v_cvt_pk_bf16_f32 v202, v12, v13
  v_cvt_pk_bf16_f32 v203, v14, v15
  v_cvt_pk_bf16_f32 v204, v16, v17
  v_cvt_pk_bf16_f32 v205, v18, v19
  v_cvt_pk_bf16_f32 v206, v20, v21
  v_cvt_pk_bf16_f32 v207, v22, v23
  buffer_store_dwordx2 v[200:201], v82, s[24:27], s47 offen offset:0
  buffer_store_dwordx2 v[202:203], v82, s[24:27], s47 offen offset:32
  buffer_store_dwordx2 v[204:205], v82, s[24:27], s47 offen offset:64
  buffer_store_dwordx2 v[206:207], v82, s[24:27], s47 offen offset:96
END:
  s_endpgm

.p2align 8
.type TABLE,@object
TABLE:
.long 0x3f803f80,0x3f803f80,0x3f803f80,0x3f803f80,0x3f7b3f80,0x3f553f6d,0x3f0e3f35,0x3e483ec4
.long 0x3f6d3f80,0x3ec43f35,0xbec4248d,0xbf6dbf35,0x3f553f80,0xbe483ec4,0xbf7bbf35,0xbf0ebf6d
.long 0x3f353f80,0xbf35248d,0xbf35bf80,0x3f35a554,0x3f0e3f80,0xbf7bbec4,0x3e48bf35,0x3f553f6d
.long 0x3ec43f80,0xbf6dbf35,0x3f6da554,0xbec43f35,0x3e483f80,0xbf0ebf6d,0x3f553f35,0xbf7bbec4
.long 0x248d3f80,0xa554bf80,0x248d3f80,0xa554bf80,0xbe483f80,0x3f0ebf6d,0xbf553f35,0x3f7bbec4
.long 0xbec43f80,0x3f6dbf35,0xbf6d248d,0x3ec43f35,0xbf0e3f80,0x3f7bbec4,0xbe48bf35,0xbf553f6d
.long 0xbf353f80,0x3f35a554,0x3f35bf80,0xbf35248d,0xbf553f80,0x3e483ec4,0x3f7bbf35,0x3f0ebf6d
.long 0xbf6d3f80,0xbec43f35,0x3ec4a554,0x3f6dbf35,0xbf7b3f80,0xbf553f6d,0xbf0e3f35,0xbe483ec4
.long 0x3f803f80,0x3f803f80,0x3f803f80,0x3f803f80,0xbe48248d,0xbf0ebec4,0xbf55bf35,0xbf7bbf6d
.long 0xbf6dbf80,0xbec4bf35,0x3ec4a554,0x3f6d3f35,0x3f0ea554,0x3f7b3f6d,0x3e483f35,0xbf55bec4
.long 0x3f353f80,0xbf35248d,0xbf35bf80,0x3f35a554,0xbf55248d,0xbe48bf6d,0x3f7b3f35,0xbf0e3ec4
.long 0xbec4bf80,0x3f6d3f35,0xbf6d248d,0x3ec4bf35,0x3f7ba554,0xbf553ec4,0x3f0ebf35,0xbe483f6d
.long 0x248d3f80,0xa554bf80,0x248d3f80,0xa554bf80,0xbf7b248d,0x3f553ec4,0xbf0ebf35,0x3e483f6d
.long 0x3ec4bf80,0xbf6d3f35,0x3f6da554,0xbec4bf35,0x3f55a554,0x3e48bf6d,0xbf7b3f35,0x3f0e3ec4
.long 0xbf353f80,0x3f35a554,0x3f35bf80,0xbf35248d,0xbf0e248d,0xbf7b3f6d,0xbe483f35,0x3f55bec4
.long 0x3f6dbf80,0x3ec4bf35,0xbec4248d,0xbf6d3f35,0x3e48a554,0x3f0ebec4,0x3f55bf35,0x3f7bbf6d
.long 0x3f803f80,0x3f803f80,0x3f803f80,0x3f803f80,0xbf7bbf80,0xbf55bf6d,0xbf0ebf35,0xbe48bec4
.long 0x3f6d3f80,0x3ec43f35,0xbec4248d,0xbf6dbf35,0xbf55bf80,0x3e48bec4,0x3f7b3f35,0x3f0e3f6d
.long 0x3f353f80,0xbf35248d,0xbf35bf80,0x3f35a554,0xbf0ebf80,0x3f7b3ec4,0xbe483f35,0xbf55bf6d
.long 0x3ec43f80,0xbf6dbf35,0x3f6da554,0xbec43f35,0xbe48bf80,0x3f0e3f6d,0xbf55bf35,0x3f7b3ec4
.long 0x248d3f80,0xa554bf80,0x248d3f80,0xa554bf80,0x3e48bf80,0xbf0e3f6d,0x3f55bf35,0xbf7b3ec4
.long 0xbec43f80,0x3f6dbf35,0xbf6d248d,0x3ec43f35,0x3f0ebf80,0xbf7b3ec4,0x3e483f35,0x3f55bf6d
.long 0xbf353f80,0x3f35a554,0x3f35bf80,0xbf35248d,0x3f55bf80,0xbe48bec4,0xbf7b3f35,0xbf0e3f6d
.long 0xbf6d3f80,0xbec43f35,0x3ec4a554,0x3f6dbf35,0x3f7bbf80,0x3f55bf6d,0x3f0ebf35,0x3e48bec4
.long 0x3f803f80,0x3f803f80,0x3f803f80,0x3f803f80,0x3e48a554,0x3f0e3ec4,0x3f553f35,0x3f7b3f6d
.long 0xbf6dbf80,0xbec4bf35,0x3ec4a554,0x3f6d3f35,0xbf0e248d,0xbf7bbf6d,0xbe48bf35,0x3f553ec4
.long 0x3f353f80,0xbf35248d,0xbf35bf80,0x3f35a554,0x3f55a554,0x3e483f6d,0xbf7bbf35,0x3f0ebec4
.long 0xbec4bf80,0x3f6d3f35,0xbf6d248d,0x3ec4bf35,0xbf7b248d,0x3f55bec4,0xbf0e3f35,0x3e48bf6d
.long 0x248d3f80,0xa554bf80,0x248d3f80,0xa554bf80,0x3f7ba554,0xbf55bec4,0x3f0e3f35,0xbe48bf6d
.long 0x3ec4bf80,0xbf6d3f35,0x3f6da554,0xbec4bf35,0xbf55248d,0xbe483f6d,0x3f7bbf35,0xbf0ebec4
.long 0xbf353f80,0x3f35a554,0x3f35bf80,0xbf35248d,0x3f0ea554,0x3f7bbf6d,0x3e48bf35,0xbf553ec4
.long 0x3f6dbf80,0x3ec4bf35,0xbec4248d,0xbf6d3f35,0xbe48248d,0xbf0e3ec4,0xbf553f35,0xbf7b3f6d
.long 0x3f803f80,0x3f803f80,0x3f803f80,0x3f803f80,0x3f753f7f,0x3f463f62,0x3ef13f22,0x3dc93e95
.long 0x3f553f7b,0x3e483f0e,0xbf0ebe48,0xbf7bbf55,0x3f223f75,0xbef13dc9,0xbf7fbf62,0xbe95bf46
.long 0x3ec43f6d,0xbf6dbec4,0xbec4bf6d,0x3f6d3ec4,0x3dc93f62,0xbf75bf46,0x3f22be95,0x3ef13f7f
.long 0xbe483f55,0xbf0ebf7b,0x3f7b3f0e,0xbf553e48,0xbef13f46,0x3dc9bf75,0x3e953f7f,0xbf22bf62
.long 0xbf353f35,0x3f35bf35,0xbf353f35,0x3f35bf35,0xbf623f22,0x3f7fbe95,0xbf75bdc9,0x3f463ef1
.long 0xbf7b3f0e,0x3f553e48,0xbe48bf55,0xbf0e3f7b,0xbf7f3ef1,0x3e953f22,0x3f46bf75,0xbf623dc9
.long 0xbf6d3ec4,0xbec43f6d,0x3f6dbec4,0x3ec4bf6d,0xbf463e95,0xbf623f7f,0x3dc93ef1,0x3f75bf22
.long 0xbf0e3e48,0xbf7b3f55,0xbf553f7b,0xbe483f0e,0xbe953dc9,0xbf223ef1,0xbf623f46,0xbf7f3f75
.long 0x3f803f80,0x3f803f80,0x3f803f80,0x3f803f80,0xbe95bdc9,0xbf22bef1,0xbf62bf46,0xbf7fbf75
.long 0xbf55bf7b,0xbe48bf0e,0x3f0e3e48,0x3f7b3f55,0x3f463e95,0x3f623f7f,0xbdc93ef1,0xbf75bf22
.long 0x3ec43f6d,0xbf6dbec4,0xbec4bf6d,0x3f6d3ec4,0xbf7fbef1,0x3e95bf22,0x3f463f75,0xbf62bdc9
.long 0x3e48bf55,0x3f0e3f7b,0xbf7bbf0e,0x3f55be48,0x3f623f22,0xbf7fbe95,0x3f75bdc9,0xbf463ef1
.long 0xbf353f35,0x3f35bf35,0xbf353f35,0x3f35bf35,0xbef1bf46,0x3dc93f75,0x3e95bf7f,0xbf223f62
.long 0x3f7bbf0e,0xbf55be48,0x3e483f55,0x3f0ebf7b,0xbdc93f62,0x3f75bf46,0xbf22be95,0xbef13f7f
.long 0xbf6d3ec4,0xbec43f6d,0x3f6dbec4,0x3ec4bf6d,0x3f22bf75,0xbef1bdc9,0xbf7f3f62,0xbe953f46
.long 0x3f0ebe48,0x3f7bbf55,0x3f55bf7b,0x3e48bf0e,0xbf753f7f,0xbf463f62,0xbef13f22,0xbdc93e95
.long 0x3f803f80,0x3f803f80,0x3f803f80,0x3f803f80,0xbf75bf7f,0xbf46bf62,0xbef1bf22,0xbdc9be95
.long 0x3f553f7b,0x3e483f0e,0xbf0ebe48,0xbf7bbf55,0xbf22bf75,0x3ef1bdc9,0x3f7f3f62,0x3e953f46
.long 0x3ec43f6d,0xbf6dbec4,0xbec4bf6d,0x3f6d3ec4,0xbdc9bf62,0x3f753f46,0xbf223e95,0xbef1bf7f
.long 0xbe483f55,0xbf0ebf7b,0x3f7b3f0e,0xbf553e48,0x3ef1bf46,0xbdc93f75,0xbe95bf7f,0x3f223f62
.long 0xbf353f35,0x3f35bf35,0xbf353f35,0x3f35bf35,0x3f62bf22,0xbf7f3e95,0x3f753dc9,0xbf46bef1
.long 0xbf7b3f0e,0x3f553e48,0xbe48bf55,0xbf0e3f7b,0x3f7fbef1,0xbe95bf22,0xbf463f75,0x3f62bdc9
.long 0xbf6d3ec4,0xbec43f6d,0x3f6dbec4,0x3ec4bf6d,0x3f46be95,0x3f62bf7f,0xbdc9bef1,0xbf753f22
.long 0xbf0e3e48,0xbf7b3f55,0xbf553f7b,0xbe483f0e,0x3e95bdc9,0x3f22bef1,0x3f62bf46,0x3f7fbf75
.long 0x3f803f80,0x3f803f80,0x3f803f80,0x3f803f80,0x3e953dc9,0x3f223ef1,0x3f623f46,0x3f7f3f75
.long 0xbf55bf7b,0xbe48bf0e,0x3f0e3e48,0x3f7b3f55,0xbf46be95,0xbf62bf7f,0x3dc9bef1,0x3f753f22
.long 0x3ec43f6d,0xbf6dbec4,0xbec4bf6d,0x3f6d3ec4,0x3f7f3ef1,0xbe953f22,0xbf46bf75,0x3f623dc9
.long 0x3e48bf55,0x3f0e3f7b,0xbf7bbf0e,0x3f55be48,0xbf62bf22,0x3f7f3e95,0xbf753dc9,0x3f46bef1
.long 0xbf353f35,0x3f35bf35,0xbf353f35,0x3f35bf35,0x3ef13f46,0xbdc9bf75,0xbe953f7f,0x3f22bf62
.long 0x3f7bbf0e,0xbf55be48,0x3e483f55,0x3f0ebf7b,0x3dc9bf62,0xbf753f46,0x3f223e95,0x3ef1bf7f
.long 0xbf6d3ec4,0xbec43f6d,0x3f6dbec4,0x3ec4bf6d,0xbf223f75,0x3ef13dc9,0x3f7fbf62,0x3e95bf46
.long 0x3f0ebe48,0x3f7bbf55,0x3f55bf7b,0x3e48bf0e,0x3f75bf7f,0x3f46bf62,0x3ef1bf22,0x3dc9be95
.long 0xbf803f80,0xbf803f80,0xbf803f80,0xbf803f80,0xbf7b3f80,0xbf553f6d,0xbf0e3f35,0xbe483ec4
.long 0xbf6d3f80,0xbec43f35,0x3ec4248d,0x3f6dbf35,0xbf553f80,0x3e483ec4,0x3f7bbf35,0x3f0ebf6d
.long 0xbf353f80,0x3f35248d,0x3f35bf80,0xbf35a554,0xbf0e3f80,0x3f7bbec4,0xbe48bf35,0xbf553f6d
.long 0xbec43f80,0x3f6dbf35,0xbf6da554,0x3ec43f35,0xbe483f80,0x3f0ebf6d,0xbf553f35,0x3f7bbec4
.long 0xa5543f80,0x248dbf80,0xa5543f80,0x248dbf80,0x3e483f80,0xbf0ebf6d,0x3f553f35,0xbf7bbec4
.long 0x3ec43f80,0xbf6dbf35,0x3f6d248d,0xbec43f35,0x3f0e3f80,0xbf7bbec4,0x3e48bf35,0x3f553f6d
.long 0x3f353f80,0xbf35a554,0xbf35bf80,0x3f35248d,0x3f553f80,0xbe483ec4,0xbf7bbf35,0xbf0ebf6d
.long 0x3f6d3f80,0x3ec43f35,0xbec4a554,0xbf6dbf35,0x3f7b3f80,0x3f553f6d,0x3f0e3f35,0x3e483ec4
.long 0xbf803f80,0xbf803f80,0xbf803f80,0xbf803f80,0x3e48248d,0x3f0ebec4,0x3f55bf35,0x3f7bbf6d
.long 0x3f6dbf80,0x3ec4bf35,0xbec4a554,0xbf6d3f35,0xbf0ea554,0xbf7b3f6d,0xbe483f35,0x3f55bec4
.long 0xbf353f80,0x3f35248d,0x3f35bf80,0xbf35a554,0x3f55248d,0x3e48bf6d,0xbf7b3f35,0x3f0e3ec4
.long 0x3ec4bf80,0xbf6d3f35,0x3f6d248d,0xbec4bf35,0xbf7ba554,0x3f553ec4,0xbf0ebf35,0x3e483f6d
.long 0xa5543f80,0x248dbf80,0xa5543f80,0x248dbf80,0x3f7b248d,0xbf553ec4,0x3f0ebf35,0xbe483f6d
.long 0xbec4bf80,0x3f6d3f35,0xbf6da554,0x3ec4bf35,0xbf55a554,0xbe48bf6d,0x3f7b3f35,0xbf0e3ec4
.long 0x3f353f80,0xbf35a554,0xbf35bf80,0x3f35248d,0x3f0e248d,0x3f7b3f6d,0x3e483f35,0xbf55bec4
.long 0xbf6dbf80,0xbec4bf35,0x3ec4248d,0x3f6d3f35,0xbe48a554,0xbf0ebec4,0xbf55bf35,0xbf7bbf6d
.long 0xbf803f80,0xbf803f80,0xbf803f80,0xbf803f80,0x3f7bbf80,0x3f55bf6d,0x3f0ebf35,0x3e48bec4
.long 0xbf6d3f80,0xbec43f35,0x3ec4248d,0x3f6dbf35,0x3f55bf80,0xbe48bec4,0xbf7b3f35,0xbf0e3f6d
.long 0xbf353f80,0x3f35248d,0x3f35bf80,0xbf35a554,0x3f0ebf80,0xbf7b3ec4,0x3e483f35,0x3f55bf6d
.long 0xbec43f80,0x3f6dbf35,0xbf6da554,0x3ec43f35,0x3e48bf80,0xbf0e3f6d,0x3f55bf35,0xbf7b3ec4
.long 0xa5543f80,0x248dbf80,0xa5543f80,0x248dbf80,0xbe48bf80,0x3f0e3f6d,0xbf55bf35,0x3f7b3ec4
.long 0x3ec43f80,0xbf6dbf35,0x3f6d248d,0xbec43f35,0xbf0ebf80,0x3f7b3ec4,0xbe483f35,0xbf55bf6d
.long 0x3f353f80,0xbf35a554,0xbf35bf80,0x3f35248d,0xbf55bf80,0x3e48bec4,0x3f7b3f35,0x3f0e3f6d
.long 0x3f6d3f80,0x3ec43f35,0xbec4a554,0xbf6dbf35,0xbf7bbf80,0xbf55bf6d,0xbf0ebf35,0xbe48bec4
.long 0xbf803f80,0xbf803f80,0xbf803f80,0xbf803f80,0xbe48a554,0xbf0e3ec4,0xbf553f35,0xbf7b3f6d
.long 0x3f6dbf80,0x3ec4bf35,0xbec4a554,0xbf6d3f35,0x3f0e248d,0x3f7bbf6d,0x3e48bf35,0xbf553ec4
.long 0xbf353f80,0x3f35248d,0x3f35bf80,0xbf35a554,0xbf55a554,0xbe483f6d,0x3f7bbf35,0xbf0ebec4
.long 0x3ec4bf80,0xbf6d3f35,0x3f6d248d,0xbec4bf35,0x3f7b248d,0xbf55bec4,0x3f0e3f35,0xbe48bf6d
.long 0xa5543f80,0x248dbf80,0xa5543f80,0x248dbf80,0xbf7ba554,0x3f55bec4,0xbf0e3f35,0x3e48bf6d
.long 0xbec4bf80,0x3f6d3f35,0xbf6da554,0x3ec4bf35,0x3f55248d,0x3e483f6d,0xbf7bbf35,0x3f0ebec4
.long 0x3f353f80,0xbf35a554,0xbf35bf80,0x3f35248d,0xbf0ea554,0xbf7bbf6d,0xbe48bf35,0x3f553ec4
.long 0xbf6dbf80,0xbec4bf35,0x3ec4248d,0x3f6d3f35,0x3e48248d,0x3f0e3ec4,0x3f553f35,0x3f7b3f6d
.long 0xa554248d,0xa554248d,0xa554248d,0xa554248d,0x3e95bdc9,0x3f22bef1,0x3f62bf46,0x3f7fbf75
.long 0x3f0ebe48,0x3f7bbf55,0x3f55bf7b,0x3e48bf0e,0x3f46be95,0x3f62bf7f,0xbdc9bef1,0xbf753f22
.long 0x3f6dbec4,0x3ec4bf6d,0xbf6d3ec4,0xbec43f6d,0x3f7fbef1,0xbe95bf22,0xbf463f75,0x3f62bdc9
.long 0x3f7bbf0e,0xbf55be48,0x3e483f55,0x3f0ebf7b,0x3f62bf22,0xbf7f3e95,0x3f753dc9,0xbf46bef1
.long 0x3f35bf35,0xbf353f35,0x3f35bf35,0xbf353f35,0x3ef1bf46,0xbdc93f75,0xbe95bf7f,0x3f223f62
.long 0x3e48bf55,0x3f0e3f7b,0xbf7bbf0e,0x3f55be48,0xbdc9bf62,0x3f753f46,0xbf223e95,0xbef1bf7f
.long 0xbec4bf6d,0x3f6d3ec4,0x3ec43f6d,0xbf6dbec4,0xbf22bf75,0x3ef1bdc9,0x3f7f3f62,0x3e953f46
.long 0xbf55bf7b,0xbe48bf0e,0x3f0e3e48,0x3f7b3f55,0xbf75bf7f,0xbf46bf62,0xbef1bf22,0xbdc9be95
.long 0xa554248d,0xa554248d,0xa554248d,0xa554248d,0x3f75bf7f,0x3f46bf62,0x3ef1bf22,0x3dc9be95
.long 0xbf0e3e48,0xbf7b3f55,0xbf553f7b,0xbe483f0e,0xbf223f75,0x3ef13dc9,0x3f7fbf62,0x3e95bf46
.long 0x3f6dbec4,0x3ec4bf6d,0xbf6d3ec4,0xbec43f6d,0x3dc9bf62,0xbf753f46,0x3f223e95,0x3ef1bf7f
.long 0xbf7b3f0e,0x3f553e48,0xbe48bf55,0xbf0e3f7b,0x3ef13f46,0xbdc9bf75,0xbe953f7f,0x3f22bf62
.long 0x3f35bf35,0xbf353f35,0x3f35bf35,0xbf353f35,0xbf62bf22,0x3f7f3e95,0xbf753dc9,0x3f46bef1
.long 0xbe483f55,0xbf0ebf7b,0x3f7b3f0e,0xbf553e48,0x3f7f3ef1,0xbe953f22,0xbf46bf75,0x3f623dc9
.long 0xbec4bf6d,0x3f6d3ec4,0x3ec43f6d,0xbf6dbec4,0xbf46be95,0xbf62bf7f,0x3dc9bef1,0x3f753f22
.long 0x3f553f7b,0x3e483f0e,0xbf0ebe48,0xbf7bbf55,0x3e953dc9,0x3f223ef1,0x3f623f46,0x3f7f3f75
.long 0xa554248d,0xa554248d,0xa554248d,0xa554248d,0xbe953dc9,0xbf223ef1,0xbf623f46,0xbf7f3f75
.long 0x3f0ebe48,0x3f7bbf55,0x3f55bf7b,0x3e48bf0e,0xbf463e95,0xbf623f7f,0x3dc93ef1,0x3f75bf22
.long 0x3f6dbec4,0x3ec4bf6d,0xbf6d3ec4,0xbec43f6d,0xbf7f3ef1,0x3e953f22,0x3f46bf75,0xbf623dc9
.long 0x3f7bbf0e,0xbf55be48,0x3e483f55,0x3f0ebf7b,0xbf623f22,0x3f7fbe95,0xbf75bdc9,0x3f463ef1
.long 0x3f35bf35,0xbf353f35,0x3f35bf35,0xbf353f35,0xbef13f46,0x3dc9bf75,0x3e953f7f,0xbf22bf62
.long 0x3e48bf55,0x3f0e3f7b,0xbf7bbf0e,0x3f55be48,0x3dc93f62,0xbf75bf46,0x3f22be95,0x3ef13f7f
.long 0xbec4bf6d,0x3f6d3ec4,0x3ec43f6d,0xbf6dbec4,0x3f223f75,0xbef13dc9,0xbf7fbf62,0xbe95bf46
.long 0xbf55bf7b,0xbe48bf0e,0x3f0e3e48,0x3f7b3f55,0x3f753f7f,0x3f463f62,0x3ef13f22,0x3dc93e95
.long 0xa554248d,0xa554248d,0xa554248d,0xa554248d,0xbf753f7f,0xbf463f62,0xbef13f22,0xbdc93e95
.long 0xbf0e3e48,0xbf7b3f55,0xbf553f7b,0xbe483f0e,0x3f22bf75,0xbef1bdc9,0xbf7f3f62,0xbe953f46
.long 0x3f6dbec4,0x3ec4bf6d,0xbf6d3ec4,0xbec43f6d,0xbdc93f62,0x3f75bf46,0xbf22be95,0xbef13f7f
.long 0xbf7b3f0e,0x3f553e48,0xbe48bf55,0xbf0e3f7b,0xbef1bf46,0x3dc93f75,0x3e95bf7f,0xbf223f62
.long 0x3f35bf35,0xbf353f35,0x3f35bf35,0xbf353f35,0x3f623f22,0xbf7fbe95,0x3f75bdc9,0xbf463ef1
.long 0xbe483f55,0xbf0ebf7b,0x3f7b3f0e,0xbf553e48,0xbf7fbef1,0x3e95bf22,0x3f463f75,0xbf62bdc9
.long 0xbec4bf6d,0x3f6d3ec4,0x3ec43f6d,0xbf6dbec4,0x3f463e95,0x3f623f7f,0xbdc93ef1,0xbf75bf22
.long 0x3f553f7b,0x3e483f0e,0xbf0ebe48,0xbf7bbf55,0xbe95bdc9,0xbf22bef1,0xbf62bf46,0xbf7fbf75
.long 0x3f803f80,0x3f803f80,0x3f803f80,0x3f803f80,0xbe488000,0xbf0ebec4,0xbf55bf35,0xbf7bbf6d
.long 0xbec48000,0xbf6dbf35,0xbf6dbf80,0xbec4bf35,0xbf0e8000,0xbf7bbf6d,0xbe48bf35,0x3f553ec4
.long 0xbf358000,0xbf35bf80,0x3f35a50d,0x3f353f80,0xbf558000,0xbe48bf6d,0x3f7b3f35,0xbf0e3ec4
.long 0xbf6d8000,0x3ec4bf35,0x3ec43f80,0xbf6dbf35,0xbf7b8000,0x3f55bec4,0xbf0e3f35,0x3e48bf6d
.long 0xbf808000,0x3f80a50d,0xbf808000,0x3f80a50d,0xbf7b8000,0x3f553ec4,0xbf0ebf35,0x3e483f6d
.long 0xbf6d8000,0x3ec43f35,0x3ec4bf80,0xbf6d3f35,0xbf558000,0xbe483f6d,0x3f7bbf35,0xbf0ebec4
.long 0xbf358000,0xbf353f80,0x3f35a50d,0x3f35bf80,0xbf0e8000,0xbf7b3f6d,0xbe483f35,0x3f55bec4
.long 0xbec48000,0xbf6d3f35,0xbf6d3f80,0xbec43f35,0xbe488000,0xbf0e3ec4,0xbf553f35,0xbf7b3f6d
.long 0x3f803f80,0x3f803f80,0x3f803f80,0x3f803f80,0xbf7bbf80,0xbf55bf6d,0xbf0ebf35,0xbe48bec4
.long 0x3ec4a50d,0x3f6d3f35,0x3f6d3f80,0x3ec43f35,0x3f553f80,0xbe483ec4,0xbf7bbf35,0xbf0ebf6d
.long 0xbf358000,0xbf35bf80,0x3f35a50d,0x3f353f80,0xbf0ebf80,0x3f7b3ec4,0xbe483f35,0xbf55bf6d
.long 0x3f6da50d,0xbec43f35,0xbec4bf80,0x3f6d3f35,0x3e483f80,0xbf0ebf6d,0x3f553f35,0xbf7bbec4
.long 0xbf808000,0x3f80a50d,0xbf808000,0x3f80a50d,0x3e48bf80,0xbf0e3f6d,0x3f55bf35,0xbf7b3ec4
.long 0x3f6da50d,0xbec4bf35,0xbec43f80,0x3f6dbf35,0xbf0e3f80,0x3f7bbec4,0xbe48bf35,0xbf553f6d
.long 0xbf358000,0xbf353f80,0x3f35a50d,0x3f35bf80,0x3f55bf80,0xbe48bec4,0xbf7b3f35,0xbf0e3f6d
.long 0x3ec4a50d,0x3f6dbf35,0x3f6dbf80,0x3ec4bf35,0xbf7b3f80,0xbf553f6d,0xbf0e3f35,0xbe483ec4
.long 0x3f803f80,0x3f803f80,0x3f803f80,0x3f803f80,0x3e48a50d,0x3f0e3ec4,0x3f553f35,0x3f7b3f6d
.long 0xbec48000,0xbf6dbf35,0xbf6dbf80,0xbec4bf35,0x3f0ea50d,0x3f7b3f6d,0x3e483f35,0xbf55bec4
.long 0xbf358000,0xbf35bf80,0x3f35a50d,0x3f353f80,0x3f55a50d,0x3e483f6d,0xbf7bbf35,0x3f0ebec4
.long 0xbf6d8000,0x3ec4bf35,0x3ec43f80,0xbf6dbf35,0x3f7ba50d,0xbf553ec4,0x3f0ebf35,0xbe483f6d
.long 0xbf808000,0x3f80a50d,0xbf808000,0x3f80a50d,0x3f7ba50d,0xbf55bec4,0x3f0e3f35,0xbe48bf6d
.long 0xbf6d8000,0x3ec43f35,0x3ec4bf80,0xbf6d3f35,0x3f55a50d,0x3e48bf6d,0xbf7b3f35,0x3f0e3ec4
.long 0xbf358000,0xbf353f80,0x3f35a50d,0x3f35bf80,0x3f0ea50d,0x3f7bbf6d,0x3e48bf35,0xbf553ec4
.long 0xbec48000,0xbf6d3f35,0xbf6d3f80,0xbec43f35,0x3e48a50d,0x3f0ebec4,0x3f55bf35,0x3f7bbf6d
.long 0x3f803f80,0x3f803f80,0x3f803f80,0x3f803f80,0x3f7b3f80,0x3f553f6d,0x3f0e3f35,0x3e483ec4
.long 0x3ec4a50d,0x3f6d3f35,0x3f6d3f80,0x3ec43f35,0xbf55bf80,0x3e48bec4,0x3f7b3f35,0x3f0e3f6d
.long 0xbf358000,0xbf35bf80,0x3f35a50d,0x3f353f80,0x3f0e3f80,0xbf7bbec4,0x3e48bf35,0x3f553f6d
.long 0x3f6da50d,0xbec43f35,0xbec4bf80,0x3f6d3f35,0xbe48bf80,0x3f0e3f6d,0xbf55bf35,0x3f7b3ec4
.long 0xbf808000,0x3f80a50d,0xbf808000,0x3f80a50d,0xbe483f80,0x3f0ebf6d,0xbf553f35,0x3f7bbec4
.long 0x3f6da50d,0xbec4bf35,0xbec43f80,0x3f6dbf35,0x3f0ebf80,0xbf7b3ec4,0x3e483f35,0x3f55bf6d
.long 0xbf358000,0xbf353f80,0x3f35a50d,0x3f35bf80,0xbf553f80,0x3e483ec4,0x3f7bbf35,0x3f0ebf6d
.long 0x3ec4a50d,0x3f6dbf35,0x3f6dbf80,0x3ec4bf35,0x3f7bbf80,0x3f55bf6d,0x3f0ebf35,0x3e48bec4
.long 0xbf80bf80,0xbf80bf80,0xbf80bf80,0xbf80bf80,0xbe95bdc9,0xbf22bef1,0xbf62bf46,0xbf7fbf75
.long 0xbf0ebe48,0xbf7bbf55,0xbf55bf7b,0xbe48bf0e,0xbf46be95,0xbf62bf7f,0x3dc9bef1,0x3f753f22
.long 0xbf6dbec4,0xbec4bf6d,0x3f6d3ec4,0x3ec43f6d,0xbf7fbef1,0x3e95bf22,0x3f463f75,0xbf62bdc9
.long 0xbf7bbf0e,0x3f55be48,0xbe483f55,0xbf0ebf7b,0xbf62bf22,0x3f7f3e95,0xbf753dc9,0x3f46bef1
.long 0xbf35bf35,0x3f353f35,0xbf35bf35,0x3f353f35,0xbef1bf46,0x3dc93f75,0x3e95bf7f,0xbf223f62
.long 0xbe48bf55,0xbf0e3f7b,0x3f7bbf0e,0xbf55be48,0x3dc9bf62,0xbf753f46,0x3f223e95,0x3ef1bf7f
.long 0x3ec4bf6d,0xbf6d3ec4,0xbec43f6d,0x3f6dbec4,0x3f22bf75,0xbef1bdc9,0xbf7f3f62,0xbe953f46
.long 0x3f55bf7b,0x3e48bf0e,0xbf0e3e48,0xbf7b3f55,0x3f75bf7f,0x3f46bf62,0x3ef1bf22,0x3dc9be95
.long 0xbf80bf80,0xbf80bf80,0xbf80bf80,0xbf80bf80,0xbf75bf7f,0xbf46bf62,0xbef1bf22,0xbdc9be95
.long 0x3f0e3e48,0x3f7b3f55,0x3f553f7b,0x3e483f0e,0x3f223f75,0xbef13dc9,0xbf7fbf62,0xbe95bf46
.long 0xbf6dbec4,0xbec4bf6d,0x3f6d3ec4,0x3ec43f6d,0xbdc9bf62,0x3f753f46,0xbf223e95,0xbef1bf7f
.long 0x3f7b3f0e,0xbf553e48,0x3e48bf55,0x3f0e3f7b,0xbef13f46,0x3dc9bf75,0x3e953f7f,0xbf22bf62
.long 0xbf35bf35,0x3f353f35,0xbf35bf35,0x3f353f35,0x3f62bf22,0xbf7f3e95,0x3f753dc9,0xbf46bef1
.long 0x3e483f55,0x3f0ebf7b,0xbf7b3f0e,0x3f553e48,0xbf7f3ef1,0x3e953f22,0x3f46bf75,0xbf623dc9
.long 0x3ec4bf6d,0xbf6d3ec4,0xbec43f6d,0x3f6dbec4,0x3f46be95,0x3f62bf7f,0xbdc9bef1,0xbf753f22
.long 0xbf553f7b,0xbe483f0e,0x3f0ebe48,0x3f7bbf55,0xbe953dc9,0xbf223ef1,0xbf623f46,0xbf7f3f75
.long 0xbf80bf80,0xbf80bf80,0xbf80bf80,0xbf80bf80,0x3e953dc9,0x3f223ef1,0x3f623f46,0x3f7f3f75
.long 0xbf0ebe48,0xbf7bbf55,0xbf55bf7b,0xbe48bf0e,0x3f463e95,0x3f623f7f,0xbdc93ef1,0xbf75bf22
.long 0xbf6dbec4,0xbec4bf6d,0x3f6d3ec4,0x3ec43f6d,0x3f7f3ef1,0xbe953f22,0xbf46bf75,0x3f623dc9
.long 0xbf7bbf0e,0x3f55be48,0xbe483f55,0xbf0ebf7b,0x3f623f22,0xbf7fbe95,0x3f75bdc9,0xbf463ef1
.long 0xbf35bf35,0x3f353f35,0xbf35bf35,0x3f353f35,0x3ef13f46,0xbdc9bf75,0xbe953f7f,0x3f22bf62
.long 0xbe48bf55,0xbf0e3f7b,0x3f7bbf0e,0xbf55be48,0xbdc93f62,0x3f75bf46,0xbf22be95,0xbef13f7f
.long 0x3ec4bf6d,0xbf6d3ec4,0xbec43f6d,0x3f6dbec4,0xbf223f75,0x3ef13dc9,0x3f7fbf62,0x3e95bf46
.long 0x3f55bf7b,0x3e48bf0e,0xbf0e3e48,0xbf7b3f55,0xbf753f7f,0xbf463f62,0xbef13f22,0xbdc93e95
.long 0xbf80bf80,0xbf80bf80,0xbf80bf80,0xbf80bf80,0x3f753f7f,0x3f463f62,0x3ef13f22,0x3dc93e95
.long 0x3f0e3e48,0x3f7b3f55,0x3f553f7b,0x3e483f0e,0xbf22bf75,0x3ef1bdc9,0x3f7f3f62,0x3e953f46
.long 0xbf6dbec4,0xbec4bf6d,0x3f6d3ec4,0x3ec43f6d,0x3dc93f62,0xbf75bf46,0x3f22be95,0x3ef13f7f
.long 0x3f7b3f0e,0xbf553e48,0x3e48bf55,0x3f0e3f7b,0x3ef1bf46,0xbdc93f75,0xbe95bf7f,0x3f223f62
.long 0xbf35bf35,0x3f353f35,0xbf35bf35,0x3f353f35,0xbf623f22,0x3f7fbe95,0xbf75bdc9,0x3f463ef1
.long 0x3e483f55,0x3f0ebf7b,0xbf7b3f0e,0x3f553e48,0x3f7fbef1,0xbe95bf22,0xbf463f75,0x3f62bdc9
.long 0x3ec4bf6d,0xbf6d3ec4,0xbec43f6d,0x3f6dbec4,0xbf463e95,0xbf623f7f,0x3dc93ef1,0x3f75bf22
.long 0xbf553f7b,0xbe483f0e,0x3f0ebe48,0x3f7bbf55,0x3e95bdc9,0x3f22bef1,0x3f62bf46,0x3f7fbf75
.long 0xa50d8000,0xa50d8000,0xa50d8000,0xa50d8000,0x3e488000,0x3f0ebec4,0x3f55bf35,0x3f7bbf6d
.long 0x3ec48000,0x3f6dbf35,0x3f6dbf80,0x3ec4bf35,0x3f0e8000,0x3f7bbf6d,0x3e48bf35,0xbf553ec4
.long 0x3f358000,0x3f35bf80,0xbf35a50d,0xbf353f80,0x3f558000,0x3e48bf6d,0xbf7b3f35,0x3f0e3ec4
.long 0x3f6d8000,0xbec4bf35,0xbec43f80,0x3f6dbf35,0x3f7b8000,0xbf55bec4,0x3f0e3f35,0xbe48bf6d
.long 0x3f808000,0xbf80a50d,0x3f808000,0xbf80a50d,0x3f7b8000,0xbf553ec4,0x3f0ebf35,0xbe483f6d
.long 0x3f6d8000,0xbec43f35,0xbec4bf80,0x3f6d3f35,0x3f558000,0x3e483f6d,0xbf7bbf35,0x3f0ebec4
.long 0x3f358000,0x3f353f80,0xbf35a50d,0xbf35bf80,0x3f0e8000,0x3f7b3f6d,0x3e483f35,0xbf55bec4
.long 0x3ec48000,0x3f6d3f35,0x3f6d3f80,0x3ec43f35,0x3e488000,0x3f0e3ec4,0x3f553f35,0x3f7b3f6d
.long 0xa50d8000,0xa50d8000,0xa50d8000,0xa50d8000,0x3f7bbf80,0x3f55bf6d,0x3f0ebf35,0x3e48bec4
.long 0xbec4a50d,0xbf6d3f35,0xbf6d3f80,0xbec43f35,0xbf553f80,0x3e483ec4,0x3f7bbf35,0x3f0ebf6d
.long 0x3f358000,0x3f35bf80,0xbf35a50d,0xbf353f80,0x3f0ebf80,0xbf7b3ec4,0x3e483f35,0x3f55bf6d
.long 0xbf6da50d,0x3ec43f35,0x3ec4bf80,0xbf6d3f35,0xbe483f80,0x3f0ebf6d,0xbf553f35,0x3f7bbec4
.long 0x3f808000,0xbf80a50d,0x3f808000,0xbf80a50d,0xbe48bf80,0x3f0e3f6d,0xbf55bf35,0x3f7b3ec4
.long 0xbf6da50d,0x3ec4bf35,0x3ec43f80,0xbf6dbf35,0x3f0e3f80,0xbf7bbec4,0x3e48bf35,0x3f553f6d
.long 0x3f358000,0x3f353f80,0xbf35a50d,0xbf35bf80,0xbf55bf80,0x3e48bec4,0x3f7b3f35,0x3f0e3f6d
.long 0xbec4a50d,0xbf6dbf35,0xbf6dbf80,0xbec4bf35,0x3f7b3f80,0x3f553f6d,0x3f0e3f35,0x3e483ec4
.long 0xa50d8000,0xa50d8000,0xa50d8000,0xa50d8000,0xbe48a50d,0xbf0e3ec4,0xbf553f35,0xbf7b3f6d
.long 0x3ec48000,0x3f6dbf35,0x3f6dbf80,0x3ec4bf35,0xbf0ea50d,0xbf7b3f6d,0xbe483f35,0x3f55bec4
.long 0x3f358000,0x3f35bf80,0xbf35a50d,0xbf353f80,0xbf55a50d,0xbe483f6d,0x3f7bbf35,0xbf0ebec4
.long 0x3f6d8000,0xbec4bf35,0xbec43f80,0x3f6dbf35,0xbf7ba50d,0x3f553ec4,0xbf0ebf35,0x3e483f6d
.long 0x3f808000,0xbf80a50d,0x3f808000,0xbf80a50d,0xbf7ba50d,0x3f55bec4,0xbf0e3f35,0x3e48bf6d
.long 0x3f6d8000,0xbec43f35,0xbec4bf80,0x3f6d3f35,0xbf55a50d,0xbe48bf6d,0x3f7b3f35,0xbf0e3ec4
.long 0x3f358000,0x3f353f80,0xbf35a50d,0xbf35bf80,0xbf0ea50d,0xbf7bbf6d,0xbe48bf35,0x3f553ec4
.long 0x3ec48000,0x3f6d3f35,0x3f6d3f80,0x3ec43f35,0xbe48a50d,0xbf0ebec4,0xbf55bf35,0xbf7bbf6d
.long 0xa50d8000,0xa50d8000,0xa50d8000,0xa50d8000,0xbf7b3f80,0xbf553f6d,0xbf0e3f35,0xbe483ec4
.long 0xbec4a50d,0xbf6d3f35,0xbf6d3f80,0xbec43f35,0x3f55bf80,0xbe48bec4,0xbf7b3f35,0xbf0e3f6d
.long 0x3f358000,0x3f35bf80,0xbf35a50d,0xbf353f80,0xbf0e3f80,0x3f7bbec4,0xbe48bf35,0xbf553f6d
.long 0xbf6da50d,0x3ec43f35,0x3ec4bf80,0xbf6d3f35,0x3e48bf80,0xbf0e3f6d,0x3f55bf35,0xbf7b3ec4
.long 0x3f808000,0xbf80a50d,0x3f808000,0xbf80a50d,0x3e483f80,0xbf0ebf6d,0x3f553f35,0xbf7bbec4
.long 0xbf6da50d,0x3ec4bf35,0x3ec43f80,0xbf6dbf35,0xbf0ebf80,0x3f7b3ec4,0xbe483f35,0xbf55bf6d
.long 0x3f358000,0x3f353f80,0xbf35a50d,0xbf35bf80,0x3f553f80,0xbe483ec4,0xbf7bbf35,0xbf0ebf6d
.long 0xbec4a50d,0xbf6dbf35,0xbf6dbf80,0xbec4bf35,0xbf7bbf80,0xbf55bf6d,0xbf0ebf35,0xbe48bec4
.long 0x3f80bf80,0x3f80bf80,0x3f80bf80,0x3f80bf80,0x3f75bf7f,0x3f46bf62,0x3ef1bf22,0x3dc9be95
.long 0x3f55bf7b,0x3e48bf0e,0xbf0e3e48,0xbf7b3f55,0x3f22bf75,0xbef1bdc9,0xbf7f3f62,0xbe953f46
.long 0x3ec4bf6d,0xbf6d3ec4,0xbec43f6d,0x3f6dbec4,0x3dc9bf62,0xbf753f46,0x3f223e95,0x3ef1bf7f
.long 0xbe48bf55,0xbf0e3f7b,0x3f7bbf0e,0xbf55be48,0xbef1bf46,0x3dc93f75,0x3e95bf7f,0xbf223f62
.long 0xbf35bf35,0x3f353f35,0xbf35bf35,0x3f353f35,0xbf62bf22,0x3f7f3e95,0xbf753dc9,0x3f46bef1
.long 0xbf7bbf0e,0x3f55be48,0xbe483f55,0xbf0ebf7b,0xbf7fbef1,0x3e95bf22,0x3f463f75,0xbf62bdc9
.long 0xbf6dbec4,0xbec4bf6d,0x3f6d3ec4,0x3ec43f6d,0xbf46be95,0xbf62bf7f,0x3dc9bef1,0x3f753f22
.long 0xbf0ebe48,0xbf7bbf55,0xbf55bf7b,0xbe48bf0e,0xbe95bdc9,0xbf22bef1,0xbf62bf46,0xbf7fbf75
.long 0x3f80bf80,0x3f80bf80,0x3f80bf80,0x3f80bf80,0xbe953dc9,0xbf223ef1,0xbf623f46,0xbf7f3f75
.long 0xbf553f7b,0xbe483f0e,0x3f0ebe48,0x3f7bbf55,0x3f46be95,0x3f62bf7f,0xbdc9bef1,0xbf753f22
.long 0x3ec4bf6d,0xbf6d3ec4,0xbec43f6d,0x3f6dbec4,0xbf7f3ef1,0x3e953f22,0x3f46bf75,0xbf623dc9
.long 0x3e483f55,0x3f0ebf7b,0xbf7b3f0e,0x3f553e48,0x3f62bf22,0xbf7f3e95,0x3f753dc9,0xbf46bef1
.long 0xbf35bf35,0x3f353f35,0xbf35bf35,0x3f353f35,0xbef13f46,0x3dc9bf75,0x3e953f7f,0xbf22bf62
.long 0x3f7b3f0e,0xbf553e48,0x3e48bf55,0x3f0e3f7b,0xbdc9bf62,0x3f753f46,0xbf223e95,0xbef1bf7f
.long 0xbf6dbec4,0xbec4bf6d,0x3f6d3ec4,0x3ec43f6d,0x3f223f75,0xbef13dc9,0xbf7fbf62,0xbe95bf46
.long 0x3f0e3e48,0x3f7b3f55,0x3f553f7b,0x3e483f0e,0xbf75bf7f,0xbf46bf62,0xbef1bf22,0xbdc9be95
.long 0x3f80bf80,0x3f80bf80,0x3f80bf80,0x3f80bf80,0xbf753f7f,0xbf463f62,0xbef13f22,0xbdc93e95
.long 0x3f55bf7b,0x3e48bf0e,0xbf0e3e48,0xbf7b3f55,0xbf223f75,0x3ef13dc9,0x3f7fbf62,0x3e95bf46
.long 0x3ec4bf6d,0xbf6d3ec4,0xbec43f6d,0x3f6dbec4,0xbdc93f62,0x3f75bf46,0xbf22be95,0xbef13f7f
.long 0xbe48bf55,0xbf0e3f7b,0x3f7bbf0e,0xbf55be48,0x3ef13f46,0xbdc9bf75,0xbe953f7f,0x3f22bf62
.long 0xbf35bf35,0x3f353f35,0xbf35bf35,0x3f353f35,0x3f623f22,0xbf7fbe95,0x3f75bdc9,0xbf463ef1
.long 0xbf7bbf0e,0x3f55be48,0xbe483f55,0xbf0ebf7b,0x3f7f3ef1,0xbe953f22,0xbf46bf75,0x3f623dc9
.long 0xbf6dbec4,0xbec4bf6d,0x3f6d3ec4,0x3ec43f6d,0x3f463e95,0x3f623f7f,0xbdc93ef1,0xbf75bf22
.long 0xbf0ebe48,0xbf7bbf55,0xbf55bf7b,0xbe48bf0e,0x3e953dc9,0x3f223ef1,0x3f623f46,0x3f7f3f75
.long 0x3f80bf80,0x3f80bf80,0x3f80bf80,0x3f80bf80,0x3e95bdc9,0x3f22bef1,0x3f62bf46,0x3f7fbf75
.long 0xbf553f7b,0xbe483f0e,0x3f0ebe48,0x3f7bbf55,0xbf463e95,0xbf623f7f,0x3dc93ef1,0x3f75bf22
.long 0x3ec4bf6d,0xbf6d3ec4,0xbec43f6d,0x3f6dbec4,0x3f7fbef1,0xbe95bf22,0xbf463f75,0x3f62bdc9
.long 0x3e483f55,0x3f0ebf7b,0xbf7b3f0e,0x3f553e48,0xbf623f22,0x3f7fbe95,0xbf75bdc9,0x3f463ef1
.long 0xbf35bf35,0x3f353f35,0xbf35bf35,0x3f353f35,0x3ef1bf46,0xbdc93f75,0xbe95bf7f,0x3f223f62
.long 0x3f7b3f0e,0xbf553e48,0x3e48bf55,0x3f0e3f7b,0x3dc93f62,0xbf75bf46,0x3f22be95,0x3ef13f7f
.long 0xbf6dbec4,0xbec4bf6d,0x3f6d3ec4,0x3ec43f6d,0xbf22bf75,0x3ef1bdc9,0x3f7f3f62,0x3e953f46
.long 0x3f0e3e48,0x3f7b3f55,0x3f553f7b,0x3e483f0e,0x3f753f7f,0x3f463f62,0x3ef13f22,0x3dc93e95
.long 0x3f803f80,0x3f803f80,0x3f803f80,0x3f803f80,0x3f6d3f80,0x3ec43f35,0xbec4248d,0xbf6dbf35
.long 0x3f353f80,0xbf35248d,0xbf35bf80,0x3f35a554,0x3ec43f80,0xbf6dbf35,0x3f6da554,0xbec43f35
.long 0x248d3f80,0xa554bf80,0x248d3f80,0xa554bf80,0xbec43f80,0x3f6dbf35,0xbf6d248d,0x3ec43f35
.long 0xbf353f80,0x3f35a554,0x3f35bf80,0xbf35248d,0xbf6d3f80,0xbec43f35,0x3ec4a554,0x3f6dbf35
.long 0xbf803f80,0xbf803f80,0xbf803f80,0xbf803f80,0xbf6d3f80,0xbec43f35,0x3ec4248d,0x3f6dbf35
.long 0xbf353f80,0x3f35248d,0x3f35bf80,0xbf35a554,0xbec43f80,0x3f6dbf35,0xbf6da554,0x3ec43f35
.long 0xa5543f80,0x248dbf80,0xa5543f80,0x248dbf80,0x3ec43f80,0xbf6dbf35,0x3f6d248d,0xbec43f35
.long 0x3f353f80,0xbf35a554,0xbf35bf80,0x3f35248d,0x3f6d3f80,0x3ec43f35,0xbec4a554,0xbf6dbf35
.long 0x3f803f80,0x3f803f80,0x3f803f80,0x3f803f80,0xbf6dbf80,0xbec4bf35,0x3ec4a554,0x3f6d3f35
.long 0x3f353f80,0xbf35248d,0xbf35bf80,0x3f35a554,0xbec4bf80,0x3f6d3f35,0xbf6d248d,0x3ec4bf35
.long 0x248d3f80,0xa554bf80,0x248d3f80,0xa554bf80,0x3ec4bf80,0xbf6d3f35,0x3f6da554,0xbec4bf35
.long 0xbf353f80,0x3f35a554,0x3f35bf80,0xbf35248d,0x3f6dbf80,0x3ec4bf35,0xbec4248d,0xbf6d3f35
.long 0xbf803f80,0xbf803f80,0xbf803f80,0xbf803f80,0x3f6dbf80,0x3ec4bf35,0xbec4a554,0xbf6d3f35
.long 0xbf353f80,0x3f35248d,0x3f35bf80,0xbf35a554,0x3ec4bf80,0xbf6d3f35,0x3f6d248d,0xbec4bf35
.long 0xa5543f80,0x248dbf80,0xa5543f80,0x248dbf80,0xbec4bf80,0x3f6d3f35,0xbf6da554,0x3ec4bf35
.long 0x3f353f80,0xbf35a554,0xbf35bf80,0x3f35248d,0xbf6dbf80,0xbec4bf35,0x3ec4248d,0x3f6d3f35
.long 0x00000000,0x00000000,0x00000000,0x00000000,0x3ec40000,0x3f6d3f35,0x3f6d3f80,0x3ec43f35
.long 0x3f350000,0x3f353f80,0xbf35250d,0xbf35bf80,0x3f6d0000,0xbec43f35,0xbec4bf80,0x3f6d3f35
.long 0x3f800000,0xbf80250d,0x3f800000,0xbf80250d,0x3f6d0000,0xbec4bf35,0xbec43f80,0x3f6dbf35
.long 0x3f350000,0x3f35bf80,0xbf35250d,0xbf353f80,0x3ec40000,0x3f6dbf35,0x3f6dbf80,0x3ec4bf35
.long 0x250d0000,0x250d0000,0x250d0000,0x250d0000,0xbec40000,0xbf6d3f35,0xbf6d3f80,0xbec43f35
.long 0xbf350000,0xbf353f80,0x3f35250d,0x3f35bf80,0xbf6d0000,0x3ec43f35,0x3ec4bf80,0xbf6d3f35
.long 0xbf800000,0x3f80250d,0xbf800000,0x3f80250d,0xbf6d0000,0x3ec4bf35,0x3ec43f80,0xbf6dbf35
.long 0xbf350000,0xbf35bf80,0x3f35250d,0x3f353f80,0xbec40000,0xbf6dbf35,0xbf6dbf80,0xbec4bf35
.long 0x00000000,0x00000000,0x00000000,0x00000000,0xbec4250d,0xbf6dbf35,0xbf6dbf80,0xbec4bf35
.long 0x3f350000,0x3f353f80,0xbf35250d,0xbf35bf80,0xbf6d250d,0x3ec4bf35,0x3ec43f80,0xbf6dbf35
.long 0x3f800000,0xbf80250d,0x3f800000,0xbf80250d,0xbf6d250d,0x3ec43f35,0x3ec4bf80,0xbf6d3f35
.long 0x3f350000,0x3f35bf80,0xbf35250d,0xbf353f80,0xbec4250d,0xbf6d3f35,0xbf6d3f80,0xbec43f35
.long 0x250d0000,0x250d0000,0x250d0000,0x250d0000,0x3ec4250d,0x3f6dbf35,0x3f6dbf80,0x3ec4bf35
.long 0xbf350000,0xbf353f80,0x3f35250d,0x3f35bf80,0x3f6d250d,0xbec4bf35,0xbec43f80,0x3f6dbf35
.long 0xbf800000,0x3f80250d,0xbf800000,0x3f80250d,0x3f6d250d,0xbec43f35,0xbec4bf80,0x3f6d3f35
.long 0xbf350000,0xbf35bf80,0x3f35250d,0x3f353f80,0x3ec4250d,0x3f6d3f35,0x3f6d3f80,0x3ec43f35
.long 0x80008000,0x80008000,0x80008000,0x80008000,0xbec48000,0xbf6dbf35,0xbf6dbf80,0xbec4bf35
.long 0xbf358000,0xbf35bf80,0x3f35a50d,0x3f353f80,0xbf6d8000,0x3ec4bf35,0x3ec43f80,0xbf6dbf35
.long 0xbf808000,0x3f80a50d,0xbf808000,0x3f80a50d,0xbf6d8000,0x3ec43f35,0x3ec4bf80,0xbf6d3f35
.long 0xbf358000,0xbf353f80,0x3f35a50d,0x3f35bf80,0xbec48000,0xbf6d3f35,0xbf6d3f80,0xbec43f35
.long 0xa50d8000,0xa50d8000,0xa50d8000,0xa50d8000,0x3ec48000,0x3f6dbf35,0x3f6dbf80,0x3ec4bf35
.long 0x3f358000,0x3f35bf80,0xbf35a50d,0xbf353f80,0x3f6d8000,0xbec4bf35,0xbec43f80,0x3f6dbf35
.long 0x3f808000,0xbf80a50d,0x3f808000,0xbf80a50d,0x3f6d8000,0xbec43f35,0xbec4bf80,0x3f6d3f35
.long 0x3f358000,0x3f353f80,0xbf35a50d,0xbf35bf80,0x3ec48000,0x3f6d3f35,0x3f6d3f80,0x3ec43f35
.long 0x80008000,0x80008000,0x80008000,0x80008000,0x3ec4a50d,0x3f6d3f35,0x3f6d3f80,0x3ec43f35
.long 0xbf358000,0xbf35bf80,0x3f35a50d,0x3f353f80,0x3f6da50d,0xbec43f35,0xbec4bf80,0x3f6d3f35
.long 0xbf808000,0x3f80a50d,0xbf808000,0x3f80a50d,0x3f6da50d,0xbec4bf35,0xbec43f80,0x3f6dbf35
.long 0xbf358000,0xbf353f80,0x3f35a50d,0x3f35bf80,0x3ec4a50d,0x3f6dbf35,0x3f6dbf80,0x3ec4bf35
.long 0xa50d8000,0xa50d8000,0xa50d8000,0xa50d8000,0xbec4a50d,0xbf6d3f35,0xbf6d3f80,0xbec43f35
.long 0x3f358000,0x3f35bf80,0xbf35a50d,0xbf353f80,0xbf6da50d,0x3ec43f35,0x3ec4bf80,0xbf6d3f35
.long 0x3f808000,0xbf80a50d,0x3f808000,0xbf80a50d,0xbf6da50d,0x3ec4bf35,0x3ec43f80,0xbf6dbf35
.long 0x3f358000,0x3f353f80,0xbf35a50d,0xbf35bf80,0xbec4a50d,0xbf6dbf35,0xbf6dbf80,0xbec4bf35
.long 0x3f803f80,0x3f803f80,0x3f803f80,0x3f803f80,0x3f6d3f80,0x3ec43f35,0xbec4248d,0xbf6dbf35
.long 0x3f353f80,0xbf35248d,0xbf35bf80,0x3f35a554,0x3ec43f80,0xbf6dbf35,0x3f6da554,0xbec43f35
.long 0x248d3f80,0xa554bf80,0x248d3f80,0xa554bf80,0xbec43f80,0x3f6dbf35,0xbf6d248d,0x3ec43f35
.long 0xbf353f80,0x3f35a554,0x3f35bf80,0xbf35248d,0xbf6d3f80,0xbec43f35,0x3ec4a554,0x3f6dbf35
.long 0xbf803f80,0xbf803f80,0xbf803f80,0xbf803f80,0xbf6d3f80,0xbec43f35,0x3ec4248d,0x3f6dbf35
.long 0xbf353f80,0x3f35248d,0x3f35bf80,0xbf35a554,0xbec43f80,0x3f6dbf35,0xbf6da554,0x3ec43f35
.long 0xa5543f80,0x248dbf80,0xa5543f80,0x248dbf80,0x3ec43f80,0xbf6dbf35,0x3f6d248d,0xbec43f35
.long 0x3f353f80,0xbf35a554,0xbf35bf80,0x3f35248d,0x3f6d3f80,0x3ec43f35,0xbec4a554,0xbf6dbf35
.long 0x3f803f80,0x3f803f80,0x3f803f80,0x3f803f80,0xbf6dbf80,0xbec4bf35,0x3ec4a554,0x3f6d3f35
.long 0x3f353f80,0xbf35248d,0xbf35bf80,0x3f35a554,0xbec4bf80,0x3f6d3f35,0xbf6d248d,0x3ec4bf35
.long 0x248d3f80,0xa554bf80,0x248d3f80,0xa554bf80,0x3ec4bf80,0xbf6d3f35,0x3f6da554,0xbec4bf35
.long 0xbf353f80,0x3f35a554,0x3f35bf80,0xbf35248d,0x3f6dbf80,0x3ec4bf35,0xbec4248d,0xbf6d3f35
.long 0xbf803f80,0xbf803f80,0xbf803f80,0xbf803f80,0x3f6dbf80,0x3ec4bf35,0xbec4a554,0xbf6d3f35
.long 0xbf353f80,0x3f35248d,0x3f35bf80,0xbf35a554,0x3ec4bf80,0xbf6d3f35,0x3f6d248d,0xbec4bf35
.long 0xa5543f80,0x248dbf80,0xa5543f80,0x248dbf80,0xbec4bf80,0x3f6d3f35,0xbf6da554,0x3ec4bf35
.long 0x3f353f80,0xbf35a554,0xbf35bf80,0x3f35248d,0xbf6dbf80,0xbec4bf35,0x3ec4248d,0x3f6d3f35
.long 0x3f803f80,0x3f803f80,0x3f803f80,0x3f803f80,0x3f7b3f80,0x3f553f6d,0xbf7bbf80,0xbf55bf6d
.long 0x3f6d3f80,0x3ec43f35,0x3f6d3f80,0x3ec43f35,0x3f553f80,0xbe483ec4,0xbf55bf80,0x3e48bec4
.long 0x3f353f80,0xbf35248d,0x3f353f80,0xbf35248d,0x3f0e3f80,0xbf7bbec4,0xbf0ebf80,0x3f7b3ec4
.long 0x3ec43f80,0xbf6dbf35,0x3ec43f80,0xbf6dbf35,0x3e483f80,0xbf0ebf6d,0xbe48bf80,0x3f0e3f6d
.long 0x248d3f80,0xa554bf80,0x248d3f80,0xa554bf80,0xbe483f80,0x3f0ebf6d,0x3e48bf80,0xbf0e3f6d
.long 0xbec43f80,0x3f6dbf35,0xbec43f80,0x3f6dbf35,0xbf0e3f80,0x3f7bbec4,0x3f0ebf80,0xbf7b3ec4
.long 0xbf353f80,0x3f35a554,0xbf353f80,0x3f35a554,0xbf553f80,0x3e483ec4,0x3f55bf80,0xbe48bec4
.long 0xbf6d3f80,0xbec43f35,0xbf6d3f80,0xbec43f35,0xbf7b3f80,0xbf553f6d,0x3f7bbf80,0x3f55bf6d
.long 0x3f803f80,0x3f803f80,0x3f803f80,0x3f803f80,0x3f0e3f35,0x3e483ec4,0xbf0ebf35,0xbe48bec4
.long 0xbec4248d,0xbf6dbf35,0xbec4248d,0xbf6dbf35,0xbf7bbf35,0xbf0ebf6d,0x3f7b3f35,0x3f0e3f6d
.long 0xbf35bf80,0x3f35a554,0xbf35bf80,0x3f35a554,0x3e48bf35,0x3f553f6d,0xbe483f35,0xbf55bf6d
.long 0x3f6da554,0xbec43f35,0x3f6da554,0xbec43f35,0x3f553f35,0xbf7bbec4,0xbf55bf35,0x3f7b3ec4
.long 0x248d3f80,0xa554bf80,0x248d3f80,0xa554bf80,0xbf553f35,0x3f7bbec4,0x3f55bf35,0xbf7b3ec4
.long 0xbf6d248d,0x3ec43f35,0xbf6d248d,0x3ec43f35,0xbe48bf35,0xbf553f6d,0x3e483f35,0x3f55bf6d
.long 0x3f35bf80,0xbf35248d,0x3f35bf80,0xbf35248d,0x3f7bbf35,0x3f0ebf6d,0xbf7b3f35,0xbf0e3f6d
.long 0x3ec4a554,0x3f6dbf35,0x3ec4a554,0x3f6dbf35,0xbf0e3f35,0xbe483ec4,0x3f0ebf35,0x3e48bec4
.long 0x3f803f80,0x3f803f80,0x3f803f80,0x3f803f80,0xbe48248d,0xbf0ebec4,0x3e48a554,0x3f0e3ec4
.long 0xbf6dbf80,0xbec4bf35,0xbf6dbf80,0xbec4bf35,0x3f0ea554,0x3f7b3f6d,0xbf0e248d,0xbf7bbf6d
.long 0x3f353f80,0xbf35248d,0x3f353f80,0xbf35248d,0xbf55248d,0xbe48bf6d,0x3f55a554,0x3e483f6d
.long 0xbec4bf80,0x3f6d3f35,0xbec4bf80,0x3f6d3f35,0x3f7ba554,0xbf553ec4,0xbf7b248d,0x3f55bec4
.long 0x248d3f80,0xa554bf80,0x248d3f80,0xa554bf80,0xbf7b248d,0x3f553ec4,0x3f7ba554,0xbf55bec4
.long 0x3ec4bf80,0xbf6d3f35,0x3ec4bf80,0xbf6d3f35,0x3f55a554,0x3e48bf6d,0xbf55248d,0xbe483f6d
.long 0xbf353f80,0x3f35a554,0xbf353f80,0x3f35a554,0xbf0e248d,0xbf7b3f6d,0x3f0ea554,0x3f7bbf6d
.long 0x3f6dbf80,0x3ec4bf35,0x3f6dbf80,0x3ec4bf35,0x3e48a554,0x3f0ebec4,0xbe48248d,0xbf0e3ec4
.long 0x3f803f80,0x3f803f80,0x3f803f80,0x3f803f80,0xbf55bf35,0xbf7bbf6d,0x3f553f35,0x3f7b3f6d
.long 0x3ec4a554,0x3f6d3f35,0x3ec4a554,0x3f6d3f35,0x3e483f35,0xbf55bec4,0xbe48bf35,0x3f553ec4
.long 0xbf35bf80,0x3f35a554,0xbf35bf80,0x3f35a554,0x3f7b3f35,0xbf0e3ec4,0xbf7bbf35,0x3f0ebec4
.long 0xbf6d248d,0x3ec4bf35,0xbf6d248d,0x3ec4bf35,0x3f0ebf35,0xbe483f6d,0xbf0e3f35,0x3e48bf6d
.long 0x248d3f80,0xa554bf80,0x248d3f80,0xa554bf80,0xbf0ebf35,0x3e483f6d,0x3f0e3f35,0xbe48bf6d
.long 0x3f6da554,0xbec4bf35,0x3f6da554,0xbec4bf35,0xbf7b3f35,0x3f0e3ec4,0x3f7bbf35,0xbf0ebec4
.long 0x3f35bf80,0xbf35248d,0x3f35bf80,0xbf35248d,0xbe483f35,0x3f55bec4,0x3e48bf35,0xbf553ec4
.long 0xbec4248d,0xbf6d3f35,0xbec4248d,0xbf6d3f35,0x3f55bf35,0x3f7bbf6d,0xbf553f35,0xbf7b3f6d
.long 0x00000000,0x00000000,0x00000000,0x00000000,0x3e480000,0x3f0e3ec4,0xbe48250d,0xbf0ebec4
.long 0x3ec40000,0x3f6d3f35,0x3ec40000,0x3f6d3f35,0x3f0e0000,0x3f7b3f6d,0xbf0e250d,0xbf7bbf6d
.long 0x3f350000,0x3f353f80,0x3f350000,0x3f353f80,0x3f550000,0x3e483f6d,0xbf55250d,0xbe48bf6d
.long 0x3f6d0000,0xbec43f35,0x3f6d0000,0xbec43f35,0x3f7b0000,0xbf553ec4,0xbf7b250d,0x3f55bec4
.long 0x3f800000,0xbf80250d,0x3f800000,0xbf80250d,0x3f7b0000,0xbf55bec4,0xbf7b250d,0x3f553ec4
.long 0x3f6d0000,0xbec4bf35,0x3f6d0000,0xbec4bf35,0x3f550000,0x3e48bf6d,0xbf55250d,0xbe483f6d
.long 0x3f350000,0x3f35bf80,0x3f350000,0x3f35bf80,0x3f0e0000,0x3f7bbf6d,0xbf0e250d,0xbf7b3f6d
.long 0x3ec40000,0x3f6dbf35,0x3ec40000,0x3f6dbf35,0x3e480000,0x3f0ebec4,0xbe48250d,0xbf0e3ec4
.long 0x00000000,0x00000000,0x00000000,0x00000000,0x3f553f35,0x3f7b3f6d,0xbf55bf35,0xbf7bbf6d
.long 0x3f6d3f80,0x3ec43f35,0x3f6d3f80,0x3ec43f35,0x3e483f35,0xbf55bec4,0xbe48bf35,0x3f553ec4
.long 0xbf35250d,0xbf35bf80,0xbf35250d,0xbf35bf80,0xbf7bbf35,0x3f0ebec4,0x3f7b3f35,0xbf0e3ec4
.long 0xbec4bf80,0x3f6d3f35,0xbec4bf80,0x3f6d3f35,0x3f0ebf35,0xbe483f6d,0xbf0e3f35,0x3e48bf6d
.long 0x3f800000,0xbf80250d,0x3f800000,0xbf80250d,0x3f0e3f35,0xbe48bf6d,0xbf0ebf35,0x3e483f6d
.long 0xbec43f80,0x3f6dbf35,0xbec43f80,0x3f6dbf35,0xbf7b3f35,0x3f0e3ec4,0x3f7bbf35,0xbf0ebec4
.long 0xbf35250d,0xbf353f80,0xbf35250d,0xbf353f80,0x3e48bf35,0xbf553ec4,0xbe483f35,0x3f55bec4
.long 0x3f6dbf80,0x3ec4bf35,0x3f6dbf80,0x3ec4bf35,0x3f55bf35,0x3f7bbf6d,0xbf553f35,0xbf7b3f6d
.long 0x00000000,0x00000000,0x00000000,0x00000000,0x3f7b3f80,0x3f553f6d,0xbf7bbf80,0xbf55bf6d
.long 0xbec4250d,0xbf6dbf35,0xbec4250d,0xbf6dbf35,0xbf55bf80,0x3e48bec4,0x3f553f80,0xbe483ec4
.long 0x3f350000,0x3f353f80,0x3f350000,0x3f353f80,0x3f0e3f80,0xbf7bbec4,0xbf0ebf80,0x3f7b3ec4
.long 0xbf6d250d,0x3ec4bf35,0xbf6d250d,0x3ec4bf35,0xbe48bf80,0x3f0e3f6d,0x3e483f80,0xbf0ebf6d
.long 0x3f800000,0xbf80250d,0x3f800000,0xbf80250d,0xbe483f80,0x3f0ebf6d,0x3e48bf80,0xbf0e3f6d
.long 0xbf6d250d,0x3ec43f35,0xbf6d250d,0x3ec43f35,0x3f0ebf80,0xbf7b3ec4,0xbf0e3f80,0x3f7bbec4
.long 0x3f350000,0x3f35bf80,0x3f350000,0x3f35bf80,0xbf553f80,0x3e483ec4,0x3f55bf80,0xbe48bec4
.long 0xbec4250d,0xbf6d3f35,0xbec4250d,0xbf6d3f35,0x3f7bbf80,0x3f55bf6d,0xbf7b3f80,0xbf553f6d
.long 0x00000000,0x00000000,0x00000000,0x00000000,0x3f0e3f35,0x3e483ec4,0xbf0ebf35,0xbe48bec4
.long 0xbf6dbf80,0xbec4bf35,0xbf6dbf80,0xbec4bf35,0x3f7b3f35,0x3f0e3f6d,0xbf7bbf35,0xbf0ebf6d
.long 0xbf35250d,0xbf35bf80,0xbf35250d,0xbf35bf80,0x3e48bf35,0x3f553f6d,0xbe483f35,0xbf55bf6d
.long 0x3ec43f80,0xbf6dbf35,0x3ec43f80,0xbf6dbf35,0xbf55bf35,0x3f7b3ec4,0x3f553f35,0xbf7bbec4
.long 0x3f800000,0xbf80250d,0x3f800000,0xbf80250d,0xbf553f35,0x3f7bbec4,0x3f55bf35,0xbf7b3ec4
.long 0x3ec4bf80,0xbf6d3f35,0x3ec4bf80,0xbf6d3f35,0x3e483f35,0x3f55bf6d,0xbe48bf35,0xbf553f6d
.long 0xbf35250d,0xbf353f80,0xbf35250d,0xbf353f80,0x3f7bbf35,0x3f0ebf6d,0xbf7b3f35,0xbf0e3f6d
.long 0xbf6d3f80,0xbec43f35,0xbf6d3f80,0xbec43f35,0x3f0ebf35,0x3e48bec4,0xbf0e3f35,0xbe483ec4
.long 0xbf803f80,0xbf803f80,0xbf803f80,0xbf803f80,0xbf7b3f80,0xbf553f6d,0x3f7bbf80,0x3f55bf6d
.long 0xbf6d3f80,0xbec43f35,0xbf6d3f80,0xbec43f35,0xbf553f80,0x3e483ec4,0x3f55bf80,0xbe48bec4
.long 0xbf353f80,0x3f35248d,0xbf353f80,0x3f35248d,0xbf0e3f80,0x3f7bbec4,0x3f0ebf80,0xbf7b3ec4
.long 0xbec43f80,0x3f6dbf35,0xbec43f80,0x3f6dbf35,0xbe483f80,0x3f0ebf6d,0x3e48bf80,0xbf0e3f6d
.long 0xa5543f80,0x248dbf80,0xa5543f80,0x248dbf80,0x3e483f80,0xbf0ebf6d,0xbe48bf80,0x3f0e3f6d
.long 0x3ec43f80,0xbf6dbf35,0x3ec43f80,0xbf6dbf35,0x3f0e3f80,0xbf7bbec4,0xbf0ebf80,0x3f7b3ec4
.long 0x3f353f80,0xbf35a554,0x3f353f80,0xbf35a554,0x3f553f80,0xbe483ec4,0xbf55bf80,0x3e48bec4
.long 0x3f6d3f80,0x3ec43f35,0x3f6d3f80,0x3ec43f35,0x3f7b3f80,0x3f553f6d,0xbf7bbf80,0xbf55bf6d
.long 0xbf803f80,0xbf803f80,0xbf803f80,0xbf803f80,0xbf0e3f35,0xbe483ec4,0x3f0ebf35,0x3e48bec4
.long 0x3ec4248d,0x3f6dbf35,0x3ec4248d,0x3f6dbf35,0x3f7bbf35,0x3f0ebf6d,0xbf7b3f35,0xbf0e3f6d
.long 0x3f35bf80,0xbf35a554,0x3f35bf80,0xbf35a554,0xbe48bf35,0xbf553f6d,0x3e483f35,0x3f55bf6d
.long 0xbf6da554,0x3ec43f35,0xbf6da554,0x3ec43f35,0xbf553f35,0x3f7bbec4,0x3f55bf35,0xbf7b3ec4
.long 0xa5543f80,0x248dbf80,0xa5543f80,0x248dbf80,0x3f553f35,0xbf7bbec4,0xbf55bf35,0x3f7b3ec4
.long 0x3f6d248d,0xbec43f35,0x3f6d248d,0xbec43f35,0x3e48bf35,0x3f553f6d,0xbe483f35,0xbf55bf6d
.long 0xbf35bf80,0x3f35248d,0xbf35bf80,0x3f35248d,0xbf7bbf35,0xbf0ebf6d,0x3f7b3f35,0x3f0e3f6d
.long 0xbec4a554,0xbf6dbf35,0xbec4a554,0xbf6dbf35,0x3f0e3f35,0x3e483ec4,0xbf0ebf35,0xbe48bec4
.long 0xbf803f80,0xbf803f80,0xbf803f80,0xbf803f80,0x3e48248d,0x3f0ebec4,0xbe48a554,0xbf0e3ec4
.long 0x3f6dbf80,0x3ec4bf35,0x3f6dbf80,0x3ec4bf35,0xbf0ea554,0xbf7b3f6d,0x3f0e248d,0x3f7bbf6d
.long 0xbf353f80,0x3f35248d,0xbf353f80,0x3f35248d,0x3f55248d,0x3e48bf6d,0xbf55a554,0xbe483f6d
.long 0x3ec4bf80,0xbf6d3f35,0x3ec4bf80,0xbf6d3f35,0xbf7ba554,0x3f553ec4,0x3f7b248d,0xbf55bec4
.long 0xa5543f80,0x248dbf80,0xa5543f80,0x248dbf80,0x3f7b248d,0xbf553ec4,0xbf7ba554,0x3f55bec4
.long 0xbec4bf80,0x3f6d3f35,0xbec4bf80,0x3f6d3f35,0xbf55a554,0xbe48bf6d,0x3f55248d,0x3e483f6d
.long 0x3f353f80,0xbf35a554,0x3f353f80,0xbf35a554,0x3f0e248d,0x3f7b3f6d,0xbf0ea554,0xbf7bbf6d
.long 0xbf6dbf80,0xbec4bf35,0xbf6dbf80,0xbec4bf35,0xbe48a554,0xbf0ebec4,0x3e48248d,0x3f0e3ec4
.long 0xbf803f80,0xbf803f80,0xbf803f80,0xbf803f80,0x3f55bf35,0x3f7bbf6d,0xbf553f35,0xbf7b3f6d
.long 0xbec4a554,0xbf6d3f35,0xbec4a554,0xbf6d3f35,0xbe483f35,0x3f55bec4,0x3e48bf35,0xbf553ec4
.long 0x3f35bf80,0xbf35a554,0x3f35bf80,0xbf35a554,0xbf7b3f35,0x3f0e3ec4,0x3f7bbf35,0xbf0ebec4
.long 0x3f6d248d,0xbec4bf35,0x3f6d248d,0xbec4bf35,0xbf0ebf35,0x3e483f6d,0x3f0e3f35,0xbe48bf6d
.long 0xa5543f80,0x248dbf80,0xa5543f80,0x248dbf80,0x3f0ebf35,0xbe483f6d,0xbf0e3f35,0x3e48bf6d
.long 0xbf6da554,0x3ec4bf35,0xbf6da554,0x3ec4bf35,0x3f7b3f35,0xbf0e3ec4,0xbf7bbf35,0x3f0ebec4
.long 0xbf35bf80,0x3f35248d,0xbf35bf80,0x3f35248d,0x3e483f35,0xbf55bec4,0xbe48bf35,0x3f553ec4
.long 0x3ec4248d,0x3f6d3f35,0x3ec4248d,0x3f6d3f35,0xbf55bf35,0xbf7bbf6d,0x3f553f35,0x3f7b3f6d
.long 0x250d0000,0x250d0000,0x250d0000,0x250d0000,0xbe480000,0xbf0e3ec4,0x3e48250d,0x3f0ebec4
.long 0xbec40000,0xbf6d3f35,0xbec40000,0xbf6d3f35,0xbf0e0000,0xbf7b3f6d,0x3f0e250d,0x3f7bbf6d
.long 0xbf350000,0xbf353f80,0xbf350000,0xbf353f80,0xbf550000,0xbe483f6d,0x3f55250d,0x3e48bf6d
.long 0xbf6d0000,0x3ec43f35,0xbf6d0000,0x3ec43f35,0xbf7b0000,0x3f553ec4,0x3f7b250d,0xbf55bec4
.long 0xbf800000,0x3f80250d,0xbf800000,0x3f80250d,0xbf7b0000,0x3f55bec4,0x3f7b250d,0xbf553ec4
.long 0xbf6d0000,0x3ec4bf35,0xbf6d0000,0x3ec4bf35,0xbf550000,0xbe48bf6d,0x3f55250d,0x3e483f6d
.long 0xbf350000,0xbf35bf80,0xbf350000,0xbf35bf80,0xbf0e0000,0xbf7bbf6d,0x3f0e250d,0x3f7b3f6d
.long 0xbec40000,0xbf6dbf35,0xbec40000,0xbf6dbf35,0xbe480000,0xbf0ebec4,0x3e48250d,0x3f0e3ec4
.long 0x250d0000,0x250d0000,0x250d0000,0x250d0000,0xbf553f35,0xbf7b3f6d,0x3f55bf35,0x3f7bbf6d
.long 0xbf6d3f80,0xbec43f35,0xbf6d3f80,0xbec43f35,0xbe483f35,0x3f55bec4,0x3e48bf35,0xbf553ec4
.long 0x3f35250d,0x3f35bf80,0x3f35250d,0x3f35bf80,0x3f7bbf35,0xbf0ebec4,0xbf7b3f35,0x3f0e3ec4
.long 0x3ec4bf80,0xbf6d3f35,0x3ec4bf80,0xbf6d3f35,0xbf0ebf35,0x3e483f6d,0x3f0e3f35,0xbe48bf6d
.long 0xbf800000,0x3f80250d,0xbf800000,0x3f80250d,0xbf0e3f35,0x3e48bf6d,0x3f0ebf35,0xbe483f6d
.long 0x3ec43f80,0xbf6dbf35,0x3ec43f80,0xbf6dbf35,0x3f7b3f35,0xbf0e3ec4,0xbf7bbf35,0x3f0ebec4
.long 0x3f35250d,0x3f353f80,0x3f35250d,0x3f353f80,0xbe48bf35,0x3f553ec4,0x3e483f35,0xbf55bec4
.long 0xbf6dbf80,0xbec4bf35,0xbf6dbf80,0xbec4bf35,0xbf55bf35,0xbf7bbf6d,0x3f553f35,0x3f7b3f6d
.long 0x250d0000,0x250d0000,0x250d0000,0x250d0000,0xbf7b3f80,0xbf553f6d,0x3f7bbf80,0x3f55bf6d
.long 0x3ec4250d,0x3f6dbf35,0x3ec4250d,0x3f6dbf35,0x3f55bf80,0xbe48bec4,0xbf553f80,0x3e483ec4
.long 0xbf350000,0xbf353f80,0xbf350000,0xbf353f80,0xbf0e3f80,0x3f7bbec4,0x3f0ebf80,0xbf7b3ec4
.long 0x3f6d250d,0xbec4bf35,0x3f6d250d,0xbec4bf35,0x3e48bf80,0xbf0e3f6d,0xbe483f80,0x3f0ebf6d
.long 0xbf800000,0x3f80250d,0xbf800000,0x3f80250d,0x3e483f80,0xbf0ebf6d,0xbe48bf80,0x3f0e3f6d
.long 0x3f6d250d,0xbec43f35,0x3f6d250d,0xbec43f35,0xbf0ebf80,0x3f7b3ec4,0x3f0e3f80,0xbf7bbec4
.long 0xbf350000,0xbf35bf80,0xbf350000,0xbf35bf80,0x3f553f80,0xbe483ec4,0xbf55bf80,0x3e48bec4
.long 0x3ec4250d,0x3f6d3f35,0x3ec4250d,0x3f6d3f35,0xbf7bbf80,0xbf55bf6d,0x3f7b3f80,0x3f553f6d
.long 0x250d0000,0x250d0000,0x250d0000,0x250d0000,0xbf0e3f35,0xbe483ec4,0x3f0ebf35,0x3e48bec4
.long 0x3f6dbf80,0x3ec4bf35,0x3f6dbf80,0x3ec4bf35,0xbf7b3f35,0xbf0e3f6d,0x3f7bbf35,0x3f0ebf6d
.long 0x3f35250d,0x3f35bf80,0x3f35250d,0x3f35bf80,0xbe48bf35,0xbf553f6d,0x3e483f35,0x3f55bf6d
.long 0xbec43f80,0x3f6dbf35,0xbec43f80,0x3f6dbf35,0x3f55bf35,0xbf7b3ec4,0xbf553f35,0x3f7bbec4
.long 0xbf800000,0x3f80250d,0xbf800000,0x3f80250d,0x3f553f35,0xbf7bbec4,0xbf55bf35,0x3f7b3ec4
.long 0xbec4bf80,0x3f6d3f35,0xbec4bf80,0x3f6d3f35,0xbe483f35,0xbf55bf6d,0x3e48bf35,0x3f553f6d
.long 0x3f35250d,0x3f353f80,0x3f35250d,0x3f353f80,0xbf7bbf35,0xbf0ebf6d,0x3f7b3f35,0x3f0e3f6d
.long 0x3f6d3f80,0x3ec43f35,0x3f6d3f80,0x3ec43f35,0xbf0ebf35,0xbe48bec4,0x3f0e3f35,0x3e483ec4
.long 0x3f800000,0x3f800000,0x3f800000,0x3f800000,0x3f800000,0x3f7ffb11,0x3f7fec43,0x3f7fd397
.long 0x3f800000,0x3f7fec43,0x3f7fb10f,0x3f7f4e6d,0x3f800000,0x3f7fd397,0x3f7f4e6d,0x3f7e70b0
.long 0x3f800000,0x3f7fb10f,0x3f7ec46d,0x3f7d3aac,0x3f800000,0x3f7f84ab,0x3f7e1324,0x3f7baccd
.long 0x3f800000,0x3f7f4e6d,0x3f7d3aac,0x3f79c79d,0x3f800000,0x3f7f0e58,0x3f7c3b28,0x3f778bc5
.long 0x3f800000,0x3f7ec46d,0x3f7b14be,0x3f74fa0b,0x3f800000,0x3f7e70b0,0x3f79c79d,0x3f721352
.long 0x3f800000,0x3f7e1324,0x3f7853f8,0x3f6ed89e,0x3f800000,0x3f7dabcc,0x3f76ba07,0x3f6b4b0c
.long 0x3f800000,0x3f7d3aac,0x3f74fa0b,0x3f676bd8,0x3f800000,0x3f7cbfc9,0x3f731447,0x3f633c5a
.long 0x3f800000,0x3f7c3b28,0x3f710908,0x3f5ebe05,0x3f800000,0x3f7baccd,0x3f6ed89e,0x3f59f26a
.long 0x3f800000,0x3f800000,0x3f800000,0x3f800000,0x3f7fb10f,0x3f7f84ab,0x3f7f4e6d,0x3f7f0e58
.long 0x3f7ec46d,0x3f7e1324,0x3f7d3aac,0x3f7c3b28,0x3f7d3aac,0x3f7baccd,0x3f79c79d,0x3f778bc5
.long 0x3f7b14be,0x3f7853f8,0x3f74fa0b,0x3f710908,0x3f7853f8,0x3f740bdd,0x3f6ed89e,0x3f68bf3c
.long 0x3f74fa0b,0x3f6ed89e,0x3f676bd8,0x3f5ebe05,0x3f710908,0x3f68bf3c,0x3f5ebe05,0x3f531849
.long 0x3f6c835e,0x3f61c598,0x3f54db31,0x3f45e403,0x3f676bd8,0x3f59f26a,0x3f49d112,0x3f373a23
.long 0x3f61c598,0x3f514d3d,0x3f3daef9,0x3f273656,0x3f5b941a,0x3f47de65,0x3f3085bb,0x3f15f6d9
.long 0x3f54db31,0x3f3daef9,0x3f226799,0x3f039c3d,0x3f4d9f02,0x3f32c8c9,0x3f13682a,0x3ee0924f
.long 0x3f45e403,0x3f273656,0x3f039c3d,0x3eb8442a,0x3f3daef9,0x3f1b02c6,0x3ee63375,0x3e8e9a22
.long 0x3f800000,0x3f800000,0x3f800000,0x3f800000,0x3f7ec46d,0x3f7e70b0,0x3f7e1324,0x3f7dabcc
.long 0x3f7b14be,0x3f79c79d,0x3f7853f8,0x3f76ba07,0x3f74fa0b,0x3f721352,0x3f6ed89e,0x3f6b4b0c
.long 0x3f6c835e,0x3f676bd8,0x3f61c598,0x3f5b941a,0x3f61c598,0x3f59f26a,0x3f514d3d,0x3f47de65
.long 0x3f54db31,0x3f49d112,0x3f3daef9,0x3f3085bb,0x3f45e403,0x3f373a23,0x3f273656,0x3f15f6d9
.long 0x3f3504f3,0x3f226799,0x3f0e39da,0x3ef15aea,0x3f226799,0x3f0b9a6b,0x3ee63375,0x3eb263ef
.long 0x3f0e39da,0x3ee63375,0x3eac7cd4,0x3e605c13,0x3ef15aea,0x3eb263ef,0x3e605c13,0x3dafb680
.long 0x3ec3ef15,0x3e78cfcc,0x3dc8bd36,0xbd48fb30,0x3e94a031,0x3e09cf86,0xbcc90ab0,0xbe3b6ecf
.long 0x3e47c5c2,0x3cc90ab0,0xbe164083,0xbea09ae5,0x3dc8bd36,0xbdafb680,0xbe888e93,0xbee0924f
.long 0x3f800000,0x3f800000,0x3f800000,0x3f800000,0x3f7d3aac,0x3f7cbfc9,0x3f7c3b28,0x3f7baccd
.long 0x3f74fa0b,0x3f731447,0x3f710908,0x3f6ed89e,0x3f676bd8,0x3f633c5a,0x3f5ebe05,0x3f59f26a
.long 0x3f54db31,0x3f4d9f02,0x3f45e403,0x3f3daef9,0x3f3daef9,0x3f32c8c9,0x3f273656,0x3f1b02c6
.long 0x3f226799,0x3f13682a,0x3f039c3d,0x3ee63375,0x3f039c3d,0x3ee0924f,0x3eb8442a,0x3e8e9a22
.long 0x3ec3ef15,0x3e94a031,0x3e47c5c2,0x3dc8bd36,0x3e78cfcc,0x3e09cf86,0x3cc90ab0,0xbdafb680
.long 0x3dc8bd36,0xbcc90ab0,0xbe164083,0xbe888e93,0xbd48fb30,0xbe3b6ecf,0xbea09ae5,0xbee0924f
.long 0xbe47c5c2,0xbeac7cd4,0xbef15aea,0xbf187fc0,0xbeac7cd4,0xbef6e0cb,0xbf1d7fd1,0xbf3b8f3b
.long 0xbef15aea,0xbf1d7fd1,0xbf3daef9,0xbf584853,0xbf187fc0,0xbf3b8f3b,0xbf584853,0xbf6db293
.long 0x3f800000,0x3f800000,0x3f800000,0x3f800000,0x3f7b14be,0x3f7a7302,0x3f79c79d,0x3f791298
.long 0x3f6c835e,0x3f6a09a7,0x3f676bd8,0x3f64aa59,0x3f54db31,0x3f4f7a1f,0x3f49d112,0x3f43e200
.long 0x3f3504f3,0x3f2beb4a,0x3f226799,0x3f187fc0,0x3f0e39da,0x3f00e7e4,0x3ee63375,0x3ec9b953
.long 0x3ec3ef15,0x3ea09ae5,0x3e78cfcc,0x3e2f10a2,0x3e47c5c2,0x3de1bc2e,0x3cc90ab0,0xbd7b2b74
.long 0x248d3132,0xbdc8bd36,0xbe47c5c2,0xbe94a031,0xbe47c5c2,0xbe9aa086,0xbecf7bca,0xbf00e7e4
.long 0xbec3ef15,0xbefc5d27,0xbf187fc0,0xbf3085bb,0xbf0e39da,0xbf299415,0xbf41d870,0xbf5695e5
.long 0xbf3504f3,0xbf4d9f02,0xbf61c598,0xbf710908,0xbf54db31,0xbf68bf3c,0xbf76ba07,0xbf7e70b0
.long 0xbf6c835e,0xbf79c79d,0xbf7fb10f,0xbf7e1324,0xbf7b14be,0xbf7ffb11,0xbf7c3b28,0xbf6ff573
.long 0x3f800000,0x3f800000,0x3f800000,0x3f800000,0x3f7853f8,0x3f778bc5,0x3f76ba07,0x3f75dec6
.long 0x3f61c598,0x3f5ebe05,0x3f5b941a,0x3f584853,0x3f3daef9,0x3f373a23,0x3f3085bb,0x3f299415
.long 0x3f0e39da,0x3f039c3d,0x3ef15aea,0x3edae880,0x3eac7cd4,0x3e8e9a22,0x3e605c13,0x3e22abb6
.long 0x3dc8bd36,0x3cc90ab0,0xbd48fb30,0xbdfab273,0xbe164083,0xbe6c9a7f,0xbea09ae5,0xbec9b953
.long 0xbec3ef15,0xbef15aea,0xbf0e39da,0xbf226799,0xbf187fc0,0xbf2e3bde,0xbf41d870,0xbf531849
.long 0xbf45e403,0xbf584853,0xbf676bd8,0xbf731447,0xbf676bd8,0xbf740bdd,0xbf7c3b28,0xbf7fd397
.long 0xbf7b14be,0xbf7fb10f,0xbf7ec46d,0xbf7853f8,0xbf7fb10f,0xbf7a7302,0xbf6ed89e,0xbf5d2d53
.long 0xbf74fa0b,0xbf64aa59,0xbf4d9f02,0xbf3085bb,0xbf5b941a,0xbf3fc767,0xbf1d7fd1,0xbeebcbbb
.long 0x3f800000,0x3f800000,0x3f800000,0x3f800000,0x3f74fa0b,0x3f740bdd,0x3f731447,0x3f721352
.long 0x3f54db31,0x3f514d3d,0x3f4d9f02,0x3f49d112,0x3f226799,0x3f1b02c6,0x3f13682a,0x3f0b9a6b
.long 0x3ec3ef15,0x3eac7cd4,0x3e94a031,0x3e78cfcc,0x3dc8bd36,0x3d16c32c,0xbcc90ab0,0xbdafb680
.long 0xbe47c5c2,0xbe888e93,0xbeac7cd4,0xbecf7bca,0xbef15aea,0xbf0b9a6b,0xbf1d7fd1,0xbf2e3bde
.long 0xbf3504f3,0xbf45e403,0xbf54db31,0xbf61c598,0xbf61c598,0xbf6db293,0xbf76ba07,0xbf7cbfc9
.long 0xbf7b14be,0xbf7f4e6d,0xbf7fb10f,0xbf7c3b28,0xbf7ec46d,0xbf791298,0xbf6ed89e,0xbf604621
.long 0xbf6c835e,0xbf5b941a,0xbf45e403,0xbf2beb4a,0xbf45e403,0xbf299415,0xbf08f59b,0xbec9b953
.long 0xbf0e39da,0xbecf7bca,0xbe78cfcc,0xbd96a905,0xbe94a031,0xbde1bc2e,0x3d96a905,0x3e827dc0
.long 0x3f800000,0x3f800000,0x3f800000,0x3f800000,0x3f710908,0x3f6ff573,0x3f6ed89e,0x3f6db293
.long 0x3f45e403,0x3f41d870,0x3f3daef9,0x3f396842,0x3f039c3d,0x3ef6e0cb,0x3ee63375,0x3ed53641
.long 0x3e47c5c2,0x3e164083,0x3dc8bd36,0x3d48fb30,0xbe164083,0xbe541501,0xbe888e93,0xbea68f12
.long 0xbef15aea,0xbf08f59b,0xbf187fc0,0xbf273656,0xbf3daef9,0xbf4bbbf8,0xbf584853,0xbf633c5a
.long 0xbf6c835e,0xbf74fa0b,0xbf7b14be,0xbf7ec46d,0xbf7fb10f,0xbf7f84ab,0xbf7c3b28,0xbf75dec6
.long 0xbf74fa0b,0xbf6a09a7,0xbf5b941a,0xbf49d112,0xbf4d9f02,0xbf373a23,0xbf1d7fd1,0xbf00e7e4
.long 0xbf0e39da,0xbedae880,0xbe94a031,0xbe164083,0xbe78cfcc,0xbdafb680,0x3d96a905,0x3e6c9a7f
.long 0x3dc8bd36,0x3e888e93,0x3edae880,0x3f13682a,0x3edae880,0x3f15f6d9,0x3f396842,0x3f5695e5
.long 0x00000000,0x00000000,0x00000000,0x00000000,0x00000000,0x3c490e90,0x3cc90ab0,0x3d16c32c
.long 0x00000000,0x3cc90ab0,0x3d48fb30,0x3d96a905,0x00000000,0x3d16c32c,0x3d96a905,0x3de1bc2e
.long 0x00000000,0x3d48fb30,0x3dc8bd36,0x3e164083,0x00000000,0x3d7b2b74,0x3dfab273,0x3e3b6ecf
.long 0x00000000,0x3d96a905,0x3e164083,0x3e605c13,0x00000000,0x3dafb680,0x3e2f10a2,0x3e827dc0
.long 0x00000000,0x3dc8bd36,0x3e47c5c2,0x3e94a031,0x00000000,0x3de1bc2e,0x3e605c13,0x3ea68f12
.long 0x00000000,0x3dfab273,0x3e78cfcc,0x3eb8442a,0x00000000,0x3e09cf86,0x3e888e93,0x3ec9b953
.long 0x00000000,0x3e164083,0x3e94a031,0x3edae880,0x00000000,0x3e22abb6,0x3ea09ae5,0x3eebcbbb
.long 0x00000000,0x3e2f10a2,0x3eac7cd4,0x3efc5d27,0x00000000,0x3e3b6ecf,0x3eb8442a,0x3f064b82
.long 0x00000000,0x00000000,0x00000000,0x00000000,0x3d48fb30,0x3d7b2b74,0x3d96a905,0x3dafb680
.long 0x3dc8bd36,0x3dfab273,0x3e164083,0x3e2f10a2,0x3e164083,0x3e3b6ecf,0x3e605c13,0x3e827dc0
.long 0x3e47c5c2,0x3e78cfcc,0x3e94a031,0x3eac7cd4,0x3e78cfcc,0x3e9aa086,0x3eb8442a,0x3ed53641
.long 0x3e94a031,0x3eb8442a,0x3edae880,0x3efc5d27,0x3eac7cd4,0x3ed53641,0x3efc5d27,0x3f10d3cd
.long 0x3ec3ef15,0x3ef15aea,0x3f0e39da,0x3f226799,0x3edae880,0x3f064b82,0x3f1d7fd1,0x3f32c8c9
.long 0x3ef15aea,0x3f13682a,0x3f2beb4a,0x3f41d870,0x3f039c3d,0x3f1ff6cb,0x3f396842,0x3f4f7a1f
.long 0x3f0e39da,0x3f2beb4a,0x3f45e403,0x3f5b941a,0x3f187fc0,0x3f373a23,0x3f514d3d,0x3f660f88
.long 0x3f226799,0x3f41d870,0x3f5b941a,0x3f6ed89e,0x3f2beb4a,0x3f4bbbf8,0x3f64aa59,0x3f75dec6
.long 0x00000000,0x00000000,0x00000000,0x00000000,0x3dc8bd36,0x3de1bc2e,0x3dfab273,0x3e09cf86
.long 0x3e47c5c2,0x3e605c13,0x3e78cfcc,0x3e888e93,0x3e94a031,0x3ea68f12,0x3eb8442a,0x3ec9b953
.long 0x3ec3ef15,0x3edae880,0x3ef15aea,0x3f039c3d,0x3ef15aea,0x3f064b82,0x3f13682a,0x3f1ff6cb
.long 0x3f0e39da,0x3f1d7fd1,0x3f2beb4a,0x3f396842,0x3f226799,0x3f32c8c9,0x3f41d870,0x3f4f7a1f
.long 0x3f3504f3,0x3f45e403,0x3f54db31,0x3f61c598,0x3f45e403,0x3f5695e5,0x3f64aa59,0x3f6ff573
.long 0x3f54db31,0x3f64aa59,0x3f710908,0x3f79c79d,0x3f61c598,0x3f6ff573,0x3f79c79d,0x3f7f0e58
.long 0x3f6c835e,0x3f7853f8,0x3f7ec46d,0x3f7fb10f,0x3f74fa0b,0x3f7dabcc,0x3f7fec43,0x3f7baccd
.long 0x3f7b14be,0x3f7fec43,0x3f7d3aac,0x3f731447,0x3f7ec46d,0x3f7f0e58,0x3f76ba07,0x3f660f88
.long 0x00000000,0x00000000,0x00000000,0x00000000,0x3e164083,0x3e22abb6,0x3e2f10a2,0x3e3b6ecf
.long 0x3e94a031,0x3ea09ae5,0x3eac7cd4,0x3eb8442a,0x3edae880,0x3eebcbbb,0x3efc5d27,0x3f064b82
.long 0x3f0e39da,0x3f187fc0,0x3f226799,0x3f2beb4a,0x3f2beb4a,0x3f373a23,0x3f41d870,0x3f4bbbf8
.long 0x3f45e403,0x3f514d3d,0x3f5b941a,0x3f64aa59,0x3f5b941a,0x3f660f88,0x3f6ed89e,0x3f75dec6
.long 0x3f6c835e,0x3f74fa0b,0x3f7b14be,0x3f7ec46d,0x3f7853f8,0x3f7dabcc,0x3f7fec43,0x3f7f0e58
.long 0x3f7ec46d,0x3f7fec43,0x3f7d3aac,0x3f76ba07,0x3f7fb10f,0x3f7baccd,0x3f731447,0x3f660f88
.long 0x3f7b14be,0x3f710908,0x3f61c598,0x3f4d9f02,0x3f710908,0x3f604621,0x3f49d112,0x3f2e3bde
.long 0x3f61c598,0x3f49d112,0x3f2beb4a,0x3f08f59b,0x3f4d9f02,0x3f2e3bde,0x3f08f59b,0x3ebe1d4a
.long 0x00000000,0x00000000,0x00000000,0x00000000,0x3e47c5c2,0x3e541501,0x3e605c13,0x3e6c9a7f
.long 0x3ec3ef15,0x3ecf7bca,0x3edae880,0x3ee63375,0x3f0e39da,0x3f15f6d9,0x3f1d7fd1,0x3f24d225
.long 0x3f3504f3,0x3f3daef9,0x3f45e403,0x3f4d9f02,0x3f54db31,0x3f5d2d53,0x3f64aa59,0x3f6b4b0c
.long 0x3f6c835e,0x3f731447,0x3f7853f8,0x3f7c3b28,0x3f7b14be,0x3f7e70b0,0x3f7fec43,0x3f7f84ab
.long 0x3f800000,0x3f7ec46d,0x3f7b14be,0x3f74fa0b,0x3f7b14be,0x3f740bdd,0x3f6a09a7,0x3f5d2d53
.long 0x3f6c835e,0x3f5ebe05,0x3f4d9f02,0x3f396842,0x3f54db31,0x3f3fc767,0x3f273656,0x3f0b9a6b
.long 0x3f3504f3,0x3f187fc0,0x3ef15aea,0x3eac7cd4,0x3f0e39da,0x3ed53641,0x3e888e93,0x3de1bc2e
.long 0x3ec3ef15,0x3e605c13,0x3d48fb30,0xbdfab273,0x3e47c5c2,0x3c490e90,0xbe2f10a2,0xbeb263ef
.long 0x00000000,0x00000000,0x00000000,0x00000000,0x3e78cfcc,0x3e827dc0,0x3e888e93,0x3e8e9a22
.long 0x3ef15aea,0x3efc5d27,0x3f039c3d,0x3f08f59b,0x3f2beb4a,0x3f32c8c9,0x3f396842,0x3f3fc767
.long 0x3f54db31,0x3f5b941a,0x3f61c598,0x3f676bd8,0x3f710908,0x3f75dec6,0x3f79c79d,0x3f7cbfc9
.long 0x3f7ec46d,0x3f7fec43,0x3f7fb10f,0x3f7e1324,0x3f7d3aac,0x3f791298,0x3f731447,0x3f6b4b0c
.long 0x3f6c835e,0x3f61c598,0x3f54db31,0x3f45e403,0x3f4d9f02,0x3f3b8f3b,0x3f273656,0x3f10d3cd
.long 0x3f226799,0x3f08f59b,0x3edae880,0x3ea09ae5,0x3edae880,0x3e9aa086,0x3e2f10a2,0x3d16c32c
.long 0x3e47c5c2,0x3d48fb30,0xbdc8bd36,0xbe78cfcc,0xbd48fb30,0xbe541501,0xbeb8442a,0xbf00e7e4
.long 0xbe94a031,0xbee63375,0xbf187fc0,0xbf396842,0xbf039c3d,0xbf299415,0xbf49d112,0xbf633c5a
.long 0x00000000,0x00000000,0x00000000,0x00000000,0x3e94a031,0x3e9aa086,0x3ea09ae5,0x3ea68f12
.long 0x3f0e39da,0x3f13682a,0x3f187fc0,0x3f1d7fd1,0x3f45e403,0x3f4bbbf8,0x3f514d3d,0x3f5695e5
.long 0x3f6c835e,0x3f710908,0x3f74fa0b,0x3f7853f8,0x3f7ec46d,0x3f7fd397,0x3f7fec43,0x3f7f0e58
.long 0x3f7b14be,0x3f76ba07,0x3f710908,0x3f6a09a7,0x3f61c598,0x3f5695e5,0x3f49d112,0x3f3b8f3b
.long 0x3f3504f3,0x3f226799,0x3f0e39da,0x3ef15aea,0x3ef15aea,0x3ebe1d4a,0x3e888e93,0x3e22abb6
.long 0x3e47c5c2,0x3d96a905,0xbd48fb30,0xbe2f10a2,0xbdc8bd36,0xbe6c9a7f,0xbeb8442a,0xbef6e0cb
.long 0xbec3ef15,0xbf039c3d,0xbf226799,0xbf3daef9,0xbf226799,0xbf3fc767,0xbf584853,0xbf6b4b0c
.long 0xbf54db31,0xbf6a09a7,0xbf7853f8,0xbf7f4e6d,0xbf74fa0b,0xbf7e70b0,0xbf7f4e6d,0xbf778bc5
.long 0x00000000,0x00000000,0x00000000,0x00000000,0x3eac7cd4,0x3eb263ef,0x3eb8442a,0x3ebe1d4a
.long 0x3f226799,0x3f273656,0x3f2beb4a,0x3f3085bb,0x3f5b941a,0x3f604621,0x3f64aa59,0x3f68bf3c
.long 0x3f7b14be,0x3f7d3aac,0x3f7ec46d,0x3f7fb10f,0x3f7d3aac,0x3f7a7302,0x3f76ba07,0x3f721352
.long 0x3f61c598,0x3f584853,0x3f4d9f02,0x3f41d870,0x3f2beb4a,0x3f1b02c6,0x3f08f59b,0x3eebcbbb
.long 0x3ec3ef15,0x3e94a031,0x3e47c5c2,0x3dc8bd36,0x3d48fb30,0xbd7b2b74,0xbe2f10a2,0xbe8e9a22
.long 0xbe94a031,0xbecf7bca,0xbf039c3d,0xbf1d7fd1,0xbf187fc0,0xbf32c8c9,0xbf49d112,0xbf5d2d53
.long 0xbf54db31,0xbf676bd8,0xbf74fa0b,0xbf7d3aac,0xbf7853f8,0xbf7f0e58,0xbf7f4e6d,0xbf791298
.long 0xbf7ec46d,0xbf76ba07,0xbf676bd8,0xbf514d3d,0xbf676bd8,0xbf4f7a1f,0xbf3085bb,0xbf0b9a6b
.size TABLE, 18432
.section .rodata,"a"
.p2align 6
.amdhsa_kernel interleave_layers__spectral_fnet__dense_activation_relu__prompt_kernel
  .amdhsa_next_free_vgpr 512
  .amdhsa_next_free_sgpr 102
  .amdhsa_accum_offset 256
  .amdhsa_group_segment_fixed_size 0
  .amdhsa_kernarg_size 88
  .amdhsa_user_sgpr_count 2
  .amdhsa_user_sgpr_kernarg_segment_ptr 1
  .amdhsa_system_sgpr_workgroup_id_x 1
  .amdhsa_float_denorm_mode_32 3
.end_amdhsa_kernel
```
